```python
import torch

def _softmax(x, axis=-1):
    return torch.softmax(x, dim=axis)
def _gelu(x):
    return torch.nn.functional.gelu(x, approximate="tanh")
def _silu(x):
    return torch.nn.functional.silu(x)
def _sigmoid(x):
    return torch.sigmoid(x)
def _layernorm(x, axis=-1, eps=1e-5):
    m = x.mean(dim=axis, keepdim=True)
    v = x.var(dim=axis, keepdim=True, unbiased=False)
    return (x - m) / torch.sqrt(v + eps)
def _scatter_add(tgt, idx, src, axis=0):
    return tgt.clone().index_add_(axis, idx, src)
def _segment_sum(src, seg, n):
    out = torch.zeros((n,) + src.shape[1:], dtype=src.dtype)
    return out.index_add_(0, seg, src)
def _pad(x, pw):
    flat = tuple(v for pair in reversed(pw) for v in pair)
    return torch.nn.functional.pad(x, flat)

kernel_name = 'parallel_sum__sliding_local_dilated__glu_gated_swiglu__prompt'

def setup_inputs():

    _w = (lambda a: (lambda t: t.to(torch.bfloat16) if t.is_floating_point() else t)(torch.as_tensor(a)))
    def _A_setup():
        B, S, D = 1, 2048, 512
        return {
            "x": _w((lambda *s: torch.randn(*s, dtype=torch.bfloat16) * 0.05)(B, S, D)),
            "wqkv": _w((lambda *s: torch.randn(*s, dtype=torch.bfloat16) * 0.05)(D, 3 * D)),
            "wo": _w((lambda *s: torch.randn(*s, dtype=torch.bfloat16) * 0.05)(D, D)),
        }
    _A_in = _A_setup()

    def _B_setup():
        B, S, D, F = 1, 2048, 512, 1792
        return {
            "x": _w((lambda *s: torch.randn(*s, dtype=torch.bfloat16) * 0.05)(B, S, D)),
            "w1": _w((lambda *s: torch.randn(*s, dtype=torch.bfloat16) * 0.8)(D, F) * (2.0 / D) ** 0.5),
            "w3": _w((lambda *s: torch.randn(*s, dtype=torch.bfloat16) * 0.8)(D, F) * (2.0 / D) ** 0.5),
            "w2": _w((lambda *s: torch.randn(*s, dtype=torch.bfloat16) * 0.8)(F, D) * (2.0 / F) ** 0.5),
        }
    _B_in = _B_setup()

    return {
        "A_x": _A_in["x"],
        "A_wqkv": _A_in["wqkv"],
        "A_wo": _A_in["wo"],
        "B_x": _B_in["x"],
        "B_w1": _B_in["w1"],
        "B_w3": _B_in["w3"],
        "B_w2": _B_in["w2"],
    }

def reference(A_x, A_wqkv, A_wo, B_x, B_w1, B_w3, B_w2):
    def _A_ref(x, wqkv, wo):
        B, S, D = x.shape
        H = 32; Dh = D // H
        W, dil = 8, 2
        qkv = (lambda x, *d: x.permute(*d))((x @ wqkv).reshape(B, S, 3, H, Dh), 2, 0, 3, 1, 4)
        q, k, v = qkv[0], qkv[1], qkv[2]
        scale = Dh ** -0.5
        pos = torch.arange(S)
        off = torch.arange(W) * dil
        idx = pos[:, None] - off[None, :]
        mask = idx >= 0
        idx_c = torch.where(mask, idx, 0).reshape(-1)
        kg = k[:, :, idx_c, :].reshape(B, H, S, W, Dh)
        vg = v[:, :, idx_c, :].reshape(B, H, S, W, Dh)
        logits = torch.einsum("bhsd,bhswd->bhsw", q, kg) * scale
        logits = torch.where(mask[None, None, :, :], logits, -1e9)
        attn = _softmax(logits, axis=-1)
        o = torch.einsum("bhsw,bhswd->bhsd", attn, vg)
        return (lambda x, *d: x.permute(*d))(o, 0, 2, 1, 3).reshape(B, S, D) @ wo

    def _B_ref(x, w1, w3, w2):
        gate = torch.einsum("bsd,df->bsf", x, w1)
        up = torch.einsum("bsd,df->bsf", x, w3)
        h = _silu(gate) * up
        out = torch.einsum("bsf,fd->bsd", h, w2)
        return out

    x = A_x
    xn = _layernorm(x, axis=-1)
    return x + _A_ref(xn, A_wqkv, A_wo) + _B_ref(xn, B_w1, B_w3, B_w2)
```

```asm
; @launch grid=(256,1,1) block=(256,1,1) lds=163840
.amdgcn_target "amdgcn-amd-amdhsa--gfx950"
.text
.globl parallel_sum__sliding_local_dilated__glu_gated_swiglu__prompt_kernel
.p2align 12
.p2align 8
.type parallel_sum__sliding_local_dilated__glu_gated_swiglu__prompt_kernel,@function
parallel_sum__sliding_local_dilated__glu_gated_swiglu__prompt_kernel:
    s_load_dwordx2 s[24:25], s[0:1], 0
    s_cmp_ge_u32 s2, 256
    s_cbranch_scc1 L_end
    s_getpc_b64 s[32:33]
L_pc:
    v_lshrrev_b32 v212, 6, v0
    v_and_b32 v210, 31, v0
    v_lshl_add_u32 v210, v212, 5, v210
    v_lshlrev_b32 v210, 2, v210
    s_mov_b32 s34, L_tab+131072-L_pc
    s_mov_b32 s35, 0x20000
    s_lshl_b32 s9, s2, 9
    s_add_u32 s9, s9, L_tab-L_pc
    buffer_load_dword v213, v210, s[32:35], s9 offen
    v_readfirstlane_b32 s4, v212
    v_and_b32 v210, 7, v0
    v_lshlrev_b32 v210, 4, v210
    v_bfe_u32 v211, v0, 3, 3
    v_lshl_add_u32 v174, v211, 10, v210
    s_bfe_u32 s7, s2, 0x20003
    s_lshr_b32 s10, s2, 5
    s_and_b32 s8, s2, 4
    s_lshl1_add_u32 s8, s8, s10
    s_and_b32 s16, s2, 3
    s_lshl2_add_u32 s15, s8, s4
    s_lshl_b32 s15, s15, 15
    s_lshl_b32 s14, s10, 7
    s_add_u32 s14, s15, s14
    s_add_u32 s15, s14, 1024
    s_mov_b32 s26, 2098176
    s_mov_b32 s27, 0x20000
    s_lshl_b32 s11, s16, 13
    v_add_u32 v227, s11, v174
    s_mov_b32 s12, s10
    s_mov_b32 s34, L_codeend-L_pc
    s_lshr_b32 s8, s2, 3
    s_lshl_b32 s8, s8, 11
    v_lshrrev_b32 v210, 4, v0
    v_lshlrev_b32 v210, 13, v210
    v_add_lshl_u32 v210, v210, v0, 7
    buffer_load_dword a255, v210, s[32:35], s8 offen
    v_and_b32 v218, 63, v0
    s_waitcnt lgkmcnt(0)
    s_sub_u32 s24, s24, 1024
    s_subb_u32 s25, s25, 0
    buffer_load_dwordx4 v[0:3], v227, s[24:27], s15 offen offset:0
    s_cmp_ge_u32 s12, 7
    s_cselect_b32 s75, s14, s15
    buffer_load_dwordx4 v[4:7], v227, s[24:27], s75 offen offset:128
    s_cmp_ge_u32 s12, 6
    s_cselect_b32 s76, s14, s15
    buffer_load_dwordx4 v[8:11], v227, s[24:27], s76 offen offset:256
    s_cmp_ge_u32 s12, 5
    s_cselect_b32 s77, s14, s15
    buffer_load_dwordx4 v[12:15], v227, s[24:27], s77 offen offset:384
    s_cmp_ge_u32 s12, 4
    s_cselect_b32 s78, s14, s15
    buffer_load_dwordx4 v[16:19], v227, s[24:27], s78 offen offset:512
    s_cmp_ge_u32 s12, 3
    s_cselect_b32 s79, s14, s15
    buffer_load_dwordx4 v[20:23], v227, s[24:27], s79 offen offset:640
    s_cmp_ge_u32 s12, 2
    s_cselect_b32 s80, s14, s15
    buffer_load_dwordx4 v[24:27], v227, s[24:27], s80 offen offset:768
    s_cmp_ge_u32 s12, 1
    s_cselect_b32 s81, s14, s15
    buffer_load_dwordx4 v[28:31], v227, s[24:27], s81 offen offset:896
    s_and_b32 s6, s4, 1
    s_lshr_b32 s5, s4, 1
    s_lshl_b32 s13, s10, 1
    s_lshl3_add_u32 s22, s6, s0
    s_addc_u32 s23, s1, 0
    s_load_dwordx2 s[28:29], s[22:23], 32
    s_load_dwordx2 s[36:37], s[0:1], 48
    s_load_dwordx2 s[40:41], s[0:1], 16
    s_load_dwordx2 s[44:45], s[0:1], 72
    s_load_dwordx2 s[48:49], s[0:1], 64
    s_load_dwordx2 s[32:33], s[0:1], 8
    s_load_dwordx2 s[52:53], s[0:1], 56
    s_mov_b32 s30, 1835008
    s_mov_b32 s31, 0x20000
    s_mov_b32 s34, 1572864
    s_mov_b32 s35, 0x20000
    s_mov_b32 s38, 1835008
    s_mov_b32 s39, 0x20000
    s_mov_b32 s42, 524288
    s_mov_b32 s43, 0x20000
    s_mov_b32 s46, 14680064
    s_mov_b32 s47, 0x20000
    s_mov_b32 s50, 256
    s_mov_b32 s51, 0x20000
    s_mov_b32 s54, 2097152
    s_mov_b32 s55, 0x20000
    v_mov_b32 v222, 0xbb00bb00
    v_mov_b32 v223, 0xbb00bb00
    v_lshrrev_b32 v208, 4, v218
    v_and_b32 v209, 15, v218
    v_lshlrev_b32 v160, 4, v218
    s_lshl_b32 s8, s5, 12
    s_add_u32 s8, s8, 32768
    v_xor_b32 v210, v209, v208
    v_lshl_add_u32 v210, v210, 4, s8
    v_lshl_add_u32 v172, v208, 8, v210
    v_xor_b32 v173, 64, v172
    s_lshr_b32 s8, s16, 1
    s_lshl1_add_u32 s8, s4, s8
    s_and_b32 s9, s16, 1
    s_lshl3_add_u32 s8, s8, s9
    s_lshl_b32 s8, s8, 7
    s_add_u32 s8, s8, 32768
    v_xor_b32 v210, v218, v211
    v_and_b32 v210, 7, v210
    v_lshl_add_u32 v210, v210, 4, s8
    v_bfe_u32 v212, v218, 2, 1
    v_lshl_add_u32 v210, v212, 13, v210
    v_and_b32 v216, 3, v218
    v_lshl_add_u32 v224, v216, 8, v210
    v_add_u32 v225, 0x10000, v224
    v_cmp_gt_u32 vcc, 2, v216
    v_and_b32 v210, 16, v160
    v_mov_b32 v212, 0x3f80
    v_lshlrev_b32 v210, v210, v212
    v_cndmask_b32 v232, 0, v210, vcc
    v_sub_u32 v233, v210, v232
    v_mov_b32 v221, 0x3b000000
    s_lshl2_add_u32 s8, s4, s16
    s_lshl_b32 s8, s8, 6
    s_add_u32 s8, s8, 147456
    v_lshl_add_u32 v200, v211, 3, s8
    v_xor_b32 v201, 64, v200
    v_xor_b32 v202, 128, v200
    v_xor_b32 v203, 192, v200
    s_lshl_b32 s8, s5, 9
    s_add_u32 s8, s8, 147456
    v_lshl_add_u32 v204, v209, 3, s8
    v_add_u32 v210, 2, v218
    v_lshrrev_b32 v210, 4, v210
    v_lshlrev_b32 v210, 17, v210
    v_add_lshl_u32 v214, v210, v218, 7
    v_lshrrev_b32 v212, 2, v218
    v_lshl_add_u32 v215, v212, 24, v214
    v_lshlrev_b32 v210, 14, v211
    v_add_lshl_u32 v179, v210, v218, 10
    v_mov_b32 v228, 0
    v_mov_b32 v229, 0
    v_mov_b32 v230, 0
    v_mov_b32 v231, 0
    s_lshl_b32 s8, s4, 12
    s_add_u32 s9, s8, 49152
    v_and_b32 v217, 3, v211
    v_lshl_add_u32 v210, v217, 5, s9
    v_lshl_add_u32 v210, v216, 3, v210
    v_lshl_add_u32 v180, v212, 7, v210
    v_xor_b32 v181, 32, v180
    v_xor_b32 v182, 64, v180
    v_xor_b32 v183, 96, v180
    s_movk_i32 s9, 3584
    s_movk_i32 s11, 3072
    v_and_b32 v210, 32, v218
    v_lshl_add_u32 v178, v210, 4, v160
    v_lshlrev_b32 v166, 4, v216
    v_xor_b32 v210, v210, v166
    v_mad_u32_u24 v163, v212, s9, v210
    s_lshl_b32 s17, s6, 1
    v_xor_b32 v161, s17, v217
    v_lshlrev_b32 v161, 5, v161
    v_lshl_add_u32 v161, v216, 3, v161
    v_and_b32 v217, 7, v218
    v_xor_b32 v210, v208, v217
    s_add_u32 s8, s8, 0
    v_lshl_add_u32 v210, v210, 4, s8
    v_lshl_add_u32 v175, v209, 8, v210
    s_lshl_b32 s8, s4, 14
    s_add_u32 s8, s8, 0
    v_lshlrev_b32 v210, 1, v217
    v_xor_b32 v210, v210, v211
    v_lshl_add_u32 v210, v210, 4, s8
    v_lshl_add_u32 v176, v211, 8, v210
    v_and_b32 v210, 0x70, v160
    v_lshlrev_b32 v212, 5, v208
    v_xor_b32 v168, v210, v212
    v_lshl_add_u32 v168, v211, 10, v168
    v_and_b32 v212, 32, v212
    v_xor_b32 v210, v210, v212
    v_mad_u32_u24 v164, v211, s9, v210
    v_mad_u32_u24 v166, v211, s11, v210
    v_xor_b32 v165, 64, v164
    v_add_u32 v165, 27648, v165
    v_xor_b32 v167, 64, v166
    v_add_u32 v167, 23552, v167
    s_cmp_ge_u32 s7, 2
    s_cselect_b64 vcc, -1, 0
    v_add_u32 v210, 56320, v163
    v_cndmask_b32 v166, v166, v163, vcc
    v_cndmask_b32 v167, v167, v210, vcc
    v_bfe_u32 v217, v218, 2, 2
    v_lshl_add_u32 v217, v208, 3, v217
    v_lshl_add_u32 v161, v217, 7, v161
    v_xor_b32 v162, 32, v161
    s_lshl_b32 s8, s6, 5
    v_xor_b32 v210, s8, v212
    v_lshl_add_u32 v210, v216, 3, v210
    v_lshl_add_u32 v163, v217, 6, v210
    v_lshl_add_u32 v169, v218, 25, 64
    v_lshlrev_b32 v170, 2, v209
    v_cmp_lt_u32 vcc, 31, v218
    v_lshlrev_b32 v210, 1, v218
    s_nop 0
    v_cndmask_b32 v210, v218, v210, vcc
    v_add_u32 v210, s13, v210
    v_and_b32 v210, 15, v210
    v_lshlrev_b32 v210, 5, v210
    s_cmp_lt_u32 s7, 2
    s_cselect_b32 s11, s11, s9
    v_cmp_lt_u32 s[20:21], 15, v218
    v_mov_b32 v212, s9
    v_mov_b32 v216, s11
    v_cndmask_b32 v212, v212, v216, s[20:21]
    v_mul_u32_u24 v177, v210, v212
    s_mov_b32 s18, 0x22222222
    s_mov_b32 s19, 0x22222222
    s_mov_b32 s20, 0x44444444
    s_mov_b32 s21, 0x44444444
    s_mov_b32 s22, 0x88888888
    s_mov_b32 s23, 0x88888888
    v_lshlrev_b32 v210, 2, v208
    s_waitcnt lgkmcnt(0)
    s_waitcnt vmcnt(9)
    ds_bpermute_b32 v212, v210, v213
    v_readlane_b32 s59, v213, 3
    v_readlane_b32 s60, v213, 4
    v_readlane_b32 s61, v213, 5
    v_readlane_b32 s62, v213, 6
    v_readlane_b32 s63, v213, 7
    v_readlane_b32 s64, v213, 8
    v_readlane_b32 s65, v213, 9
    v_readlane_b32 s66, v213, 10
    v_readlane_b32 s67, v213, 11
    v_readlane_b32 s68, v213, 12
    v_readlane_b32 s69, v213, 13
    v_readlane_b32 s70, v213, 14
    v_readlane_b32 s71, v213, 15
    v_readlane_b32 s72, v213, 16
    v_readlane_b32 s73, v213, 17
    v_readlane_b32 s74, v213, 18
    v_readlane_b32 s82, v213, 26
    v_readlane_b32 s83, v213, 27
    v_readlane_b32 s84, v213, 28
    v_readlane_b32 s85, v213, 29
    v_readlane_b32 s86, v213, 30
    v_readlane_b32 s87, v213, 31
    s_waitcnt lgkmcnt(0)
    v_add_u32 v177, v177, v212
    buffer_store_dwordx4 v[228:231], v160, s[44:47], s84 offen offset:0 sc1
    buffer_store_dwordx4 v[228:231], v160, s[44:47], s84 offen offset:1024 sc1
    s_min_u32 s68, s68, 1
    s_cmp_eq_u32 s68, 0
    s_cselect_b32 s70, 1073741824, s70
    s_mov_b32 s88, 0xbfb8aa3b
    v_readlane_b32 s56, v177, 0
    v_xor_b32 v227, 8192, v227
    buffer_load_dwordx4 v[32:35], v227, s[24:27], s15 offen offset:0
    buffer_load_dwordx4 v[36:39], v227, s[24:27], s75 offen offset:128
    buffer_load_dwordx4 v[40:43], v227, s[24:27], s76 offen offset:256
    s_lshr_b32 s8, s7, 1
    s_lshl2_add_u32 s8, s8, s4
    s_mov_b64 exec, 0
    s_cmp_eq_u32 s8, 0
    s_cbranch_scc1 L_stub1
    s_cmp_eq_u32 s8, 1
    s_cbranch_scc1 L_stub2
    s_cmp_eq_u32 s8, 2
    s_cbranch_scc1 L_stub3
    s_cmp_eq_u32 s8, 3
    s_cbranch_scc1 L_stub4
    s_cmp_eq_u32 s8, 4
    s_cbranch_scc1 L_stub6
    s_cmp_eq_u32 s8, 5
    s_cbranch_scc1 L_stub7
    s_cmp_eq_u32 s8, 6
    s_cbranch_scc1 L_stub8
    s_cmp_eq_u32 s8, 7
    s_cbranch_scc1 L_stub9
L_tourret:
    s_mov_b64 exec, -1
    s_waitcnt vmcnt(12)
    v_mfma_f32_4x4x4_16b_bf16 v[236:239], v[222:223], v[0:1], 0
    v_mfma_f32_4x4x4_16b_bf16 v[240:243], v[0:1], v[0:1], 0
    buffer_load_dwordx4 v[44:47], v227, s[24:27], s77 offen offset:384
    v_mfma_f32_4x4x4_16b_bf16 v[236:239], v[222:223], v[2:3], v[236:239]
    v_mfma_f32_4x4x4_16b_bf16 v[240:243], v[2:3], v[2:3], v[240:243]
    s_waitcnt vmcnt(12)
    v_mfma_f32_4x4x4_16b_bf16 v[236:239], v[222:223], v[4:5], v[236:239]
    v_mfma_f32_4x4x4_16b_bf16 v[240:243], v[4:5], v[4:5], v[240:243]
    buffer_load_dwordx4 v[48:51], v227, s[24:27], s78 offen offset:512
    v_mfma_f32_4x4x4_16b_bf16 v[236:239], v[222:223], v[6:7], v[236:239]
    v_mfma_f32_4x4x4_16b_bf16 v[240:243], v[6:7], v[6:7], v[240:243]
    s_waitcnt vmcnt(12)
    v_mfma_f32_4x4x4_16b_bf16 v[236:239], v[222:223], v[8:9], v[236:239]
    v_mfma_f32_4x4x4_16b_bf16 v[240:243], v[8:9], v[8:9], v[240:243]
    buffer_load_dwordx4 v[52:55], v227, s[24:27], s79 offen offset:640
    v_mfma_f32_4x4x4_16b_bf16 v[236:239], v[222:223], v[10:11], v[236:239]
    v_mfma_f32_4x4x4_16b_bf16 v[240:243], v[10:11], v[10:11], v[240:243]
    s_waitcnt vmcnt(12)
    v_mfma_f32_4x4x4_16b_bf16 v[236:239], v[222:223], v[12:13], v[236:239]
    v_mfma_f32_4x4x4_16b_bf16 v[240:243], v[12:13], v[12:13], v[240:243]
    buffer_load_dwordx4 v[56:59], v227, s[24:27], s80 offen offset:768
    v_mfma_f32_4x4x4_16b_bf16 v[236:239], v[222:223], v[14:15], v[236:239]
    v_mfma_f32_4x4x4_16b_bf16 v[240:243], v[14:15], v[14:15], v[240:243]
    s_waitcnt vmcnt(12)
    v_mfma_f32_4x4x4_16b_bf16 v[236:239], v[222:223], v[16:17], v[236:239]
    v_mfma_f32_4x4x4_16b_bf16 v[240:243], v[16:17], v[16:17], v[240:243]
    buffer_load_dwordx4 v[60:63], v227, s[24:27], s81 offen offset:896
    v_mfma_f32_4x4x4_16b_bf16 v[236:239], v[222:223], v[18:19], v[236:239]
    v_mfma_f32_4x4x4_16b_bf16 v[240:243], v[18:19], v[18:19], v[240:243]
    s_waitcnt vmcnt(12)
    v_mfma_f32_4x4x4_16b_bf16 v[236:239], v[222:223], v[20:21], v[236:239]
    v_mfma_f32_4x4x4_16b_bf16 v[240:243], v[20:21], v[20:21], v[240:243]
    v_xor_b32 v227, 24576, v227
    buffer_load_dwordx4 v[64:67], v227, s[24:27], s15 offen offset:0
    v_mfma_f32_4x4x4_16b_bf16 v[236:239], v[222:223], v[22:23], v[236:239]
    v_mfma_f32_4x4x4_16b_bf16 v[240:243], v[22:23], v[22:23], v[240:243]
    s_waitcnt vmcnt(12)
    v_mfma_f32_4x4x4_16b_bf16 v[236:239], v[222:223], v[24:25], v[236:239]
    v_mfma_f32_4x4x4_16b_bf16 v[240:243], v[24:25], v[24:25], v[240:243]
    buffer_load_dwordx4 v[68:71], v227, s[24:27], s75 offen offset:128
    v_mfma_f32_4x4x4_16b_bf16 v[236:239], v[222:223], v[26:27], v[236:239]
    v_mfma_f32_4x4x4_16b_bf16 v[240:243], v[26:27], v[26:27], v[240:243]
    s_waitcnt vmcnt(12)
    v_mfma_f32_4x4x4_16b_bf16 v[236:239], v[222:223], v[28:29], v[236:239]
    v_mfma_f32_4x4x4_16b_bf16 v[240:243], v[28:29], v[28:29], v[240:243]
    buffer_load_dwordx4 v[72:75], v227, s[24:27], s76 offen offset:256
    v_mfma_f32_4x4x4_16b_bf16 v[236:239], v[222:223], v[30:31], v[236:239]
    v_mfma_f32_4x4x4_16b_bf16 v[240:243], v[30:31], v[30:31], v[240:243]
    s_nop 3
    v_add_f32_dpp v236, v236, v236 quad_perm:[1,0,3,2] row_mask:0xf bank_mask:0xf
    v_cndmask_b32 v240, v240, v241, s[18:19]
    s_nop 0
    v_add_f32_dpp v236, v236, v236 quad_perm:[2,3,0,1] row_mask:0xf bank_mask:0xf
    v_cndmask_b32 v240, v240, v242, s[20:21]
    v_cndmask_b32 v240, v240, v243, s[22:23]
    v_add_f32_dpp v237, v236, v236 row_half_mirror row_mask:0xf bank_mask:0xf
    v_add_f32_dpp v238, v236, v236 row_half_mirror row_mask:0xf bank_mask:0xf
    v_add_f32_dpp v239, v236, v236 row_half_mirror row_mask:0xf bank_mask:0xf
    v_add_f32_dpp v236, v236, v236 row_half_mirror row_mask:0xf bank_mask:0xf
    s_nop 1
    v_mfma_f32_4x4x4_16b_bf16 v[128:131], v[232:233], v[0:1], v[236:239]
    v_add_f32_dpp v240, v240, v240 quad_perm:[1,0,3,2] row_mask:0xf bank_mask:0xf
    v_mfma_f32_4x4x4_16b_bf16 v[132:135], v[232:233], v[2:3], v[236:239]
    v_mul_f32 v241, v236, v236
    v_mfma_f32_4x4x4_16b_bf16 v[136:139], v[232:233], v[4:5], v[236:239]
    v_add_f32_dpp v240, v240, v240 quad_perm:[2,3,0,1] row_mask:0xf bank_mask:0xf
    buffer_load_dwordx4 v[76:79], v227, s[24:27], s77 offen offset:384
    v_mfma_f32_4x4x4_16b_bf16 v[140:143], v[232:233], v[6:7], v[236:239]
    v_add_f32_dpp v240, v240, v240 row_half_mirror row_mask:0xf bank_mask:0xf
    v_cvt_pk_bf16_f32 v0, v128, v129
    v_cvt_pk_bf16_f32 v1, v130, v131
    v_mfma_f32_4x4x4_16b_bf16 v[144:147], v[232:233], v[8:9], v[236:239]
    v_fma_f32 v240, v240, v221, -v241
    v_cvt_pk_bf16_f32 v2, v132, v133
    v_cvt_pk_bf16_f32 v3, v134, v135
    ds_write_b128 v224, v[0:3] offset:0
    v_mfma_f32_4x4x4_16b_bf16 v[148:151], v[232:233], v[10:11], v[236:239]
    v_max_f32 v240, 0, v240
    v_cvt_pk_bf16_f32 v4, v136, v137
    v_cvt_pk_bf16_f32 v5, v138, v139
    v_mfma_f32_4x4x4_16b_bf16 v[152:155], v[232:233], v[12:13], v[236:239]
    v_add_f32 v185, 0x3727c5ac, v240
    v_cvt_pk_bf16_f32 v6, v140, v141
    v_cvt_pk_bf16_f32 v7, v142, v143
    ds_write_b128 v224, v[4:7] offset:16384
    buffer_load_dwordx4 v[80:83], v227, s[24:27], s78 offen offset:512
    v_mfma_f32_4x4x4_16b_bf16 v[156:159], v[232:233], v[14:15], v[236:239]
    v_rsq_f32 v240, v185
    v_cvt_pk_bf16_f32 v8, v144, v145
    v_cvt_pk_bf16_f32 v9, v146, v147
    v_mfma_f32_4x4x4_16b_bf16 v[128:131], v[232:233], v[16:17], v[236:239]
    v_mul_f32 v184, s88, v240
    v_cvt_pk_bf16_f32 v10, v148, v149
    v_cvt_pk_bf16_f32 v11, v150, v151
    ds_write_b128 v224, v[8:11] offset:32768
    v_mfma_f32_4x4x4_16b_bf16 v[132:135], v[232:233], v[18:19], v[236:239]
    v_cvt_pk_bf16_f32 v12, v152, v153
    v_cvt_pk_bf16_f32 v13, v154, v155
    v_mfma_f32_4x4x4_16b_bf16 v[136:139], v[232:233], v[20:21], v[236:239]
    v_cvt_pk_bf16_f32 v14, v156, v157
    v_cvt_pk_bf16_f32 v15, v158, v159
    ds_write_b128 v224, v[12:15] offset:49152
    buffer_load_dwordx4 v[84:87], v227, s[24:27], s79 offen offset:640
    v_mfma_f32_4x4x4_16b_bf16 v[140:143], v[232:233], v[22:23], v[236:239]
    v_cvt_pk_bf16_f32 v16, v128, v129
    v_cvt_pk_bf16_f32 v17, v130, v131
    v_mfma_f32_4x4x4_16b_bf16 v[144:147], v[232:233], v[24:25], v[236:239]
    v_cvt_pk_bf16_f32 v18, v132, v133
    v_cvt_pk_bf16_f32 v19, v134, v135
    s_waitcnt vmcnt(13)
    v_mfma_f32_4x4x4_16b_bf16 v[244:247], v[222:223], v[32:33], 0
    v_mfma_f32_4x4x4_16b_bf16 v[248:251], v[32:33], v[32:33], 0
    ds_write_b128 v225, v[16:19] offset:0
    buffer_load_dwordx4 v[88:91], v227, s[24:27], s80 offen offset:768
    v_mfma_f32_4x4x4_16b_bf16 v[244:247], v[222:223], v[34:35], v[244:247]
    v_mfma_f32_4x4x4_16b_bf16 v[148:151], v[232:233], v[26:27], v[236:239]
    v_mfma_f32_4x4x4_16b_bf16 v[248:251], v[34:35], v[34:35], v[248:251]
    s_waitcnt vmcnt(13)
    v_mfma_f32_4x4x4_16b_bf16 v[244:247], v[222:223], v[36:37], v[244:247]
    v_mfma_f32_4x4x4_16b_bf16 v[248:251], v[36:37], v[36:37], v[248:251]
    v_cvt_pk_bf16_f32 v20, v136, v137
    buffer_load_dwordx4 v[92:95], v227, s[24:27], s81 offen offset:896
    v_mfma_f32_4x4x4_16b_bf16 v[244:247], v[222:223], v[38:39], v[244:247]
    v_cvt_pk_bf16_f32 v21, v138, v139
    v_mfma_f32_4x4x4_16b_bf16 v[248:251], v[38:39], v[38:39], v[248:251]
    s_waitcnt vmcnt(13)
    v_mfma_f32_4x4x4_16b_bf16 v[244:247], v[222:223], v[40:41], v[244:247]
    v_mfma_f32_4x4x4_16b_bf16 v[152:155], v[232:233], v[28:29], v[236:239]
    v_mfma_f32_4x4x4_16b_bf16 v[248:251], v[40:41], v[40:41], v[248:251]
    v_xor_b32 v227, 8192, v227
    buffer_load_dwordx4 v[96:99], v227, s[24:27], s15 offen offset:0
    v_mfma_f32_4x4x4_16b_bf16 v[244:247], v[222:223], v[42:43], v[244:247]
    v_cvt_pk_bf16_f32 v22, v140, v141
    v_mfma_f32_4x4x4_16b_bf16 v[248:251], v[42:43], v[42:43], v[248:251]
    s_waitcnt vmcnt(13)
    v_mfma_f32_4x4x4_16b_bf16 v[244:247], v[222:223], v[44:45], v[244:247]
    v_cvt_pk_bf16_f32 v23, v142, v143
    v_mfma_f32_4x4x4_16b_bf16 v[248:251], v[44:45], v[44:45], v[248:251]
    buffer_load_dwordx4 v[100:103], v227, s[24:27], s75 offen offset:128
    ds_write_b128 v225, v[20:23] offset:16384
    v_mfma_f32_4x4x4_16b_bf16 v[244:247], v[222:223], v[46:47], v[244:247]
    v_mfma_f32_4x4x4_16b_bf16 v[248:251], v[46:47], v[46:47], v[248:251]
    s_waitcnt vmcnt(13)
    v_mfma_f32_4x4x4_16b_bf16 v[244:247], v[222:223], v[48:49], v[244:247]
    buffer_load_dwordx4 v[104:107], v227, s[24:27], s76 offen offset:256
    v_mfma_f32_4x4x4_16b_bf16 v[248:251], v[48:49], v[48:49], v[248:251]
    buffer_load_dwordx4 v[108:111], v227, s[24:27], s77 offen offset:384
    v_mfma_f32_4x4x4_16b_bf16 v[156:159], v[232:233], v[30:31], v[236:239]
    v_mfma_f32_4x4x4_16b_bf16 v[244:247], v[222:223], v[50:51], v[244:247]
    v_mfma_f32_4x4x4_16b_bf16 v[248:251], v[50:51], v[50:51], v[248:251]
    v_cvt_pk_bf16_f32 v24, v144, v145
    s_waitcnt vmcnt(14)
    v_mfma_f32_4x4x4_16b_bf16 v[244:247], v[222:223], v[52:53], v[244:247]
    v_mfma_f32_4x4x4_16b_bf16 v[248:251], v[52:53], v[52:53], v[248:251]
    buffer_load_dwordx4 v[112:115], v227, s[24:27], s78 offen offset:512
    v_cvt_pk_bf16_f32 v25, v146, v147
    v_mfma_f32_4x4x4_16b_bf16 v[244:247], v[222:223], v[54:55], v[244:247]
    v_mfma_f32_4x4x4_16b_bf16 v[248:251], v[54:55], v[54:55], v[248:251]
    v_cvt_pk_bf16_f32 v26, v148, v149
    s_waitcnt vmcnt(14)
    v_mfma_f32_4x4x4_16b_bf16 v[244:247], v[222:223], v[56:57], v[244:247]
    v_mfma_f32_4x4x4_16b_bf16 v[248:251], v[56:57], v[56:57], v[248:251]
    v_cvt_pk_bf16_f32 v27, v150, v151
    buffer_load_dwordx4 v[116:119], v227, s[24:27], s79 offen offset:640
    v_mfma_f32_4x4x4_16b_bf16 v[244:247], v[222:223], v[58:59], v[244:247]
    v_mfma_f32_4x4x4_16b_bf16 v[248:251], v[58:59], v[58:59], v[248:251]
    ds_write_b128 v225, v[24:27] offset:32768
    s_waitcnt vmcnt(14)
    v_mfma_f32_4x4x4_16b_bf16 v[244:247], v[222:223], v[60:61], v[244:247]
    v_mfma_f32_4x4x4_16b_bf16 v[248:251], v[60:61], v[60:61], v[248:251]
    v_cvt_pk_bf16_f32 v28, v152, v153
    buffer_load_dwordx4 v[120:123], v227, s[24:27], s80 offen offset:768
    v_mfma_f32_4x4x4_16b_bf16 v[244:247], v[222:223], v[62:63], v[244:247]
    v_cvt_pk_bf16_f32 v29, v154, v155
    v_mfma_f32_4x4x4_16b_bf16 v[248:251], v[62:63], v[62:63], v[248:251]
    s_nop 2
    v_add_f32_dpp v244, v244, v244 quad_perm:[1,0,3,2] row_mask:0xf bank_mask:0xf
    s_nop 0
    v_cndmask_b32 v248, v248, v249, s[18:19]
    v_cvt_pk_bf16_f32 v30, v156, v157
    v_add_f32_dpp v244, v244, v244 quad_perm:[2,3,0,1] row_mask:0xf bank_mask:0xf
    v_cndmask_b32 v248, v248, v250, s[20:21]
    v_cvt_pk_bf16_f32 v31, v158, v159
    v_cndmask_b32 v248, v248, v251, s[22:23]
    v_add_f32_dpp v245, v244, v244 row_half_mirror row_mask:0xf bank_mask:0xf
    ds_write_b128 v225, v[28:31] offset:49152
    v_add_f32_dpp v246, v244, v244 row_half_mirror row_mask:0xf bank_mask:0xf
    v_add_f32_dpp v247, v244, v244 row_half_mirror row_mask:0xf bank_mask:0xf
    v_add_f32_dpp v244, v244, v244 row_half_mirror row_mask:0xf bank_mask:0xf
    v_xor_b32 v224, 128, v224
    v_xor_b32 v225, 128, v225
    s_waitcnt vmcnt(14)
    v_mfma_f32_4x4x4_16b_bf16 v[236:239], v[222:223], v[64:65], 0
    v_mfma_f32_4x4x4_16b_bf16 v[128:131], v[232:233], v[32:33], v[244:247]
    v_mfma_f32_4x4x4_16b_bf16 v[240:243], v[64:65], v[64:65], 0
    v_add_f32_dpp v248, v248, v248 quad_perm:[1,0,3,2] row_mask:0xf bank_mask:0xf
    v_mfma_f32_4x4x4_16b_bf16 v[132:135], v[232:233], v[34:35], v[244:247]
    buffer_load_dwordx4 v[124:127], v227, s[24:27], s81 offen offset:896
    v_mul_f32 v249, v244, v244
    v_mfma_f32_4x4x4_16b_bf16 v[236:239], v[222:223], v[66:67], v[236:239]
    v_mfma_f32_4x4x4_16b_bf16 v[136:139], v[232:233], v[36:37], v[244:247]
    v_add_f32_dpp v248, v248, v248 quad_perm:[2,3,0,1] row_mask:0xf bank_mask:0xf
    v_mfma_f32_4x4x4_16b_bf16 v[240:243], v[66:67], v[66:67], v[240:243]
    s_add_u32 m0, s59, 0
    s_nop 0
    buffer_load_dwordx4 v164, s[28:31], s56 offen offset:0 lds
    v_readlane_b32 s57, v177, 1
    s_waitcnt vmcnt(15)
    v_mfma_f32_4x4x4_16b_bf16 v[236:239], v[222:223], v[68:69], v[236:239]
    v_mfma_f32_4x4x4_16b_bf16 v[140:143], v[232:233], v[38:39], v[244:247]
    v_add_f32_dpp v248, v248, v248 row_half_mirror row_mask:0xf bank_mask:0xf
    v_mfma_f32_4x4x4_16b_bf16 v[240:243], v[68:69], v[68:69], v[240:243]
    v_cvt_pk_bf16_f32 v32, v128, v129
    buffer_load_dwordx4 v165, s[28:31], s56 offen offset:1024 lds
    v_cvt_pk_bf16_f32 v33, v130, v131
    v_mfma_f32_4x4x4_16b_bf16 v[144:147], v[232:233], v[40:41], v[244:247]
    v_mfma_f32_4x4x4_16b_bf16 v[236:239], v[222:223], v[70:71], v[236:239]
    v_fma_f32 v248, v248, v221, -v249
    v_mfma_f32_4x4x4_16b_bf16 v[240:243], v[70:71], v[70:71], v[240:243]
    v_cvt_pk_bf16_f32 v34, v132, v133
    s_waitcnt vmcnt(15)
    v_mfma_f32_4x4x4_16b_bf16 v[236:239], v[222:223], v[72:73], v[236:239]
    v_cvt_pk_bf16_f32 v35, v134, v135
L_stub0:
    s_cbranch_execz L_tourret
    s_nop 0
    ds_write_b128 v224, v[32:35] offset:0
    v_mfma_f32_4x4x4_16b_bf16 v[240:243], v[72:73], v[72:73], v[240:243]
    v_mfma_f32_4x4x4_16b_bf16 v[148:151], v[232:233], v[42:43], v[244:247]
    s_add_u32 m0, s59, 8192
    s_nop 0
    buffer_load_dwordx4 v164, s[28:31], s57 offen offset:0 lds
    v_readlane_b32 s56, v177, 2
    v_max_f32 v248, 0, v248
    v_cvt_pk_bf16_f32 v36, v136, v137
    v_mfma_f32_4x4x4_16b_bf16 v[236:239], v[222:223], v[74:75], v[236:239]
    v_cvt_pk_bf16_f32 v37, v138, v139
    v_mfma_f32_4x4x4_16b_bf16 v[240:243], v[74:75], v[74:75], v[240:243]
    v_mfma_f32_4x4x4_16b_bf16 v[152:155], v[232:233], v[44:45], v[244:247]
    v_add_f32 v187, 0x3727c5ac, v248
    s_waitcnt vmcnt(15)
    v_mfma_f32_4x4x4_16b_bf16 v[236:239], v[222:223], v[76:77], v[236:239]
    v_cvt_pk_bf16_f32 v38, v140, v141
    v_mfma_f32_4x4x4_16b_bf16 v[240:243], v[76:77], v[76:77], v[240:243]
    v_cvt_pk_bf16_f32 v39, v142, v143
    ds_write_b128 v224, v[36:39] offset:16384
    buffer_load_dwordx4 v165, s[28:31], s57 offen offset:1024 lds
    s_add_u32 m0, s59, 16384
    s_nop 0
    buffer_load_dwordx4 v164, s[28:31], s56 offen offset:0 lds
    v_readlane_b32 s57, v177, 3
    v_mfma_f32_4x4x4_16b_bf16 v[236:239], v[222:223], v[78:79], v[236:239]
    v_mfma_f32_4x4x4_16b_bf16 v[156:159], v[232:233], v[46:47], v[244:247]
    v_mfma_f32_4x4x4_16b_bf16 v[240:243], v[78:79], v[78:79], v[240:243]
    v_rsq_f32 v248, v187
    v_cvt_pk_bf16_f32 v40, v144, v145
    s_waitcnt vmcnt(16)
    v_mfma_f32_4x4x4_16b_bf16 v[236:239], v[222:223], v[80:81], v[236:239]
    v_cvt_pk_bf16_f32 v41, v146, v147
    v_mfma_f32_4x4x4_16b_bf16 v[240:243], v[80:81], v[80:81], v[240:243]
    v_mfma_f32_4x4x4_16b_bf16 v[128:131], v[232:233], v[48:49], v[244:247]
    v_mul_f32 v186, s88, v248
    buffer_load_dwordx4 v165, s[28:31], s56 offen offset:1024 lds
    v_cvt_pk_bf16_f32 v42, v148, v149
    v_mfma_f32_4x4x4_16b_bf16 v[236:239], v[222:223], v[82:83], v[236:239]
    v_cvt_pk_bf16_f32 v43, v150, v151
    ds_write_b128 v224, v[40:43] offset:32768
    v_mfma_f32_4x4x4_16b_bf16 v[240:243], v[82:83], v[82:83], v[240:243]
    v_mfma_f32_4x4x4_16b_bf16 v[132:135], v[232:233], v[50:51], v[244:247]
    s_waitcnt vmcnt(16)
    v_mfma_f32_4x4x4_16b_bf16 v[236:239], v[222:223], v[84:85], v[236:239]
    v_cvt_pk_bf16_f32 v44, v152, v153
    v_cvt_pk_bf16_f32 v45, v154, v155
    v_mfma_f32_4x4x4_16b_bf16 v[240:243], v[84:85], v[84:85], v[240:243]
    v_mfma_f32_4x4x4_16b_bf16 v[136:139], v[232:233], v[52:53], v[244:247]
    s_add_u32 m0, s59, 24576
    s_nop 0
    buffer_load_dwordx4 v164, s[28:31], s57 offen offset:0 lds
    v_readlane_b32 s56, v177, 4
    v_cvt_pk_bf16_f32 v46, v156, v157
    v_cvt_pk_bf16_f32 v47, v158, v159
    v_mfma_f32_4x4x4_16b_bf16 v[236:239], v[222:223], v[86:87], v[236:239]
    ds_write_b128 v224, v[44:47] offset:49152
    v_mfma_f32_4x4x4_16b_bf16 v[240:243], v[86:87], v[86:87], v[240:243]
    buffer_load_dwordx4 v165, s[28:31], s57 offen offset:1024 lds
    s_waitcnt vmcnt(17)
    v_mfma_f32_4x4x4_16b_bf16 v[236:239], v[222:223], v[88:89], v[236:239]
    v_mfma_f32_4x4x4_16b_bf16 v[140:143], v[232:233], v[54:55], v[244:247]
    v_cvt_pk_bf16_f32 v48, v128, v129
    v_mfma_f32_4x4x4_16b_bf16 v[240:243], v[88:89], v[88:89], v[240:243]
    v_cvt_pk_bf16_f32 v49, v130, v131
    buffer_load_dword a254, v214, s[36:39], s82 offen
    v_mfma_f32_4x4x4_16b_bf16 v[144:147], v[232:233], v[56:57], v[244:247]
    v_cvt_pk_bf16_f32 v50, v132, v133
    v_mfma_f32_4x4x4_16b_bf16 v[236:239], v[222:223], v[90:91], v[236:239]
    v_cvt_pk_bf16_f32 v51, v134, v135
    v_mfma_f32_4x4x4_16b_bf16 v[240:243], v[90:91], v[90:91], v[240:243]
    ds_write_b128 v225, v[48:51] offset:0
    v_mfma_f32_4x4x4_16b_bf16 v[148:151], v[232:233], v[58:59], v[244:247]
    s_waitcnt vmcnt(17)
    v_mfma_f32_4x4x4_16b_bf16 v[236:239], v[222:223], v[92:93], v[236:239]
    v_cvt_pk_bf16_f32 v52, v136, v137
    v_mfma_f32_4x4x4_16b_bf16 v[240:243], v[92:93], v[92:93], v[240:243]
    v_cvt_pk_bf16_f32 v53, v138, v139
    v_mfma_f32_4x4x4_16b_bf16 v[152:155], v[232:233], v[60:61], v[244:247]
    buffer_load_dword a253, v215, s[40:43], s83 offen
    v_cvt_pk_bf16_f32 v54, v140, v141
    v_mfma_f32_4x4x4_16b_bf16 v[236:239], v[222:223], v[94:95], v[236:239]
    v_cvt_pk_bf16_f32 v55, v142, v143
    v_mfma_f32_4x4x4_16b_bf16 v[240:243], v[94:95], v[94:95], v[240:243]
    ds_write_b128 v225, v[52:55] offset:16384
    s_nop 1
    v_add_f32_dpp v236, v236, v236 quad_perm:[1,0,3,2] row_mask:0xf bank_mask:0xf
    v_mfma_f32_4x4x4_16b_bf16 v[156:159], v[232:233], v[62:63], v[244:247]
    v_cndmask_b32 v240, v240, v241, s[18:19]
    v_cvt_pk_bf16_f32 v56, v144, v145
    v_cvt_pk_bf16_f32 v57, v146, v147
    v_add_f32_dpp v236, v236, v236 quad_perm:[2,3,0,1] row_mask:0xf bank_mask:0xf
    v_cvt_pk_bf16_f32 v58, v148, v149
    v_cndmask_b32 v240, v240, v242, s[20:21]
    v_cvt_pk_bf16_f32 v59, v150, v151
    ds_write_b128 v225, v[56:59] offset:32768
    v_cndmask_b32 v240, v240, v243, s[22:23]
    v_cvt_pk_bf16_f32 v60, v152, v153
    v_add_f32_dpp v237, v236, v236 row_half_mirror row_mask:0xf bank_mask:0xf
    v_cvt_pk_bf16_f32 v61, v154, v155
    v_cvt_pk_bf16_f32 v62, v156, v157
    v_add_f32_dpp v238, v236, v236 row_half_mirror row_mask:0xf bank_mask:0xf
    v_cvt_pk_bf16_f32 v63, v158, v159
    v_add_f32_dpp v239, v236, v236 row_half_mirror row_mask:0xf bank_mask:0xf
    ds_write_b128 v225, v[60:63] offset:49152
    v_add_f32_dpp v236, v236, v236 row_half_mirror row_mask:0xf bank_mask:0xf
    v_xor_b32 v224, 1152, v224
    v_xor_b32 v225, 1152, v225
    s_waitcnt vmcnt(17)
    v_mfma_f32_4x4x4_16b_bf16 v[244:247], v[222:223], v[96:97], 0
    v_mfma_f32_4x4x4_16b_bf16 v[128:131], v[232:233], v[64:65], v[236:239]
    v_mfma_f32_4x4x4_16b_bf16 v[248:251], v[96:97], v[96:97], 0
    v_add_f32_dpp v240, v240, v240 quad_perm:[1,0,3,2] row_mask:0xf bank_mask:0xf
    v_mfma_f32_4x4x4_16b_bf16 v[132:135], v[232:233], v[66:67], v[236:239]
    v_mul_f32 v241, v236, v236
    v_mfma_f32_4x4x4_16b_bf16 v[244:247], v[222:223], v[98:99], v[244:247]
    v_mfma_f32_4x4x4_16b_bf16 v[136:139], v[232:233], v[68:69], v[236:239]
    v_add_f32_dpp v240, v240, v240 quad_perm:[2,3,0,1] row_mask:0xf bank_mask:0xf
    v_mfma_f32_4x4x4_16b_bf16 v[248:251], v[98:99], v[98:99], v[248:251]
    s_waitcnt vmcnt(16)
    v_mfma_f32_4x4x4_16b_bf16 v[244:247], v[222:223], v[100:101], v[244:247]
    v_mfma_f32_4x4x4_16b_bf16 v[140:143], v[232:233], v[70:71], v[236:239]
    v_add_f32_dpp v240, v240, v240 row_half_mirror row_mask:0xf bank_mask:0xf
    v_mfma_f32_4x4x4_16b_bf16 v[248:251], v[100:101], v[100:101], v[248:251]
    v_cvt_pk_bf16_f32 v64, v128, v129
    v_cvt_pk_bf16_f32 v65, v130, v131
    v_mfma_f32_4x4x4_16b_bf16 v[144:147], v[232:233], v[72:73], v[236:239]
    v_mfma_f32_4x4x4_16b_bf16 v[244:247], v[222:223], v[102:103], v[244:247]
    v_fma_f32 v240, v240, v221, -v241
    v_mfma_f32_4x4x4_16b_bf16 v[248:251], v[102:103], v[102:103], v[248:251]
    v_cvt_pk_bf16_f32 v66, v132, v133
    s_waitcnt vmcnt(15)
    v_mfma_f32_4x4x4_16b_bf16 v[244:247], v[222:223], v[104:105], v[244:247]
    v_cvt_pk_bf16_f32 v67, v134, v135
    ds_write_b128 v224, v[64:67] offset:0
    v_mfma_f32_4x4x4_16b_bf16 v[248:251], v[104:105], v[104:105], v[248:251]
    v_mfma_f32_4x4x4_16b_bf16 v[148:151], v[232:233], v[74:75], v[236:239]
    v_max_f32 v240, 0, v240
    v_cvt_pk_bf16_f32 v68, v136, v137
    v_mfma_f32_4x4x4_16b_bf16 v[244:247], v[222:223], v[106:107], v[244:247]
    v_cvt_pk_bf16_f32 v69, v138, v139
    v_mfma_f32_4x4x4_16b_bf16 v[248:251], v[106:107], v[106:107], v[248:251]
    v_mfma_f32_4x4x4_16b_bf16 v[152:155], v[232:233], v[76:77], v[236:239]
    v_add_f32 v189, 0x3727c5ac, v240
    s_waitcnt vmcnt(14)
    v_mfma_f32_4x4x4_16b_bf16 v[244:247], v[222:223], v[108:109], v[244:247]
    v_cvt_pk_bf16_f32 v70, v140, v141
    v_mfma_f32_4x4x4_16b_bf16 v[248:251], v[108:109], v[108:109], v[248:251]
    v_cvt_pk_bf16_f32 v71, v142, v143
    ds_write_b128 v224, v[68:71] offset:16384
    v_mfma_f32_4x4x4_16b_bf16 v[244:247], v[222:223], v[110:111], v[244:247]
    v_mfma_f32_4x4x4_16b_bf16 v[156:159], v[232:233], v[78:79], v[236:239]
    v_mfma_f32_4x4x4_16b_bf16 v[248:251], v[110:111], v[110:111], v[248:251]
    v_rsq_f32 v240, v189
    v_cvt_pk_bf16_f32 v72, v144, v145
    s_waitcnt vmcnt(13)
    v_mfma_f32_4x4x4_16b_bf16 v[244:247], v[222:223], v[112:113], v[244:247]
    v_cvt_pk_bf16_f32 v73, v146, v147
    v_mfma_f32_4x4x4_16b_bf16 v[248:251], v[112:113], v[112:113], v[248:251]
    v_mfma_f32_4x4x4_16b_bf16 v[128:131], v[232:233], v[80:81], v[236:239]
    v_mul_f32 v188, s88, v240
    v_cvt_pk_bf16_f32 v74, v148, v149
    v_mfma_f32_4x4x4_16b_bf16 v[244:247], v[222:223], v[114:115], v[244:247]
    v_cvt_pk_bf16_f32 v75, v150, v151
    ds_write_b128 v224, v[72:75] offset:32768
    v_mfma_f32_4x4x4_16b_bf16 v[248:251], v[114:115], v[114:115], v[248:251]
    v_mfma_f32_4x4x4_16b_bf16 v[132:135], v[232:233], v[82:83], v[236:239]
    s_waitcnt vmcnt(12)
    v_mfma_f32_4x4x4_16b_bf16 v[244:247], v[222:223], v[116:117], v[244:247]
    v_cvt_pk_bf16_f32 v76, v152, v153
    v_cvt_pk_bf16_f32 v77, v154, v155
    v_mfma_f32_4x4x4_16b_bf16 v[248:251], v[116:117], v[116:117], v[248:251]
    v_mfma_f32_4x4x4_16b_bf16 v[136:139], v[232:233], v[84:85], v[236:239]
    v_cvt_pk_bf16_f32 v78, v156, v157
    v_cvt_pk_bf16_f32 v79, v158, v159
    v_mfma_f32_4x4x4_16b_bf16 v[244:247], v[222:223], v[118:119], v[244:247]
    ds_write_b128 v224, v[76:79] offset:49152
    v_mfma_f32_4x4x4_16b_bf16 v[248:251], v[118:119], v[118:119], v[248:251]
    s_waitcnt vmcnt(11)
    v_mfma_f32_4x4x4_16b_bf16 v[244:247], v[222:223], v[120:121], v[244:247]
    v_mfma_f32_4x4x4_16b_bf16 v[140:143], v[232:233], v[86:87], v[236:239]
    v_cvt_pk_bf16_f32 v80, v128, v129
    v_mfma_f32_4x4x4_16b_bf16 v[248:251], v[120:121], v[120:121], v[248:251]
    v_cvt_pk_bf16_f32 v81, v130, v131
    v_mfma_f32_4x4x4_16b_bf16 v[144:147], v[232:233], v[88:89], v[236:239]
    v_cvt_pk_bf16_f32 v82, v132, v133
    v_mfma_f32_4x4x4_16b_bf16 v[244:247], v[222:223], v[122:123], v[244:247]
    v_cvt_pk_bf16_f32 v83, v134, v135
    v_mfma_f32_4x4x4_16b_bf16 v[248:251], v[122:123], v[122:123], v[248:251]
    ds_write_b128 v225, v[80:83] offset:0
    v_mfma_f32_4x4x4_16b_bf16 v[148:151], v[232:233], v[90:91], v[236:239]
    s_waitcnt vmcnt(10)
    v_mfma_f32_4x4x4_16b_bf16 v[244:247], v[222:223], v[124:125], v[244:247]
    v_cvt_pk_bf16_f32 v84, v136, v137
    v_mfma_f32_4x4x4_16b_bf16 v[248:251], v[124:125], v[124:125], v[248:251]
    v_cvt_pk_bf16_f32 v85, v138, v139
    v_mfma_f32_4x4x4_16b_bf16 v[152:155], v[232:233], v[92:93], v[236:239]
    v_cvt_pk_bf16_f32 v86, v140, v141
    v_mfma_f32_4x4x4_16b_bf16 v[244:247], v[222:223], v[126:127], v[244:247]
    v_cvt_pk_bf16_f32 v87, v142, v143
    v_mfma_f32_4x4x4_16b_bf16 v[248:251], v[126:127], v[126:127], v[248:251]
    ds_write_b128 v225, v[84:87] offset:16384
    s_nop 1
    v_add_f32_dpp v244, v244, v244 quad_perm:[1,0,3,2] row_mask:0xf bank_mask:0xf
    v_mfma_f32_4x4x4_16b_bf16 v[156:159], v[232:233], v[94:95], v[236:239]
    v_cndmask_b32 v248, v248, v249, s[18:19]
    v_cvt_pk_bf16_f32 v88, v144, v145
    v_cvt_pk_bf16_f32 v89, v146, v147
    v_add_f32_dpp v244, v244, v244 quad_perm:[2,3,0,1] row_mask:0xf bank_mask:0xf
    v_cvt_pk_bf16_f32 v90, v148, v149
    v_cndmask_b32 v248, v248, v250, s[20:21]
    v_cvt_pk_bf16_f32 v91, v150, v151
    ds_write_b128 v225, v[88:91] offset:32768
    v_cndmask_b32 v248, v248, v251, s[22:23]
    v_cvt_pk_bf16_f32 v92, v152, v153
    v_add_f32_dpp v245, v244, v244 row_half_mirror row_mask:0xf bank_mask:0xf
    v_cvt_pk_bf16_f32 v93, v154, v155
    v_cvt_pk_bf16_f32 v94, v156, v157
    v_add_f32_dpp v246, v244, v244 row_half_mirror row_mask:0xf bank_mask:0xf
    v_cvt_pk_bf16_f32 v95, v158, v159
    v_add_f32_dpp v247, v244, v244 row_half_mirror row_mask:0xf bank_mask:0xf
    ds_write_b128 v225, v[92:95] offset:49152
    v_add_f32_dpp v244, v244, v244 row_half_mirror row_mask:0xf bank_mask:0xf
    v_xor_b32 v224, 128, v224
    v_xor_b32 v225, 128, v225
    v_mfma_f32_4x4x4_16b_bf16 v[128:131], v[232:233], v[96:97], v[244:247]
    v_add_f32_dpp v248, v248, v248 quad_perm:[1,0,3,2] row_mask:0xf bank_mask:0xf
    v_mfma_f32_4x4x4_16b_bf16 v[132:135], v[232:233], v[98:99], v[244:247]
    v_mul_f32 v249, v244, v244
    v_mfma_f32_4x4x4_16b_bf16 v[136:139], v[232:233], v[100:101], v[244:247]
    v_add_f32_dpp v248, v248, v248 quad_perm:[2,3,0,1] row_mask:0xf bank_mask:0xf
    v_mfma_f32_4x4x4_16b_bf16 v[140:143], v[232:233], v[102:103], v[244:247]
    s_nop 0
    v_add_f32_dpp v248, v248, v248 row_half_mirror row_mask:0xf bank_mask:0xf
    v_cvt_pk_bf16_f32 v96, v128, v129
    v_cvt_pk_bf16_f32 v97, v130, v131
    v_mfma_f32_4x4x4_16b_bf16 v[144:147], v[232:233], v[104:105], v[244:247]
    v_fma_f32 v248, v248, v221, -v249
    v_cvt_pk_bf16_f32 v98, v132, v133
    v_cvt_pk_bf16_f32 v99, v134, v135
    ds_write_b128 v224, v[96:99] offset:0
    v_mfma_f32_4x4x4_16b_bf16 v[148:151], v[232:233], v[106:107], v[244:247]
    v_max_f32 v248, 0, v248
    v_cvt_pk_bf16_f32 v100, v136, v137
    v_cvt_pk_bf16_f32 v101, v138, v139
    v_mfma_f32_4x4x4_16b_bf16 v[152:155], v[232:233], v[108:109], v[244:247]
    v_add_f32 v191, 0x3727c5ac, v248
    v_cvt_pk_bf16_f32 v102, v140, v141
    v_cvt_pk_bf16_f32 v103, v142, v143
    ds_write_b128 v224, v[100:103] offset:16384
    v_mfma_f32_4x4x4_16b_bf16 v[156:159], v[232:233], v[110:111], v[244:247]
    v_rsq_f32 v248, v191
    v_cvt_pk_bf16_f32 v104, v144, v145
    v_cvt_pk_bf16_f32 v105, v146, v147
    v_mfma_f32_4x4x4_16b_bf16 v[128:131], v[232:233], v[112:113], v[244:247]
    v_mul_f32 v190, s88, v248
    v_cvt_pk_bf16_f32 v106, v148, v149
    v_cvt_pk_bf16_f32 v107, v150, v151
    ds_write_b128 v224, v[104:107] offset:32768
    v_mfma_f32_4x4x4_16b_bf16 v[132:135], v[232:233], v[114:115], v[244:247]
    v_cvt_pk_bf16_f32 v108, v152, v153
    v_cvt_pk_bf16_f32 v109, v154, v155
    v_mfma_f32_4x4x4_16b_bf16 v[136:139], v[232:233], v[116:117], v[244:247]
    v_cvt_pk_bf16_f32 v110, v156, v157
    v_cvt_pk_bf16_f32 v111, v158, v159
    ds_write_b128 v224, v[108:111] offset:49152
    v_mfma_f32_4x4x4_16b_bf16 v[140:143], v[232:233], v[118:119], v[244:247]
    v_cvt_pk_bf16_f32 v112, v128, v129
    v_cvt_pk_bf16_f32 v113, v130, v131
    v_mfma_f32_4x4x4_16b_bf16 v[144:147], v[232:233], v[120:121], v[244:247]
    v_cvt_pk_bf16_f32 v114, v132, v133
    v_cvt_pk_bf16_f32 v115, v134, v135
    ds_write_b128 v225, v[112:115] offset:0
    v_mfma_f32_4x4x4_16b_bf16 v[148:151], v[232:233], v[122:123], v[244:247]
    v_cvt_pk_bf16_f32 v116, v136, v137
    v_cvt_pk_bf16_f32 v117, v138, v139
    v_mfma_f32_4x4x4_16b_bf16 v[152:155], v[232:233], v[124:125], v[244:247]
    v_cvt_pk_bf16_f32 v118, v140, v141
    v_cvt_pk_bf16_f32 v119, v142, v143
    ds_write_b128 v225, v[116:119] offset:16384
    v_mfma_f32_4x4x4_16b_bf16 v[156:159], v[232:233], v[126:127], v[244:247]
    v_cvt_pk_bf16_f32 v120, v144, v145
    v_cvt_pk_bf16_f32 v121, v146, v147
    v_cvt_pk_bf16_f32 v122, v148, v149
    v_cvt_pk_bf16_f32 v123, v150, v151
    ds_write_b128 v225, v[120:123] offset:32768
    v_cvt_pk_bf16_f32 v124, v152, v153
    v_cvt_pk_bf16_f32 v125, v154, v155
    v_cvt_pk_bf16_f32 v126, v156, v157
    v_cvt_pk_bf16_f32 v127, v158, v159
    ds_write_b128 v225, v[124:127] offset:49152
    s_waitcnt vmcnt(8) lgkmcnt(0)
    s_barrier
    ds_read_b128 a[0:3], v172 offset:0
    ds_read_b128 a[4:7], v172 offset:1024
    ds_read_b128 a[8:11], v172 offset:2048
    ds_read_b128 a[12:15], v172 offset:3072
    ds_read_b64_tr_b16 v[128:129], v161 offset:0
    ds_read_b64_tr_b16 v[130:131], v161 offset:512
    ds_read_b64_tr_b16 v[132:133], v162 offset:0
    ds_read_b64_tr_b16 v[134:135], v162 offset:512
    ds_read_b64_tr_b16 v[136:137], v161 offset:4096
    ds_read_b64_tr_b16 v[138:139], v161 offset:4608
    ds_read_b64_tr_b16 v[140:141], v162 offset:4096
    ds_read_b64_tr_b16 v[142:143], v162 offset:4608
    ds_read_b128 a[16:19], v173 offset:8192
    ds_read_b128 a[20:23], v173 offset:9216
    ds_read_b128 a[24:27], v173 offset:10240
    ds_read_b128 a[28:31], v173 offset:11264
    v_readlane_b32 s75, v213, 19
    v_readlane_b32 s76, v213, 20
    v_readlane_b32 s77, v213, 21
    v_readlane_b32 s78, v213, 22
    v_readlane_b32 s79, v213, 23
    v_readlane_b32 s80, v213, 24
    v_readlane_b32 s81, v213, 25
    buffer_store_dword v169, v169, s[48:51], s85 offen sc1
    s_cmp_ge_u32 s7, 2
    s_cbranch_scc1 L_typeB
    s_waitcnt vmcnt(7) lgkmcnt(0)
    s_barrier
    v_mfma_f32_16x16x32_bf16 v[0:3], v[128:131], a[0:3], 0
    ds_read_b128 a[32:35], v172 offset:16384
    v_mfma_f32_16x16x32_bf16 v[4:7], v[128:131], a[4:7], 0
    ds_read_b128 a[36:39], v172 offset:17408
    s_add_u32 m0, s59, 32768
    v_mfma_f32_16x16x32_bf16 v[8:11], v[128:131], a[8:11], 0
    ds_read_b128 a[40:43], v172 offset:18432
    buffer_load_dwordx4 v164, s[28:31], s56 offen offset:0 lds
    v_readlane_b32 s57, v177, 5
    v_mfma_f32_16x16x32_bf16 v[12:15], v[128:131], a[12:15], 0
    ds_read_b128 a[44:47], v172 offset:19456
    v_mfma_f32_16x16x32_bf16 v[28:31], v[132:135], a[12:15], 0
    ds_read_b64_tr_b16 v[144:145], v161 offset:8192
    v_mfma_f32_16x16x32_bf16 v[24:27], v[132:135], a[8:11], 0
    ds_read_b64_tr_b16 v[146:147], v161 offset:8704
    v_mfma_f32_16x16x32_bf16 v[20:23], v[132:135], a[4:7], 0
    ds_read_b64_tr_b16 v[148:149], v162 offset:8192
    buffer_load_dwordx4 v165, s[28:31], s56 offen offset:1024 lds
    v_mfma_f32_16x16x32_bf16 v[16:19], v[132:135], a[0:3], 0
    ds_read_b64_tr_b16 v[150:151], v162 offset:8704
    v_mfma_f32_16x16x32_bf16 v[32:35], v[136:139], a[0:3], 0
    ds_read_b64_tr_b16 v[152:153], v161 offset:12288
    s_add_u32 m0, s59, 40960
    v_mfma_f32_16x16x32_bf16 v[36:39], v[136:139], a[4:7], 0
    ds_read_b64_tr_b16 v[154:155], v161 offset:12800
    buffer_load_dwordx4 v164, s[28:31], s57 offen offset:0 lds
    v_readlane_b32 s56, v177, 6
    v_mfma_f32_16x16x32_bf16 v[40:43], v[136:139], a[8:11], 0
    ds_read_b64_tr_b16 v[156:157], v162 offset:12288
    v_mfma_f32_16x16x32_bf16 v[44:47], v[136:139], a[12:15], 0
    ds_read_b64_tr_b16 v[158:159], v162 offset:12800
    v_mfma_f32_16x16x32_bf16 v[60:63], v[140:143], a[12:15], 0
    v_mfma_f32_16x16x32_bf16 v[56:59], v[140:143], a[8:11], 0
    buffer_load_dwordx4 v165, s[28:31], s57 offen offset:1024 lds
    v_mfma_f32_16x16x32_bf16 v[52:55], v[140:143], a[4:7], 0
    s_waitcnt vmcnt(9) lgkmcnt(0)
    v_mfma_f32_16x16x32_bf16 v[48:51], v[140:143], a[0:3], 0
    s_barrier
    v_mfma_f32_16x16x32_bf16 v[0:3], v[144:147], a[16:19], v[0:3]
    ds_read_b128 a[48:51], v173 offset:24576
    v_mfma_f32_16x16x32_bf16 v[4:7], v[144:147], a[20:23], v[4:7]
    ds_read_b128 a[52:55], v173 offset:25600
    s_add_u32 m0, s59, 0
    v_mfma_f32_16x16x32_bf16 v[8:11], v[144:147], a[24:27], v[8:11]
    ds_read_b128 a[56:59], v173 offset:26624
    buffer_load_dwordx4 v164, s[28:31], s56 offen offset:0 lds
    v_readlane_b32 s57, v177, 7
    v_mfma_f32_16x16x32_bf16 v[12:15], v[144:147], a[28:31], v[12:15]
    ds_read_b128 a[60:63], v173 offset:27648
    v_mfma_f32_16x16x32_bf16 v[28:31], v[148:151], a[28:31], v[28:31]
    ds_read_b64_tr_b16 v[128:129], v161 offset:16384
    v_mfma_f32_16x16x32_bf16 v[24:27], v[148:151], a[24:27], v[24:27]
    ds_read_b64_tr_b16 v[130:131], v161 offset:16896
    v_mfma_f32_16x16x32_bf16 v[20:23], v[148:151], a[20:23], v[20:23]
    ds_read_b64_tr_b16 v[132:133], v162 offset:16384
    buffer_load_dwordx4 v165, s[28:31], s56 offen offset:1024 lds
    v_mfma_f32_16x16x32_bf16 v[16:19], v[148:151], a[16:19], v[16:19]
    ds_read_b64_tr_b16 v[134:135], v162 offset:16896
    v_mfma_f32_16x16x32_bf16 v[32:35], v[152:155], a[16:19], v[32:35]
    ds_read_b64_tr_b16 v[136:137], v161 offset:20480
    s_add_u32 m0, s59, 8192
    v_mfma_f32_16x16x32_bf16 v[36:39], v[152:155], a[20:23], v[36:39]
    ds_read_b64_tr_b16 v[138:139], v161 offset:20992
    buffer_load_dwordx4 v164, s[28:31], s57 offen offset:0 lds
    v_readlane_b32 s56, v177, 8
    v_mfma_f32_16x16x32_bf16 v[40:43], v[152:155], a[24:27], v[40:43]
    ds_read_b64_tr_b16 v[140:141], v162 offset:20480
    v_mfma_f32_16x16x32_bf16 v[44:47], v[152:155], a[28:31], v[44:47]
    ds_read_b64_tr_b16 v[142:143], v162 offset:20992
    v_mfma_f32_16x16x32_bf16 v[60:63], v[156:159], a[28:31], v[60:63]
    v_mfma_f32_16x16x32_bf16 v[56:59], v[156:159], a[24:27], v[56:59]
    buffer_load_dwordx4 v165, s[28:31], s57 offen offset:1024 lds
    v_mfma_f32_16x16x32_bf16 v[52:55], v[156:159], a[20:23], v[52:55]
    s_waitcnt vmcnt(11) lgkmcnt(0)
    v_mfma_f32_16x16x32_bf16 v[48:51], v[156:159], a[16:19], v[48:51]
    s_barrier
    v_mfma_f32_16x16x32_bf16 v[0:3], v[128:131], a[32:35], v[0:3]
    ds_read_b128 a[64:67], v172 offset:32768
    v_mfma_f32_16x16x32_bf16 v[4:7], v[128:131], a[36:39], v[4:7]
    ds_read_b128 a[68:71], v172 offset:33792
    s_add_u32 m0, s59, 16384
    v_mfma_f32_16x16x32_bf16 v[8:11], v[128:131], a[40:43], v[8:11]
    ds_read_b128 a[72:75], v172 offset:34816
    buffer_load_dwordx4 v164, s[28:31], s56 offen offset:0 lds
    v_readlane_b32 s57, v177, 9
    v_mfma_f32_16x16x32_bf16 v[12:15], v[128:131], a[44:47], v[12:15]
    ds_read_b128 a[76:79], v172 offset:35840
    v_mfma_f32_16x16x32_bf16 v[28:31], v[132:135], a[44:47], v[28:31]
    ds_read_b64_tr_b16 v[144:145], v161 offset:24576
    v_mfma_f32_16x16x32_bf16 v[24:27], v[132:135], a[40:43], v[24:27]
    ds_read_b64_tr_b16 v[146:147], v161 offset:25088
    v_mfma_f32_16x16x32_bf16 v[20:23], v[132:135], a[36:39], v[20:23]
    ds_read_b64_tr_b16 v[148:149], v162 offset:24576
    buffer_load_dwordx4 v165, s[28:31], s56 offen offset:1024 lds
    v_mfma_f32_16x16x32_bf16 v[16:19], v[132:135], a[32:35], v[16:19]
    ds_read_b64_tr_b16 v[150:151], v162 offset:25088
    v_mfma_f32_16x16x32_bf16 v[32:35], v[136:139], a[32:35], v[32:35]
    ds_read_b64_tr_b16 v[152:153], v161 offset:28672
    s_add_u32 m0, s78, 49152
    s_add_u32 s9, s74, 0
    v_mfma_f32_16x16x32_bf16 v[36:39], v[136:139], a[36:39], v[36:39]
    ds_read_b64_tr_b16 v[154:155], v161 offset:29184
    buffer_load_dwordx4 v168, s[36:39], s9 offen lds
    v_mfma_f32_16x16x32_bf16 v[40:43], v[136:139], a[40:43], v[40:43]
    ds_read_b64_tr_b16 v[156:157], v162 offset:28672
    v_mfma_f32_16x16x32_bf16 v[44:47], v[136:139], a[44:47], v[44:47]
    ds_read_b64_tr_b16 v[158:159], v162 offset:29184
    v_mfma_f32_16x16x32_bf16 v[60:63], v[140:143], a[44:47], v[60:63]
    s_add_u32 m0, s79, 49152
    s_add_u32 s9, s75, 0
    v_mfma_f32_16x16x32_bf16 v[56:59], v[140:143], a[40:43], v[56:59]
    buffer_load_dwordx4 v168, s[36:39], s9 offen lds
    v_mfma_f32_16x16x32_bf16 v[52:55], v[140:143], a[36:39], v[52:55]
    s_waitcnt vmcnt(10) lgkmcnt(0)
    v_mfma_f32_16x16x32_bf16 v[48:51], v[140:143], a[32:35], v[48:51]
    s_barrier
    v_mfma_f32_16x16x32_bf16 v[0:3], v[144:147], a[48:51], v[0:3]
    ds_read_b128 a[80:83], v173 offset:40960
    v_mfma_f32_16x16x32_bf16 v[4:7], v[144:147], a[52:55], v[4:7]
    ds_read_b128 a[84:87], v173 offset:41984
    s_add_u32 m0, s59, 24576
    v_mfma_f32_16x16x32_bf16 v[8:11], v[144:147], a[56:59], v[8:11]
    ds_read_b128 a[88:91], v173 offset:43008
    buffer_load_dwordx4 v164, s[28:31], s57 offen offset:0 lds
    v_readlane_b32 s56, v177, 10
    v_mfma_f32_16x16x32_bf16 v[12:15], v[144:147], a[60:63], v[12:15]
    ds_read_b128 a[92:95], v173 offset:44032
    v_mfma_f32_16x16x32_bf16 v[28:31], v[148:151], a[60:63], v[28:31]
    ds_read_b64_tr_b16 v[128:129], v161 offset:32768
    v_mfma_f32_16x16x32_bf16 v[24:27], v[148:151], a[56:59], v[24:27]
    ds_read_b64_tr_b16 v[130:131], v161 offset:33280
    v_mfma_f32_16x16x32_bf16 v[20:23], v[148:151], a[52:55], v[20:23]
    ds_read_b64_tr_b16 v[132:133], v162 offset:32768
    buffer_load_dwordx4 v165, s[28:31], s57 offen offset:1024 lds
    v_mfma_f32_16x16x32_bf16 v[16:19], v[148:151], a[48:51], v[16:19]
    ds_read_b64_tr_b16 v[134:135], v162 offset:33280
    v_mfma_f32_16x16x32_bf16 v[32:35], v[152:155], a[48:51], v[32:35]
    ds_read_b64_tr_b16 v[136:137], v161 offset:36864
    s_add_u32 m0, s80, 49152
    s_add_u32 s9, s76, 0
    v_mfma_f32_16x16x32_bf16 v[36:39], v[152:155], a[52:55], v[36:39]
    ds_read_b64_tr_b16 v[138:139], v161 offset:37376
    buffer_load_dwordx4 v168, s[36:39], s9 offen lds
    v_mfma_f32_16x16x32_bf16 v[40:43], v[152:155], a[56:59], v[40:43]
    ds_read_b64_tr_b16 v[140:141], v162 offset:36864
    v_mfma_f32_16x16x32_bf16 v[44:47], v[152:155], a[60:63], v[44:47]
    ds_read_b64_tr_b16 v[142:143], v162 offset:37376
    v_mfma_f32_16x16x32_bf16 v[60:63], v[156:159], a[60:63], v[60:63]
    s_add_u32 m0, s81, 49152
    s_add_u32 s9, s77, 0
    v_mfma_f32_16x16x32_bf16 v[56:59], v[156:159], a[56:59], v[56:59]
    buffer_load_dwordx4 v168, s[36:39], s9 offen lds
    v_mfma_f32_16x16x32_bf16 v[52:55], v[156:159], a[52:55], v[52:55]
    s_waitcnt vmcnt(12) lgkmcnt(0)
    v_mfma_f32_16x16x32_bf16 v[48:51], v[156:159], a[48:51], v[48:51]
    s_barrier
    v_mfma_f32_16x16x32_bf16 v[0:3], v[128:131], a[64:67], v[0:3]
    ds_read_b128 a[96:99], v172 offset:49152
    v_mfma_f32_16x16x32_bf16 v[4:7], v[128:131], a[68:71], v[4:7]
    ds_read_b128 a[100:103], v172 offset:50176
    s_add_u32 m0, s59, 32768
    v_mfma_f32_16x16x32_bf16 v[8:11], v[128:131], a[72:75], v[8:11]
    ds_read_b128 a[104:107], v172 offset:51200
    buffer_load_dwordx4 v164, s[28:31], s56 offen offset:0 lds
    v_readlane_b32 s57, v177, 11
    v_mfma_f32_16x16x32_bf16 v[12:15], v[128:131], a[76:79], v[12:15]
    ds_read_b128 a[108:111], v172 offset:52224
    v_mfma_f32_16x16x32_bf16 v[28:31], v[132:135], a[76:79], v[28:31]
    ds_read_b64_tr_b16 v[144:145], v161 offset:40960
    v_mfma_f32_16x16x32_bf16 v[24:27], v[132:135], a[72:75], v[24:27]
    ds_read_b64_tr_b16 v[146:147], v161 offset:41472
    v_mfma_f32_16x16x32_bf16 v[20:23], v[132:135], a[68:71], v[20:23]
    ds_read_b64_tr_b16 v[148:149], v162 offset:40960
    buffer_load_dwordx4 v165, s[28:31], s56 offen offset:1024 lds
    v_mfma_f32_16x16x32_bf16 v[16:19], v[132:135], a[64:67], v[16:19]
    ds_read_b64_tr_b16 v[150:151], v162 offset:41472
    v_mfma_f32_16x16x32_bf16 v[32:35], v[136:139], a[64:67], v[32:35]
    ds_read_b64_tr_b16 v[152:153], v161 offset:45056
    s_add_u32 m0, s78, 65536
    s_add_u32 s9, s74, 32768
    v_mfma_f32_16x16x32_bf16 v[36:39], v[136:139], a[68:71], v[36:39]
    ds_read_b64_tr_b16 v[154:155], v161 offset:45568
    buffer_load_dwordx4 v168, s[36:39], s9 offen lds
    v_mfma_f32_16x16x32_bf16 v[40:43], v[136:139], a[72:75], v[40:43]
    ds_read_b64_tr_b16 v[156:157], v162 offset:45056
    v_mfma_f32_16x16x32_bf16 v[44:47], v[136:139], a[76:79], v[44:47]
    ds_read_b64_tr_b16 v[158:159], v162 offset:45568
    v_mfma_f32_16x16x32_bf16 v[60:63], v[140:143], a[76:79], v[60:63]
    s_add_u32 m0, s79, 65536
    s_add_u32 s9, s75, 32768
    v_mfma_f32_16x16x32_bf16 v[56:59], v[140:143], a[72:75], v[56:59]
    buffer_load_dwordx4 v168, s[36:39], s9 offen lds
    v_mfma_f32_16x16x32_bf16 v[52:55], v[140:143], a[68:71], v[52:55]
    s_waitcnt vmcnt(14) lgkmcnt(0)
    v_mfma_f32_16x16x32_bf16 v[48:51], v[140:143], a[64:67], v[48:51]
    s_barrier
    v_mfma_f32_16x16x32_bf16 v[0:3], v[144:147], a[80:83], v[0:3]
    ds_read_b128 a[112:115], v173 offset:57344
    v_mfma_f32_16x16x32_bf16 v[4:7], v[144:147], a[84:87], v[4:7]
    ds_read_b128 a[116:119], v173 offset:58368
    s_add_u32 m0, s59, 40960
    v_mfma_f32_16x16x32_bf16 v[8:11], v[144:147], a[88:91], v[8:11]
    ds_read_b128 a[120:123], v173 offset:59392
    buffer_load_dwordx4 v164, s[28:31], s57 offen offset:0 lds
    v_readlane_b32 s56, v177, 12
    v_mfma_f32_16x16x32_bf16 v[12:15], v[144:147], a[92:95], v[12:15]
    ds_read_b128 a[124:127], v173 offset:60416
    v_mfma_f32_16x16x32_bf16 v[28:31], v[148:151], a[92:95], v[28:31]
    ds_read_b64_tr_b16 v[128:129], v161 offset:0
    v_mfma_f32_16x16x32_bf16 v[24:27], v[148:151], a[88:91], v[24:27]
    ds_read_b64_tr_b16 v[130:131], v161 offset:512
    v_mfma_f32_16x16x32_bf16 v[20:23], v[148:151], a[84:87], v[20:23]
    ds_read_b64_tr_b16 v[132:133], v162 offset:0
    buffer_load_dwordx4 v165, s[28:31], s57 offen offset:1024 lds
    v_mfma_f32_16x16x32_bf16 v[16:19], v[148:151], a[80:83], v[16:19]
    ds_read_b64_tr_b16 v[134:135], v162 offset:512
L_stub1:
    s_cbranch_execz L_stub5
    s_nop 0
    v_mfma_f32_16x16x32_bf16 v[32:35], v[152:155], a[80:83], v[32:35]
    ds_read_b64_tr_b16 v[136:137], v161 offset:4096
    s_add_u32 m0, s80, 65536
    s_add_u32 s9, s76, 32768
    v_mfma_f32_16x16x32_bf16 v[36:39], v[152:155], a[84:87], v[36:39]
    ds_read_b64_tr_b16 v[138:139], v161 offset:4608
    buffer_load_dwordx4 v168, s[36:39], s9 offen lds
    v_mfma_f32_16x16x32_bf16 v[40:43], v[152:155], a[88:91], v[40:43]
    ds_read_b64_tr_b16 v[140:141], v162 offset:4096
    v_mfma_f32_16x16x32_bf16 v[44:47], v[152:155], a[92:95], v[44:47]
    ds_read_b64_tr_b16 v[142:143], v162 offset:4608
    v_mfma_f32_16x16x32_bf16 v[60:63], v[156:159], a[92:95], v[60:63]
    s_add_u32 m0, s81, 65536
    s_add_u32 s9, s77, 32768
    v_mfma_f32_16x16x32_bf16 v[56:59], v[156:159], a[88:91], v[56:59]
    buffer_load_dwordx4 v168, s[36:39], s9 offen lds
    v_mfma_f32_16x16x32_bf16 v[52:55], v[156:159], a[84:87], v[52:55]
    s_waitcnt vmcnt(16) lgkmcnt(0)
    v_mfma_f32_16x16x32_bf16 v[48:51], v[156:159], a[80:83], v[48:51]
    s_barrier
    v_mfma_f32_16x16x32_bf16 v[0:3], v[128:131], a[96:99], v[0:3]
    v_add_u32 v172, 0x10000, v172
    ds_read_b128 a[128:131], v172 offset:0
    v_mfma_f32_16x16x32_bf16 v[4:7], v[128:131], a[100:103], v[4:7]
    ds_read_b128 a[132:135], v172 offset:1024
    s_add_u32 m0, s59, 0
    v_mfma_f32_16x16x32_bf16 v[8:11], v[128:131], a[104:107], v[8:11]
    ds_read_b128 a[136:139], v172 offset:2048
    buffer_load_dwordx4 v164, s[28:31], s56 offen offset:0 lds
    v_readlane_b32 s57, v177, 13
    v_mfma_f32_16x16x32_bf16 v[12:15], v[128:131], a[108:111], v[12:15]
    ds_read_b128 a[140:143], v172 offset:3072
    v_mfma_f32_16x16x32_bf16 v[28:31], v[132:135], a[108:111], v[28:31]
    ds_read_b64_tr_b16 v[144:145], v161 offset:8192
    v_mfma_f32_16x16x32_bf16 v[24:27], v[132:135], a[104:107], v[24:27]
    ds_read_b64_tr_b16 v[146:147], v161 offset:8704
    v_mfma_f32_16x16x32_bf16 v[20:23], v[132:135], a[100:103], v[20:23]
    ds_read_b64_tr_b16 v[148:149], v162 offset:8192
    buffer_load_dwordx4 v165, s[28:31], s56 offen offset:1024 lds
    v_mfma_f32_16x16x32_bf16 v[16:19], v[132:135], a[96:99], v[16:19]
    ds_read_b64_tr_b16 v[150:151], v162 offset:8704
    v_mfma_f32_16x16x32_bf16 v[32:35], v[136:139], a[96:99], v[32:35]
    ds_read_b64_tr_b16 v[152:153], v161 offset:12288
    s_add_u32 m0, s78, 81920
    s_add_u32 s9, s74, 65536
    v_mfma_f32_16x16x32_bf16 v[36:39], v[136:139], a[100:103], v[36:39]
    ds_read_b64_tr_b16 v[154:155], v161 offset:12800
    buffer_load_dwordx4 v168, s[36:39], s9 offen lds
    v_mfma_f32_16x16x32_bf16 v[40:43], v[136:139], a[104:107], v[40:43]
    ds_read_b64_tr_b16 v[156:157], v162 offset:12288
    v_mfma_f32_16x16x32_bf16 v[44:47], v[136:139], a[108:111], v[44:47]
    ds_read_b64_tr_b16 v[158:159], v162 offset:12800
    v_mfma_f32_16x16x32_bf16 v[60:63], v[140:143], a[108:111], v[60:63]
    s_add_u32 m0, s79, 81920
    s_add_u32 s9, s75, 65536
    v_mfma_f32_16x16x32_bf16 v[56:59], v[140:143], a[104:107], v[56:59]
    buffer_load_dwordx4 v168, s[36:39], s9 offen lds
    v_mfma_f32_16x16x32_bf16 v[52:55], v[140:143], a[100:103], v[52:55]
    s_waitcnt vmcnt(18) lgkmcnt(0)
    v_mfma_f32_16x16x32_bf16 v[48:51], v[140:143], a[96:99], v[48:51]
    s_barrier
    v_mfma_f32_16x16x32_bf16 v[0:3], v[144:147], a[112:115], v[0:3]
    v_add_u32 v173, 0x10000, v173
    ds_read_b128 a[144:147], v173 offset:8192
    v_mfma_f32_16x16x32_bf16 v[4:7], v[144:147], a[116:119], v[4:7]
    ds_read_b128 a[148:151], v173 offset:9216
    s_add_u32 m0, s59, 8192
    v_mfma_f32_16x16x32_bf16 v[8:11], v[144:147], a[120:123], v[8:11]
    ds_read_b128 a[152:155], v173 offset:10240
    buffer_load_dwordx4 v164, s[28:31], s57 offen offset:0 lds
    v_readlane_b32 s56, v177, 14
    v_mfma_f32_16x16x32_bf16 v[12:15], v[144:147], a[124:127], v[12:15]
    ds_read_b128 a[156:159], v173 offset:11264
    v_mfma_f32_16x16x32_bf16 v[28:31], v[148:151], a[124:127], v[28:31]
    ds_read_b64_tr_b16 v[128:129], v161 offset:16384
    v_mfma_f32_16x16x32_bf16 v[24:27], v[148:151], a[120:123], v[24:27]
    ds_read_b64_tr_b16 v[130:131], v161 offset:16896
    v_mfma_f32_16x16x32_bf16 v[20:23], v[148:151], a[116:119], v[20:23]
    ds_read_b64_tr_b16 v[132:133], v162 offset:16384
    buffer_load_dwordx4 v165, s[28:31], s57 offen offset:1024 lds
    v_mfma_f32_16x16x32_bf16 v[16:19], v[148:151], a[112:115], v[16:19]
    ds_read_b64_tr_b16 v[134:135], v162 offset:16896
    v_mfma_f32_16x16x32_bf16 v[32:35], v[152:155], a[112:115], v[32:35]
    ds_read_b64_tr_b16 v[136:137], v161 offset:20480
    s_add_u32 m0, s80, 81920
    s_add_u32 s9, s76, 65536
    v_mfma_f32_16x16x32_bf16 v[36:39], v[152:155], a[116:119], v[36:39]
    ds_read_b64_tr_b16 v[138:139], v161 offset:20992
    buffer_load_dwordx4 v168, s[36:39], s9 offen lds
    v_mfma_f32_16x16x32_bf16 v[40:43], v[152:155], a[120:123], v[40:43]
    ds_read_b64_tr_b16 v[140:141], v162 offset:20480
    v_mfma_f32_16x16x32_bf16 v[44:47], v[152:155], a[124:127], v[44:47]
    ds_read_b64_tr_b16 v[142:143], v162 offset:20992
    v_mfma_f32_16x16x32_bf16 v[60:63], v[156:159], a[124:127], v[60:63]
    s_add_u32 m0, s81, 81920
    s_add_u32 s9, s77, 65536
    v_mfma_f32_16x16x32_bf16 v[56:59], v[156:159], a[120:123], v[56:59]
    buffer_load_dwordx4 v168, s[36:39], s9 offen lds
    v_mfma_f32_16x16x32_bf16 v[52:55], v[156:159], a[116:119], v[52:55]
    s_waitcnt vmcnt(18) lgkmcnt(0)
    v_mfma_f32_16x16x32_bf16 v[48:51], v[156:159], a[112:115], v[48:51]
    s_barrier
    v_mfma_f32_16x16x32_bf16 v[0:3], v[128:131], a[128:131], v[0:3]
    ds_read_b128 a[160:163], v172 offset:16384
    v_mfma_f32_16x16x32_bf16 v[4:7], v[128:131], a[132:135], v[4:7]
    ds_read_b128 a[164:167], v172 offset:17408
    s_add_u32 m0, s59, 16384
    v_mfma_f32_16x16x32_bf16 v[8:11], v[128:131], a[136:139], v[8:11]
    ds_read_b128 a[168:171], v172 offset:18432
    buffer_load_dwordx4 v164, s[28:31], s56 offen offset:0 lds
    v_readlane_b32 s57, v177, 15
    v_mfma_f32_16x16x32_bf16 v[12:15], v[128:131], a[140:143], v[12:15]
    ds_read_b128 a[172:175], v172 offset:19456
    v_mfma_f32_16x16x32_bf16 v[28:31], v[132:135], a[140:143], v[28:31]
    ds_read_b64_tr_b16 v[144:145], v161 offset:24576
    v_mfma_f32_16x16x32_bf16 v[24:27], v[132:135], a[136:139], v[24:27]
    ds_read_b64_tr_b16 v[146:147], v161 offset:25088
    buffer_load_dwordx4 v165, s[28:31], s56 offen offset:1024 lds
    v_mfma_f32_16x16x32_bf16 v[20:23], v[132:135], a[132:135], v[20:23]
    ds_read_b64_tr_b16 v[148:149], v162 offset:24576
    v_mfma_f32_16x16x32_bf16 v[16:19], v[132:135], a[128:131], v[16:19]
    ds_read_b64_tr_b16 v[150:151], v162 offset:25088
    v_mfma_f32_16x16x32_bf16 v[32:35], v[136:139], a[128:131], v[32:35]
    ds_read_b64_tr_b16 v[152:153], v161 offset:28672
    buffer_load_dword v170, v170, s[48:51], 0 offen offset:64 sc1
    v_mfma_f32_16x16x32_bf16 v[36:39], v[136:139], a[132:135], v[36:39]
    ds_read_b64_tr_b16 v[154:155], v161 offset:29184
    s_add_u32 m0, s78, 98304
    s_add_u32 s9, s74, 98304
    v_mfma_f32_16x16x32_bf16 v[40:43], v[136:139], a[136:139], v[40:43]
    ds_read_b64_tr_b16 v[156:157], v162 offset:28672
    buffer_load_dwordx4 v168, s[36:39], s9 offen lds
    v_mfma_f32_16x16x32_bf16 v[44:47], v[136:139], a[140:143], v[44:47]
    ds_read_b64_tr_b16 v[158:159], v162 offset:29184
    v_mfma_f32_16x16x32_bf16 v[60:63], v[140:143], a[140:143], v[60:63]
    s_add_u32 m0, s79, 98304
    s_add_u32 s9, s75, 98304
    v_mfma_f32_16x16x32_bf16 v[56:59], v[140:143], a[136:139], v[56:59]
    buffer_load_dwordx4 v168, s[36:39], s9 offen lds
    v_mfma_f32_16x16x32_bf16 v[52:55], v[140:143], a[132:135], v[52:55]
    s_waitcnt vmcnt(19) lgkmcnt(0)
    v_mfma_f32_16x16x32_bf16 v[48:51], v[140:143], a[128:131], v[48:51]
    s_barrier
    v_mfma_f32_16x16x32_bf16 v[0:3], v[144:147], a[144:147], v[0:3]
    ds_read_b128 a[176:179], v173 offset:24576
    v_mfma_f32_16x16x32_bf16 v[4:7], v[144:147], a[148:151], v[4:7]
    ds_read_b128 a[180:183], v173 offset:25600
    s_add_u32 m0, s59, 24576
    v_mfma_f32_16x16x32_bf16 v[8:11], v[144:147], a[152:155], v[8:11]
    ds_read_b128 a[184:187], v173 offset:26624
    buffer_load_dwordx4 v164, s[28:31], s57 offen offset:0 lds
    v_readlane_b32 s56, v177, 16
    v_mfma_f32_16x16x32_bf16 v[12:15], v[144:147], a[156:159], v[12:15]
    ds_read_b128 a[188:191], v173 offset:27648
    v_mfma_f32_16x16x32_bf16 v[28:31], v[148:151], a[156:159], v[28:31]
    ds_read_b64_tr_b16 v[128:129], v161 offset:32768
    v_mfma_f32_16x16x32_bf16 v[24:27], v[148:151], a[152:155], v[24:27]
    ds_read_b64_tr_b16 v[130:131], v161 offset:33280
    v_mfma_f32_16x16x32_bf16 v[20:23], v[148:151], a[148:151], v[20:23]
    ds_read_b64_tr_b16 v[132:133], v162 offset:32768
    buffer_load_dwordx4 v165, s[28:31], s57 offen offset:1024 lds
    v_mfma_f32_16x16x32_bf16 v[16:19], v[148:151], a[144:147], v[16:19]
    ds_read_b64_tr_b16 v[134:135], v162 offset:33280
    v_mfma_f32_16x16x32_bf16 v[32:35], v[152:155], a[144:147], v[32:35]
    ds_read_b64_tr_b16 v[136:137], v161 offset:36864
    s_add_u32 m0, s80, 98304
    s_add_u32 s9, s76, 98304
    v_mfma_f32_16x16x32_bf16 v[36:39], v[152:155], a[148:151], v[36:39]
    ds_read_b64_tr_b16 v[138:139], v161 offset:37376
    buffer_load_dwordx4 v168, s[36:39], s9 offen lds
    v_mfma_f32_16x16x32_bf16 v[40:43], v[152:155], a[152:155], v[40:43]
    ds_read_b64_tr_b16 v[140:141], v162 offset:36864
    v_mfma_f32_16x16x32_bf16 v[44:47], v[152:155], a[156:159], v[44:47]
    ds_read_b64_tr_b16 v[142:143], v162 offset:37376
    v_mfma_f32_16x16x32_bf16 v[60:63], v[156:159], a[156:159], v[60:63]
    s_add_u32 m0, s81, 98304
    s_add_u32 s9, s77, 98304
    v_mfma_f32_16x16x32_bf16 v[56:59], v[156:159], a[152:155], v[56:59]
    buffer_load_dwordx4 v168, s[36:39], s9 offen lds
    v_mfma_f32_16x16x32_bf16 v[52:55], v[156:159], a[148:151], v[52:55]
    s_waitcnt vmcnt(19) lgkmcnt(0)
    v_mfma_f32_16x16x32_bf16 v[48:51], v[156:159], a[144:147], v[48:51]
    s_barrier
    v_mfma_f32_16x16x32_bf16 v[0:3], v[128:131], a[160:163], v[0:3]
    ds_read_b128 a[192:195], v172 offset:32768
    v_mfma_f32_16x16x32_bf16 v[4:7], v[128:131], a[164:167], v[4:7]
    ds_read_b128 a[196:199], v172 offset:33792
    v_mfma_f32_16x16x32_bf16 v[8:11], v[128:131], a[168:171], v[8:11]
    ds_read_b128 a[200:203], v172 offset:34816
    v_mfma_f32_16x16x32_bf16 v[12:15], v[128:131], a[172:175], v[12:15]
    ds_read_b128 a[204:207], v172 offset:35840
    v_mfma_f32_16x16x32_bf16 v[28:31], v[132:135], a[172:175], v[28:31]
    ds_read_b64_tr_b16 v[144:145], v161 offset:40960
    v_mfma_f32_16x16x32_bf16 v[24:27], v[132:135], a[168:171], v[24:27]
    ds_read_b64_tr_b16 v[146:147], v161 offset:41472
    v_mfma_f32_16x16x32_bf16 v[20:23], v[132:135], a[164:167], v[20:23]
    ds_read_b64_tr_b16 v[148:149], v162 offset:40960
    v_mfma_f32_16x16x32_bf16 v[16:19], v[132:135], a[160:163], v[16:19]
    ds_read_b64_tr_b16 v[150:151], v162 offset:41472
    v_mfma_f32_16x16x32_bf16 v[32:35], v[136:139], a[160:163], v[32:35]
    ds_read_b64_tr_b16 v[152:153], v161 offset:45056
    v_mfma_f32_16x16x32_bf16 v[36:39], v[136:139], a[164:167], v[36:39]
    ds_read_b64_tr_b16 v[154:155], v161 offset:45568
    v_mfma_f32_16x16x32_bf16 v[40:43], v[136:139], a[168:171], v[40:43]
    ds_read_b64_tr_b16 v[156:157], v162 offset:45056
    v_mfma_f32_16x16x32_bf16 v[44:47], v[136:139], a[172:175], v[44:47]
    ds_read_b64_tr_b16 v[158:159], v162 offset:45568
    s_add_u32 m0, s59, 32768
    v_mfma_f32_16x16x32_bf16 v[60:63], v[140:143], a[172:175], v[60:63]
    buffer_load_dwordx4 v166, s[32:35], s56 offen offset:0 lds
    v_readlane_b32 s57, v177, 17
    v_mfma_f32_16x16x32_bf16 v[56:59], v[140:143], a[168:171], v[56:59]
    v_mfma_f32_16x16x32_bf16 v[52:55], v[140:143], a[164:167], v[52:55]
    buffer_load_dwordx4 v167, s[32:35], s56 offen offset:1024 lds
    s_waitcnt vmcnt(17) lgkmcnt(0)
    v_mfma_f32_16x16x32_bf16 v[48:51], v[140:143], a[160:163], v[48:51]
    s_barrier
    v_mfma_f32_16x16x32_bf16 v[0:3], v[144:147], a[176:179], v[0:3]
    ds_read_b128 a[208:211], v173 offset:40960
    v_mfma_f32_16x16x32_bf16 v[4:7], v[144:147], a[180:183], v[4:7]
    ds_read_b128 a[212:215], v173 offset:41984
    v_mfma_f32_16x16x32_bf16 v[8:11], v[144:147], a[184:187], v[8:11]
    ds_read_b128 a[216:219], v173 offset:43008
    v_mfma_f32_16x16x32_bf16 v[12:15], v[144:147], a[188:191], v[12:15]
    ds_read_b128 a[220:223], v173 offset:44032
    v_mfma_f32_16x16x32_bf16 v[28:31], v[148:151], a[188:191], v[28:31]
    ds_read_b64_tr_b16 v[128:129], v161 offset:0
    v_mfma_f32_16x16x32_bf16 v[24:27], v[148:151], a[184:187], v[24:27]
    ds_read_b64_tr_b16 v[130:131], v161 offset:512
    v_mfma_f32_16x16x32_bf16 v[20:23], v[148:151], a[180:183], v[20:23]
    ds_read_b64_tr_b16 v[132:133], v162 offset:0
    v_mfma_f32_16x16x32_bf16 v[16:19], v[148:151], a[176:179], v[16:19]
    ds_read_b64_tr_b16 v[134:135], v162 offset:512
    v_mfma_f32_16x16x32_bf16 v[32:35], v[152:155], a[176:179], v[32:35]
    ds_read_b64_tr_b16 v[136:137], v161 offset:4096
    v_mfma_f32_16x16x32_bf16 v[36:39], v[152:155], a[180:183], v[36:39]
    ds_read_b64_tr_b16 v[138:139], v161 offset:4608
    v_mfma_f32_16x16x32_bf16 v[40:43], v[152:155], a[184:187], v[40:43]
    ds_read_b64_tr_b16 v[140:141], v162 offset:4096
    v_mfma_f32_16x16x32_bf16 v[44:47], v[152:155], a[188:191], v[44:47]
    ds_read_b64_tr_b16 v[142:143], v162 offset:4608
    s_add_u32 m0, s59, 40960
    v_mfma_f32_16x16x32_bf16 v[60:63], v[156:159], a[188:191], v[60:63]
    buffer_load_dwordx4 v166, s[32:35], s57 offen offset:0 lds
    v_readlane_b32 s56, v177, 18
    v_mfma_f32_16x16x32_bf16 v[56:59], v[156:159], a[184:187], v[56:59]
    v_mfma_f32_16x16x32_bf16 v[52:55], v[156:159], a[180:183], v[52:55]
    buffer_load_dwordx4 v167, s[32:35], s57 offen offset:1024 lds
    s_waitcnt vmcnt(15) lgkmcnt(0)
    v_mfma_f32_16x16x32_bf16 v[48:51], v[156:159], a[176:179], v[48:51]
    s_barrier
    v_mfma_f32_16x16x32_bf16 v[0:3], v[128:131], a[192:195], v[0:3]
    ds_read_b128 a[224:227], v172 offset:49152
    v_mfma_f32_16x16x32_bf16 v[4:7], v[128:131], a[196:199], v[4:7]
    ds_read_b128 a[228:231], v172 offset:50176
    v_mfma_f32_16x16x32_bf16 v[8:11], v[128:131], a[200:203], v[8:11]
    ds_read_b128 a[232:235], v172 offset:51200
    v_mfma_f32_16x16x32_bf16 v[12:15], v[128:131], a[204:207], v[12:15]
    ds_read_b128 a[236:239], v172 offset:52224
    v_mfma_f32_16x16x32_bf16 v[28:31], v[132:135], a[204:207], v[28:31]
    ds_read_b64_tr_b16 v[144:145], v161 offset:8192
    v_mfma_f32_16x16x32_bf16 v[24:27], v[132:135], a[200:203], v[24:27]
    ds_read_b64_tr_b16 v[146:147], v161 offset:8704
    v_mfma_f32_16x16x32_bf16 v[20:23], v[132:135], a[196:199], v[20:23]
    ds_read_b64_tr_b16 v[148:149], v162 offset:8192
    v_mfma_f32_16x16x32_bf16 v[16:19], v[132:135], a[192:195], v[16:19]
    ds_read_b64_tr_b16 v[150:151], v162 offset:8704
    v_mfma_f32_16x16x32_bf16 v[32:35], v[136:139], a[192:195], v[32:35]
    ds_read_b64_tr_b16 v[152:153], v161 offset:12288
    v_mfma_f32_16x16x32_bf16 v[36:39], v[136:139], a[196:199], v[36:39]
    ds_read_b64_tr_b16 v[154:155], v161 offset:12800
    v_mfma_f32_16x16x32_bf16 v[40:43], v[136:139], a[200:203], v[40:43]
    ds_read_b64_tr_b16 v[156:157], v162 offset:12288
    v_mfma_f32_16x16x32_bf16 v[44:47], v[136:139], a[204:207], v[44:47]
    ds_read_b64_tr_b16 v[158:159], v162 offset:12800
    s_add_u32 m0, s59, 0
    v_mfma_f32_16x16x32_bf16 v[60:63], v[140:143], a[204:207], v[60:63]
    buffer_load_dwordx4 v166, s[32:35], s56 offen offset:0 lds
    v_readlane_b32 s57, v177, 19
    v_mfma_f32_16x16x32_bf16 v[56:59], v[140:143], a[200:203], v[56:59]
    v_mfma_f32_16x16x32_bf16 v[52:55], v[140:143], a[196:199], v[52:55]
    buffer_load_dwordx4 v167, s[32:35], s56 offen offset:1024 lds
    s_waitcnt vmcnt(13) lgkmcnt(0)
    v_mfma_f32_16x16x32_bf16 v[48:51], v[140:143], a[192:195], v[48:51]
    s_barrier
    v_mfma_f32_16x16x32_bf16 v[0:3], v[144:147], a[208:211], v[0:3]
    ds_read_b128 a[240:243], v173 offset:57344
    v_mfma_f32_16x16x32_bf16 v[4:7], v[144:147], a[212:215], v[4:7]
    ds_read_b128 a[244:247], v173 offset:58368
    v_mfma_f32_16x16x32_bf16 v[8:11], v[144:147], a[216:219], v[8:11]
    ds_read_b128 a[248:251], v173 offset:59392
    v_mfma_f32_16x16x32_bf16 v[12:15], v[144:147], a[220:223], v[12:15]
    ds_read_b128 a[252:255], v173 offset:60416
    v_mfma_f32_16x16x32_bf16 v[28:31], v[148:151], a[220:223], v[28:31]
    ds_read_b64_tr_b16 v[128:129], v161 offset:16384
    v_mfma_f32_16x16x32_bf16 v[24:27], v[148:151], a[216:219], v[24:27]
    ds_read_b64_tr_b16 v[130:131], v161 offset:16896
    v_mfma_f32_16x16x32_bf16 v[20:23], v[148:151], a[212:215], v[20:23]
    ds_read_b64_tr_b16 v[132:133], v162 offset:16384
    v_mfma_f32_16x16x32_bf16 v[16:19], v[148:151], a[208:211], v[16:19]
    ds_read_b64_tr_b16 v[134:135], v162 offset:16896
    v_mfma_f32_16x16x32_bf16 v[32:35], v[152:155], a[208:211], v[32:35]
    ds_read_b64_tr_b16 v[136:137], v161 offset:20480
    v_mfma_f32_16x16x32_bf16 v[36:39], v[152:155], a[212:215], v[36:39]
    ds_read_b64_tr_b16 v[138:139], v161 offset:20992
    v_mfma_f32_16x16x32_bf16 v[40:43], v[152:155], a[216:219], v[40:43]
    ds_read_b64_tr_b16 v[140:141], v162 offset:20480
    v_mfma_f32_16x16x32_bf16 v[44:47], v[152:155], a[220:223], v[44:47]
    ds_read_b64_tr_b16 v[142:143], v162 offset:20992
    s_add_u32 m0, s59, 8192
    v_mfma_f32_16x16x32_bf16 v[60:63], v[156:159], a[220:223], v[60:63]
    buffer_load_dwordx4 v166, s[32:35], s57 offen offset:0 lds
    v_readlane_b32 s56, v177, 20
    v_mfma_f32_16x16x32_bf16 v[56:59], v[156:159], a[216:219], v[56:59]
    v_mfma_f32_16x16x32_bf16 v[52:55], v[156:159], a[212:215], v[52:55]
    buffer_load_dwordx4 v167, s[32:35], s57 offen offset:1024 lds
    s_waitcnt vmcnt(10) lgkmcnt(0)
    v_mfma_f32_16x16x32_bf16 v[48:51], v[156:159], a[208:211], v[48:51]
    s_barrier
    v_mfma_f32_16x16x32_bf16 v[0:3], v[128:131], a[224:227], v[0:3]
    ds_write_b64 v200, v[184:185]
    ds_write_b64 v201, v[186:187]
    v_mfma_f32_16x16x32_bf16 v[4:7], v[128:131], a[228:231], v[4:7]
    ds_write_b64 v202, v[188:189]
    s_add_u32 m0, s59, 16384
    v_mfma_f32_16x16x32_bf16 v[8:11], v[128:131], a[232:235], v[8:11]
    ds_write_b64 v203, v[190:191]
    buffer_load_dwordx4 v166, s[32:35], s56 offen offset:0 lds
    v_readlane_b32 s57, v177, 21
    v_mfma_f32_16x16x32_bf16 v[12:15], v[128:131], a[236:239], v[12:15]
    ds_read_b64_tr_b16 v[144:145], v161 offset:24576
    ds_read_b64_tr_b16 v[146:147], v161 offset:25088
    v_mfma_f32_16x16x32_bf16 v[28:31], v[132:135], a[236:239], v[28:31]
    ds_read_b64_tr_b16 v[148:149], v162 offset:24576
    v_mfma_f32_16x16x32_bf16 v[24:27], v[132:135], a[232:235], v[24:27]
    ds_read_b64_tr_b16 v[150:151], v162 offset:25088
    buffer_load_dwordx4 v167, s[32:35], s56 offen offset:1024 lds
    v_mfma_f32_16x16x32_bf16 v[20:23], v[132:135], a[228:231], v[20:23]
    ds_read_b64_tr_b16 v[152:153], v161 offset:28672
    ds_read_b64_tr_b16 v[154:155], v161 offset:29184
    v_mfma_f32_16x16x32_bf16 v[16:19], v[132:135], a[224:227], v[16:19]
    ds_read_b64_tr_b16 v[156:157], v162 offset:28672
    v_mfma_f32_16x16x32_bf16 v[32:35], v[136:139], a[224:227], v[32:35]
    ds_read_b64_tr_b16 v[158:159], v162 offset:29184
    v_cmp_eq_u32 vcc, 64, v170
    s_nop 1
    s_and_b32 s8, vcc_lo, 65535
    s_cmp_eq_u32 s8, 65535
    s_cbranch_scc0 L_slow1
L_ok1:
    v_mfma_f32_16x16x32_bf16 v[36:39], v[136:139], a[228:231], v[36:39]
    ds_read_b64_tr_b16 v[208:209], v180 offset:0
    ds_read_b64_tr_b16 v[210:211], v180 offset:2048
    s_add_u32 m0, s78, 114688
    s_add_u32 s9, s74, 131072
    v_mfma_f32_16x16x32_bf16 v[40:43], v[136:139], a[232:235], v[40:43]
    ds_read_b64_tr_b16 v[212:213], v181 offset:0
    buffer_load_dwordx4 v168, s[36:39], s9 offen lds
    v_mfma_f32_16x16x32_bf16 v[44:47], v[136:139], a[236:239], v[44:47]
    ds_read_b64_tr_b16 v[214:215], v181 offset:2048
    v_mfma_f32_16x16x32_bf16 v[60:63], v[140:143], a[236:239], v[60:63]
    s_add_u32 m0, s79, 114688
    s_add_u32 s9, s75, 131072
    v_mfma_f32_16x16x32_bf16 v[56:59], v[140:143], a[232:235], v[56:59]
    buffer_load_dwordx4 v168, s[36:39], s9 offen lds
    v_mfma_f32_16x16x32_bf16 v[52:55], v[140:143], a[228:231], v[52:55]
    s_waitcnt vmcnt(10) lgkmcnt(0)
    v_mfma_f32_16x16x32_bf16 v[48:51], v[140:143], a[224:227], v[48:51]
    s_barrier
    v_mfma_f32_16x16x32_bf16 v[0:3], v[144:147], a[240:243], v[0:3]
    ds_read_b64 v[192:193], v204 offset:0
    ds_read_b64 v[194:195], v204 offset:128
    v_mfma_f32_16x16x32_bf16 v[4:7], v[144:147], a[244:247], v[4:7]
    ds_read_b64 v[196:197], v204 offset:256
    s_add_u32 m0, s59, 24576
    v_mfma_f32_16x16x32_bf16 v[8:11], v[144:147], a[248:251], v[8:11]
    ds_read_b64 v[198:199], v204 offset:384
    buffer_load_dwordx4 v166, s[32:35], s57 offen offset:0 lds
    v_readlane_b32 s56, v177, 22
    v_mfma_f32_16x16x32_bf16 v[12:15], v[144:147], a[252:255], v[12:15]
    ds_read_b64_tr_b16 v[128:129], v161 offset:32768
    ds_read_b64_tr_b16 v[130:131], v161 offset:33280
    v_mfma_f32_16x16x32_bf16 v[28:31], v[148:151], a[252:255], v[28:31]
    ds_read_b64_tr_b16 v[132:133], v162 offset:32768
    v_mfma_f32_16x16x32_bf16 v[24:27], v[148:151], a[248:251], v[24:27]
    ds_read_b64_tr_b16 v[134:135], v162 offset:33280
    v_mfma_f32_16x16x32_bf16 v[20:23], v[148:151], a[244:247], v[20:23]
    ds_read_b64_tr_b16 v[136:137], v161 offset:36864
    ds_read_b64_tr_b16 v[138:139], v161 offset:37376
    buffer_load_dwordx4 v167, s[32:35], s57 offen offset:1024 lds
    v_mfma_f32_16x16x32_bf16 v[16:19], v[148:151], a[240:243], v[16:19]
    ds_read_b64_tr_b16 v[140:141], v162 offset:36864
    v_mfma_f32_16x16x32_bf16 v[32:35], v[152:155], a[240:243], v[32:35]
    ds_read_b64_tr_b16 v[142:143], v162 offset:37376
    s_add_u32 m0, s80, 114688
    s_add_u32 s9, s76, 131072
    v_mfma_f32_16x16x32_bf16 v[36:39], v[152:155], a[244:247], v[36:39]
    ds_read_b64_tr_b16 v[216:217], v182 offset:0
    ds_read_b64_tr_b16 v[218:219], v182 offset:2048
    buffer_load_dwordx4 v168, s[36:39], s9 offen lds
    v_mfma_f32_16x16x32_bf16 v[40:43], v[152:155], a[248:251], v[40:43]
    ds_read_b64_tr_b16 v[220:221], v183 offset:0
    v_mfma_f32_16x16x32_bf16 v[44:47], v[152:155], a[252:255], v[44:47]
    ds_read_b64_tr_b16 v[222:223], v183 offset:2048
    v_mfma_f32_16x16x32_bf16 v[60:63], v[156:159], a[252:255], v[60:63]
    s_add_u32 m0, s81, 114688
    s_add_u32 s9, s77, 131072
    v_mfma_f32_16x16x32_bf16 v[56:59], v[156:159], a[248:251], v[56:59]
    buffer_load_dwordx4 v168, s[36:39], s9 offen lds
    v_mfma_f32_16x16x32_bf16 v[52:55], v[156:159], a[244:247], v[52:55]
    s_waitcnt vmcnt(12) lgkmcnt(0)
    v_mfma_f32_16x16x32_bf16 v[48:51], v[156:159], a[240:243], v[48:51]
    s_barrier
    v_mfma_f32_16x16x32_bf16 v[64:67], v[128:131], a[0:3], 0
    ds_read_b64_tr_b16 v[144:145], v161 offset:40960
    s_add_u32 s11, s63, 16384
    v_mul_f32 v184, v192, v0
    v_mul_f32 v185, v192, v1
    v_mul_f32 v186, v192, v2
    v_mfma_f32_16x16x32_bf16 v[68:71], v[128:131], a[4:7], 0
    ds_read_b64_tr_b16 v[146:147], v161 offset:41472
    s_add_u32 m0, s59, 32768
    v_mul_f32 v187, v192, v3
    v_exp_f32 v184, v184
    v_mfma_f32_16x16x32_bf16 v[72:75], v[128:131], a[8:11], 0
    ds_read_b64_tr_b16 v[148:149], v162 offset:40960
    buffer_load_dwordx4 v166, s[32:35], s56 offen offset:0 lds
    v_readlane_b32 s57, v177, 23
    v_mfma_f32_16x16x32_bf16 v[76:79], v[128:131], a[12:15], 0
    ds_read_b64_tr_b16 v[150:151], v162 offset:41472
    v_mul_f32 v188, v192, v16
    v_mul_f32 v32, v0, v32
    v_mfma_f32_16x16x32_bf16 v[92:95], v[132:135], a[12:15], 0
    ds_read_b64_tr_b16 v[152:153], v161 offset:45056
    v_exp_f32 v185, v185
    v_mul_f32 v189, v192, v17
    v_mul_f32 v33, v1, v33
    v_mfma_f32_16x16x32_bf16 v[88:91], v[132:135], a[8:11], 0
    ds_read_b64_tr_b16 v[154:155], v161 offset:45568
    v_exp_f32 v186, v186
    v_mul_f32 v190, v192, v18
    v_mul_f32 v34, v2, v34
    v_mfma_f32_16x16x32_bf16 v[84:87], v[132:135], a[4:7], 0
    ds_read_b64_tr_b16 v[156:157], v162 offset:45056
    buffer_load_dwordx4 v167, s[32:35], s56 offen offset:1024 lds
    v_mfma_f32_16x16x32_bf16 v[80:83], v[132:135], a[0:3], 0
    ds_read_b64_tr_b16 v[158:159], v162 offset:45568
    v_exp_f32 v187, v187
    v_mul_f32 v191, v192, v19
    v_mfma_f32_16x16x32_bf16 v[96:99], a[0:3], v[136:139], 0
    ds_read_b64_tr_b16 v[224:225], v180 offset:16384
    s_add_u32 m0, s78, 131072
    s_add_u32 s9, s74, 163840
    v_mul_f32 v35, v3, v35
    v_mfma_f32_16x16x32_bf16 v[100:103], a[4:7], v[136:139], 0
    ds_read_b64_tr_b16 v[226:227], v180 offset:18432
    buffer_load_dwordx4 v168, s[36:39], s9 offen lds
    v_mfma_f32_16x16x32_bf16 v[104:107], a[8:11], v[136:139], 0
    ds_read_b64_tr_b16 v[228:229], v181 offset:16384
    v_exp_f32 v188, v188
    v_fma_f32 v184, v184, v193, v193
    v_mul_f32 v48, v16, v48
    v_mfma_f32_16x16x32_bf16 v[108:111], a[12:15], v[136:139], 0
    ds_read_b64_tr_b16 v[230:231], v181 offset:18432
    v_exp_f32 v189, v189
    v_fma_f32 v185, v185, v193, v193
    v_mul_f32 v49, v17, v49
    v_mfma_f32_16x16x32_bf16 v[124:127], a[12:15], v[140:143], 0
    s_add_u32 m0, s79, 131072
    s_add_u32 s9, s75, 163840
    v_exp_f32 v190, v190
    v_fma_f32 v186, v186, v193, v193
    v_mfma_f32_16x16x32_bf16 v[120:123], a[8:11], v[140:143], 0
    buffer_load_dwordx4 v168, s[36:39], s9 offen lds
    v_mul_f32 v50, v18, v50
    v_mfma_f32_16x16x32_bf16 v[116:119], a[4:7], v[140:143], 0
    v_exp_f32 v191, v191
    v_fma_f32 v187, v187, v193, v193
    v_mul_f32 v51, v19, v51
    s_waitcnt vmcnt(14) lgkmcnt(0)
    v_mfma_f32_16x16x32_bf16 v[112:115], a[0:3], v[140:143], 0
    s_barrier
    v_mfma_f32_16x16x32_bf16 v[64:67], v[144:147], a[16:19], v[64:67]
    ds_read_b64_tr_b16 v[128:129], v161 offset:0
    v_rcp_f32 v184, v184
    v_fma_f32 v188, v188, v193, v193
    v_mfma_f32_16x16x32_bf16 v[68:71], v[144:147], a[20:23], v[68:71]
    ds_read_b64_tr_b16 v[130:131], v161 offset:512
    s_add_u32 m0, s59, 40960
    v_rcp_f32 v185, v185
    v_fma_f32 v189, v189, v193, v193
    v_mfma_f32_16x16x32_bf16 v[72:75], v[144:147], a[24:27], v[72:75]
    ds_read_b64_tr_b16 v[132:133], v162 offset:0
    buffer_load_dwordx4 v166, s[32:35], s57 offen offset:0 lds
    v_readlane_b32 s56, v177, 24
    v_mfma_f32_16x16x32_bf16 v[76:79], v[144:147], a[28:31], v[76:79]
    ds_read_b64_tr_b16 v[134:135], v162 offset:512
    v_rcp_f32 v186, v186
    v_fma_f32 v190, v190, v193, v193
    v_mfma_f32_16x16x32_bf16 v[92:95], v[148:151], a[28:31], v[92:95]
    ds_read_b64_tr_b16 v[136:137], v161 offset:4096
    v_rcp_f32 v187, v187
    v_fma_f32 v191, v191, v193, v193
    v_mfma_f32_16x16x32_bf16 v[88:91], v[148:151], a[24:27], v[88:91]
    ds_read_b64_tr_b16 v[138:139], v161 offset:4608
    v_rcp_f32 v188, v188
    v_mul_f32 v32, v32, v184
    v_rcp_f32 v189, v189
    v_mfma_f32_16x16x32_bf16 v[84:87], v[148:151], a[20:23], v[84:87]
    ds_read_b64_tr_b16 v[140:141], v162 offset:4096
    buffer_load_dwordx4 v167, s[32:35], s57 offen offset:1024 lds
    v_mfma_f32_16x16x32_bf16 v[80:83], v[148:151], a[16:19], v[80:83]
    ds_read_b64_tr_b16 v[142:143], v162 offset:4608
    v_mul_f32 v33, v33, v185
    v_rcp_f32 v190, v190
    v_mfma_f32_16x16x32_bf16 v[96:99], a[16:19], v[152:155], v[96:99]
    ds_read_b64_tr_b16 v[232:233], v182 offset:16384
    s_add_u32 m0, s80, 131072
    s_add_u32 s9, s76, 163840
    v_mul_f32 v34, v34, v186
    v_mfma_f32_16x16x32_bf16 v[100:103], a[20:23], v[152:155], v[100:103]
    ds_read_b64_tr_b16 v[234:235], v182 offset:18432
    buffer_load_dwordx4 v168, s[36:39], s9 offen lds
    v_mfma_f32_16x16x32_bf16 v[104:107], a[24:27], v[152:155], v[104:107]
    ds_read_b64_tr_b16 v[236:237], v183 offset:16384
    v_rcp_f32 v191, v191
    v_mul_f32 v35, v35, v187
    v_cvt_pk_bf16_f32 v0, v32, v33
    v_cvt_pk_bf16_f32 v1, v34, v35
    v_mfma_f32_16x16x32_bf16 v[108:111], a[28:31], v[152:155], v[108:111]
    ds_read_b64_tr_b16 v[238:239], v183 offset:18432
    v_mul_f32 v48, v48, v188
    v_mul_f32 v49, v49, v189
    v_mul_f32 v50, v50, v190
    v_mul_f32 v51, v51, v191
    v_mfma_f32_16x16x32_bf16 v[124:127], a[28:31], v[156:159], v[124:127]
    s_add_u32 m0, s81, 131072
    s_add_u32 s9, s77, 163840
    v_cvt_pk_bf16_f32 v2, v48, v49
    v_cvt_pk_bf16_f32 v3, v50, v51
    v_mfma_f32_16x16x32_bf16 v[120:123], a[24:27], v[156:159], v[120:123]
    buffer_load_dwordx4 v168, s[36:39], s9 offen lds
    v_mfma_f32_16x16x32_bf16 v[116:119], a[20:23], v[156:159], v[116:119]
    buffer_store_dwordx4 v[0:3], v160, s[44:47], s11 offen offset:0 sc1
    v_mul_f32 v184, v194, v4
    s_waitcnt vmcnt(17) lgkmcnt(0)
    v_mfma_f32_16x16x32_bf16 v[112:115], a[16:19], v[156:159], v[112:115]
L_stub2:
    s_cbranch_execz L_tourret
    s_nop 0
    s_barrier
    v_mfma_f32_16x16x32_bf16 v[64:67], v[128:131], a[32:35], v[64:67]
    ds_read_b64_tr_b16 v[144:145], v161 offset:8192
    v_mul_f32 v185, v194, v5
    v_mul_f32 v186, v194, v6
    v_mul_f32 v187, v194, v7
    v_mfma_f32_16x16x32_bf16 v[68:71], v[128:131], a[36:39], v[68:71]
    ds_read_b64_tr_b16 v[146:147], v161 offset:8704
    s_add_u32 m0, s59, 0
    v_exp_f32 v184, v184
    v_mul_f32 v188, v194, v20
    v_mul_f32 v36, v4, v36
    v_mfma_f32_16x16x32_bf16 v[72:75], v[128:131], a[40:43], v[72:75]
    ds_read_b64_tr_b16 v[148:149], v162 offset:8192
    buffer_load_dwordx4 v166, s[32:35], s56 offen offset:0 lds
    v_readlane_b32 s57, v177, 25
    v_mfma_f32_16x16x32_bf16 v[76:79], v[128:131], a[44:47], v[76:79]
    ds_read_b64_tr_b16 v[150:151], v162 offset:8704
    v_exp_f32 v185, v185
    v_mfma_f32_16x16x32_bf16 v[92:95], v[132:135], a[44:47], v[92:95]
    ds_read_b64_tr_b16 v[152:153], v161 offset:12288
    v_mul_f32 v189, v194, v21
    v_mul_f32 v37, v5, v37
    v_exp_f32 v186, v186
    v_mfma_f32_16x16x32_bf16 v[88:91], v[132:135], a[40:43], v[88:91]
    ds_read_b64_tr_b16 v[154:155], v161 offset:12800
    v_mul_f32 v190, v194, v22
    v_mul_f32 v38, v6, v38
    v_exp_f32 v187, v187
    v_mfma_f32_16x16x32_bf16 v[84:87], v[132:135], a[36:39], v[84:87]
    ds_read_b64_tr_b16 v[156:157], v162 offset:12288
    buffer_load_dwordx4 v167, s[32:35], s56 offen offset:1024 lds
    v_mfma_f32_16x16x32_bf16 v[80:83], v[132:135], a[32:35], v[80:83]
    ds_read_b64_tr_b16 v[158:159], v162 offset:12800
    v_mul_f32 v191, v194, v23
    v_mul_f32 v39, v7, v39
    v_mfma_f32_16x16x32_bf16 v[96:99], a[32:35], v[136:139], v[96:99]
    ds_read_b64_tr_b16 v[240:241], v180 offset:32768
    s_add_u32 m0, s78, 147456
    s_add_u32 s9, s74, 196608
    v_exp_f32 v188, v188
    v_fma_f32 v184, v184, v195, v195
    v_mfma_f32_16x16x32_bf16 v[100:103], a[36:39], v[136:139], v[100:103]
    ds_read_b64_tr_b16 v[242:243], v180 offset:34816
    buffer_load_dwordx4 v168, s[36:39], s9 offen lds
    v_mfma_f32_16x16x32_bf16 v[104:107], a[40:43], v[136:139], v[104:107]
    ds_read_b64_tr_b16 v[244:245], v181 offset:32768
    v_mul_f32 v52, v20, v52
    v_exp_f32 v189, v189
    v_fma_f32 v185, v185, v195, v195
    v_mfma_f32_16x16x32_bf16 v[108:111], a[44:47], v[136:139], v[108:111]
    ds_read_b64_tr_b16 v[246:247], v181 offset:34816
    v_mul_f32 v53, v21, v53
    v_exp_f32 v190, v190
    v_fma_f32 v186, v186, v195, v195
    v_mfma_f32_16x16x32_bf16 v[124:127], a[44:47], v[140:143], v[124:127]
    s_add_u32 m0, s79, 147456
    s_add_u32 s9, s75, 196608
    v_mul_f32 v54, v22, v54
    v_mfma_f32_16x16x32_bf16 v[120:123], a[40:43], v[140:143], v[120:123]
    buffer_load_dwordx4 v168, s[36:39], s9 offen lds
    v_exp_f32 v191, v191
    v_mfma_f32_16x16x32_bf16 v[116:119], a[36:39], v[140:143], v[116:119]
    v_fma_f32 v187, v187, v195, v195
    v_mul_f32 v55, v23, v55
    v_rcp_f32 v184, v184
    s_waitcnt vmcnt(19) lgkmcnt(0)
    v_mfma_f32_16x16x32_bf16 v[112:115], a[32:35], v[140:143], v[112:115]
    s_barrier
    v_mfma_f32_16x16x32_bf16 v[64:67], v[144:147], a[48:51], v[64:67]
    ds_read_b64_tr_b16 v[128:129], v161 offset:16384
    v_fma_f32 v188, v188, v195, v195
    v_rcp_f32 v185, v185
    v_fma_f32 v189, v189, v195, v195
    v_mfma_f32_16x16x32_bf16 v[68:71], v[144:147], a[52:55], v[68:71]
    ds_read_b64_tr_b16 v[130:131], v161 offset:16896
    s_add_u32 m0, s59, 8192
    v_rcp_f32 v186, v186
    v_fma_f32 v190, v190, v195, v195
    v_mfma_f32_16x16x32_bf16 v[72:75], v[144:147], a[56:59], v[72:75]
    ds_read_b64_tr_b16 v[132:133], v162 offset:16384
    buffer_load_dwordx4 v166, s[32:35], s57 offen offset:0 lds
    v_readlane_b32 s56, v177, 26
    v_mfma_f32_16x16x32_bf16 v[76:79], v[144:147], a[60:63], v[76:79]
    ds_read_b64_tr_b16 v[134:135], v162 offset:16896
    v_rcp_f32 v187, v187
    v_mfma_f32_16x16x32_bf16 v[92:95], v[148:151], a[60:63], v[92:95]
    ds_read_b64_tr_b16 v[136:137], v161 offset:20480
    v_fma_f32 v191, v191, v195, v195
    v_rcp_f32 v188, v188
    v_mul_f32 v36, v36, v184
    v_mfma_f32_16x16x32_bf16 v[88:91], v[148:151], a[56:59], v[88:91]
    ds_read_b64_tr_b16 v[138:139], v161 offset:20992
    v_rcp_f32 v189, v189
    v_mul_f32 v37, v37, v185
    v_mfma_f32_16x16x32_bf16 v[84:87], v[148:151], a[52:55], v[84:87]
    ds_read_b64_tr_b16 v[140:141], v162 offset:20480
    buffer_load_dwordx4 v167, s[32:35], s57 offen offset:1024 lds
    v_mfma_f32_16x16x32_bf16 v[80:83], v[148:151], a[48:51], v[80:83]
    ds_read_b64_tr_b16 v[142:143], v162 offset:20992
    v_rcp_f32 v190, v190
    v_mul_f32 v38, v38, v186
    v_mfma_f32_16x16x32_bf16 v[96:99], a[48:51], v[152:155], v[96:99]
    ds_read_b64_tr_b16 v[248:249], v182 offset:32768
    s_add_u32 m0, s80, 147456
    s_add_u32 s9, s76, 196608
    v_rcp_f32 v191, v191
    v_mul_f32 v39, v39, v187
    v_mfma_f32_16x16x32_bf16 v[100:103], a[52:55], v[152:155], v[100:103]
    ds_read_b64_tr_b16 v[250:251], v182 offset:34816
    buffer_load_dwordx4 v168, s[36:39], s9 offen lds
    v_mfma_f32_16x16x32_bf16 v[104:107], a[56:59], v[152:155], v[104:107]
    ds_read_b64_tr_b16 v[252:253], v183 offset:32768
    v_cvt_pk_bf16_f32 v4, v36, v37
    v_cvt_pk_bf16_f32 v5, v38, v39
    v_mul_f32 v52, v52, v188
    v_mul_f32 v53, v53, v189
    v_mfma_f32_16x16x32_bf16 v[108:111], a[60:63], v[152:155], v[108:111]
    ds_read_b64_tr_b16 v[254:255], v183 offset:34816
    v_mul_f32 v54, v54, v190
    v_mul_f32 v55, v55, v191
    v_cvt_pk_bf16_f32 v6, v52, v53
    v_cvt_pk_bf16_f32 v7, v54, v55
    v_mfma_f32_16x16x32_bf16 v[124:127], a[60:63], v[156:159], v[124:127]
    s_add_u32 m0, s81, 147456
    s_add_u32 s9, s77, 196608
    v_mfma_f32_16x16x32_bf16 v[120:123], a[56:59], v[156:159], v[120:123]
    buffer_load_dwordx4 v168, s[36:39], s9 offen lds
    v_mfma_f32_16x16x32_bf16 v[116:119], a[52:55], v[156:159], v[116:119]
    buffer_store_dwordx4 v[4:7], v160, s[44:47], s11 offen offset:1024 sc1
    v_mul_f32 v184, v196, v8
    v_mul_f32 v185, v196, v9
    v_mul_f32 v186, v196, v10
    s_waitcnt vmcnt(20) lgkmcnt(0)
    v_mfma_f32_16x16x32_bf16 v[112:115], a[48:51], v[156:159], v[112:115]
    s_barrier
    v_mfma_f32_16x16x32_bf16 v[64:67], v[128:131], a[64:67], v[64:67]
    ds_read_b64_tr_b16 v[144:145], v161 offset:24576
    s_add_u32 m0, s59, 16384
    v_mul_f32 v187, v196, v11
    v_mfma_f32_16x16x32_bf16 v[68:71], v[128:131], a[68:71], v[68:71]
    buffer_load_dwordx4 v166, s[32:35], s56 offen offset:0 lds
    v_readlane_b32 s57, v177, 27
    v_mfma_f32_16x16x32_bf16 v[72:75], v[128:131], a[72:75], v[72:75]
    ds_read_b64_tr_b16 v[146:147], v161 offset:25088
    v_exp_f32 v184, v184
    v_mul_f32 v188, v196, v24
    v_mul_f32 v40, v8, v40
    v_mfma_f32_16x16x32_bf16 v[76:79], v[128:131], a[76:79], v[76:79]
    ds_read_b64_tr_b16 v[148:149], v162 offset:24576
    v_exp_f32 v185, v185
    v_mul_f32 v189, v196, v25
    v_mul_f32 v41, v9, v41
    v_mfma_f32_16x16x32_bf16 v[92:95], v[132:135], a[76:79], v[92:95]
    v_exp_f32 v186, v186
    v_mul_f32 v190, v196, v26
    v_mul_f32 v42, v10, v42
    v_mfma_f32_16x16x32_bf16 v[88:91], v[132:135], a[72:75], v[88:91]
    ds_read_b64_tr_b16 v[150:151], v162 offset:25088
    v_exp_f32 v187, v187
    v_mul_f32 v191, v196, v27
    v_mul_f32 v43, v11, v43
    v_mfma_f32_16x16x32_bf16 v[84:87], v[132:135], a[68:71], v[84:87]
    ds_read_b64_tr_b16 v[152:153], v161 offset:28672
    v_exp_f32 v188, v188
    v_fma_f32 v184, v184, v197, v197
    v_mfma_f32_16x16x32_bf16 v[80:83], v[132:135], a[64:67], v[80:83]
    buffer_load_dwordx4 v167, s[32:35], s56 offen offset:1024 lds
    v_mul_f32 v56, v24, v56
    v_mfma_f32_16x16x32_bf16 v[96:99], a[64:67], v[136:139], v[96:99]
    ds_read_b64_tr_b16 v[154:155], v161 offset:29184
    v_exp_f32 v189, v189
    v_fma_f32 v185, v185, v197, v197
    v_mfma_f32_16x16x32_bf16 v[100:103], a[68:71], v[136:139], v[100:103]
    ds_read_b64_tr_b16 v[156:157], v162 offset:28672
    v_mul_f32 v57, v25, v57
    v_exp_f32 v190, v190
    v_fma_f32 v186, v186, v197, v197
    v_mfma_f32_16x16x32_bf16 v[104:107], a[72:75], v[136:139], v[104:107]
    v_mul_f32 v58, v26, v58
    v_exp_f32 v191, v191
    v_fma_f32 v187, v187, v197, v197
    v_mfma_f32_16x16x32_bf16 v[108:111], a[76:79], v[136:139], v[108:111]
    ds_read_b64_tr_b16 v[158:159], v162 offset:29184
    s_add_u32 m0, s78, 49152
    s_add_u32 s9, s74, 229376
    v_mul_f32 v59, v27, v59
    v_mfma_f32_16x16x32_bf16 v[124:127], a[76:79], v[140:143], v[124:127]
    buffer_load_dwordx4 v168, s[36:39], s9 offen lds
    v_mfma_f32_16x16x32_bf16 v[120:123], a[72:75], v[140:143], v[120:123]
    s_add_u32 m0, s79, 49152
    s_add_u32 s9, s75, 229376
    v_rcp_f32 v184, v184
    v_fma_f32 v188, v188, v197, v197
    v_mfma_f32_16x16x32_bf16 v[116:119], a[68:71], v[140:143], v[116:119]
    buffer_load_dwordx4 v168, s[36:39], s9 offen lds
    s_waitcnt vmcnt(20) lgkmcnt(0)
    v_mfma_f32_16x16x32_bf16 v[112:115], a[64:67], v[140:143], v[112:115]
    s_barrier
    v_mfma_f32_16x16x32_bf16 v[64:67], v[144:147], a[80:83], v[64:67]
    ds_read_b64_tr_b16 v[128:129], v161 offset:32768
    s_add_u32 m0, s59, 24576
    v_rcp_f32 v185, v185
    v_fma_f32 v189, v189, v197, v197
    v_mfma_f32_16x16x32_bf16 v[68:71], v[144:147], a[84:87], v[68:71]
    buffer_load_dwordx4 v166, s[32:35], s57 offen offset:0 lds
    v_readlane_b32 s56, v177, 28
    v_mfma_f32_16x16x32_bf16 v[72:75], v[144:147], a[88:91], v[72:75]
    ds_read_b64_tr_b16 v[130:131], v161 offset:33280
    v_rcp_f32 v186, v186
    v_fma_f32 v190, v190, v197, v197
    v_mfma_f32_16x16x32_bf16 v[76:79], v[144:147], a[92:95], v[76:79]
    ds_read_b64_tr_b16 v[132:133], v162 offset:32768
    v_rcp_f32 v187, v187
    v_fma_f32 v191, v191, v197, v197
    v_mfma_f32_16x16x32_bf16 v[92:95], v[148:151], a[92:95], v[92:95]
    v_rcp_f32 v188, v188
    v_mul_f32 v40, v40, v184
    v_rcp_f32 v189, v189
    v_mfma_f32_16x16x32_bf16 v[88:91], v[148:151], a[88:91], v[88:91]
    ds_read_b64_tr_b16 v[134:135], v162 offset:33280
    v_mul_f32 v41, v41, v185
    v_rcp_f32 v190, v190
    v_mfma_f32_16x16x32_bf16 v[84:87], v[148:151], a[84:87], v[84:87]
    ds_read_b64_tr_b16 v[136:137], v161 offset:36864
    v_mul_f32 v42, v42, v186
    v_rcp_f32 v191, v191
    v_mul_f32 v43, v43, v187
    v_mfma_f32_16x16x32_bf16 v[80:83], v[148:151], a[80:83], v[80:83]
    buffer_load_dwordx4 v167, s[32:35], s57 offen offset:1024 lds
    v_mfma_f32_16x16x32_bf16 v[96:99], a[80:83], v[152:155], v[96:99]
    ds_read_b64_tr_b16 v[138:139], v161 offset:37376
    v_cvt_pk_bf16_f32 v8, v40, v41
    v_cvt_pk_bf16_f32 v9, v42, v43
    v_mul_f32 v56, v56, v188
    v_mul_f32 v57, v57, v189
    v_mfma_f32_16x16x32_bf16 v[100:103], a[84:87], v[152:155], v[100:103]
    ds_read_b64_tr_b16 v[140:141], v162 offset:36864
    v_mul_f32 v58, v58, v190
    v_mul_f32 v59, v59, v191
    v_cvt_pk_bf16_f32 v10, v56, v57
    v_mfma_f32_16x16x32_bf16 v[104:107], a[88:91], v[152:155], v[104:107]
    v_cvt_pk_bf16_f32 v11, v58, v59
    buffer_store_dwordx4 v[8:11], v160, s[44:47], s11 offen offset:2048 sc1
    v_mfma_f32_16x16x32_bf16 v[108:111], a[92:95], v[152:155], v[108:111]
    ds_read_b64_tr_b16 v[142:143], v162 offset:37376
    s_add_u32 m0, s80, 49152
    s_add_u32 s9, s76, 229376
    v_mul_f32 v184, v198, v12
    v_mfma_f32_16x16x32_bf16 v[124:127], a[92:95], v[156:159], v[124:127]
    buffer_load_dwordx4 v168, s[36:39], s9 offen lds
    v_mul_f32 v185, v198, v13
    v_mfma_f32_16x16x32_bf16 v[120:123], a[88:91], v[156:159], v[120:123]
    s_add_u32 m0, s81, 49152
    s_add_u32 s9, s77, 229376
    v_mul_f32 v186, v198, v14
    v_mul_f32 v187, v198, v15
    v_mfma_f32_16x16x32_bf16 v[116:119], a[84:87], v[156:159], v[116:119]
    buffer_load_dwordx4 v168, s[36:39], s9 offen lds
    s_waitcnt vmcnt(21) lgkmcnt(0)
    v_mfma_f32_16x16x32_bf16 v[112:115], a[80:83], v[156:159], v[112:115]
    s_barrier
    v_mfma_f32_16x16x32_bf16 v[64:67], v[128:131], a[96:99], v[64:67]
    ds_read_b64_tr_b16 v[144:145], v161 offset:40960
    s_add_u32 m0, s59, 32768
    v_exp_f32 v184, v184
    v_mul_f32 v188, v198, v28
    v_mfma_f32_16x16x32_bf16 v[68:71], v[128:131], a[100:103], v[68:71]
    buffer_load_dwordx4 v166, s[32:35], s56 offen offset:0 lds
    v_readlane_b32 s57, v177, 29
    v_mfma_f32_16x16x32_bf16 v[72:75], v[128:131], a[104:107], v[72:75]
    ds_read_b64_tr_b16 v[146:147], v161 offset:41472
    v_mul_f32 v44, v12, v44
    v_exp_f32 v185, v185
    v_mfma_f32_16x16x32_bf16 v[76:79], v[128:131], a[108:111], v[76:79]
    ds_read_b64_tr_b16 v[148:149], v162 offset:40960
    v_mul_f32 v189, v198, v29
    v_mul_f32 v45, v13, v45
    v_mfma_f32_16x16x32_bf16 v[92:95], v[132:135], a[108:111], v[92:95]
    v_exp_f32 v186, v186
    v_mul_f32 v190, v198, v30
    v_mul_f32 v46, v14, v46
    v_exp_f32 v187, v187
    v_mfma_f32_16x16x32_bf16 v[88:91], v[132:135], a[104:107], v[88:91]
    ds_read_b64_tr_b16 v[150:151], v162 offset:41472
    v_mul_f32 v191, v198, v31
    v_mul_f32 v47, v15, v47
    v_mfma_f32_16x16x32_bf16 v[84:87], v[132:135], a[100:103], v[84:87]
    ds_read_b64_tr_b16 v[152:153], v161 offset:45056
    v_exp_f32 v188, v188
    v_fma_f32 v184, v184, v199, v199
    v_mul_f32 v60, v28, v60
    v_mfma_f32_16x16x32_bf16 v[80:83], v[132:135], a[96:99], v[80:83]
    buffer_load_dwordx4 v167, s[32:35], s56 offen offset:1024 lds
    v_mfma_f32_16x16x32_bf16 v[96:99], a[96:99], v[136:139], v[96:99]
    ds_read_b64_tr_b16 v[154:155], v161 offset:45568
    v_exp_f32 v189, v189
    v_fma_f32 v185, v185, v199, v199
    v_mul_f32 v61, v29, v61
    v_mfma_f32_16x16x32_bf16 v[100:103], a[100:103], v[136:139], v[100:103]
    ds_read_b64_tr_b16 v[156:157], v162 offset:45056
    v_exp_f32 v190, v190
    v_fma_f32 v186, v186, v199, v199
    v_mul_f32 v62, v30, v62
    v_mfma_f32_16x16x32_bf16 v[104:107], a[104:107], v[136:139], v[104:107]
    v_exp_f32 v191, v191
    v_fma_f32 v187, v187, v199, v199
    v_mul_f32 v63, v31, v63
    v_mfma_f32_16x16x32_bf16 v[108:111], a[108:111], v[136:139], v[108:111]
    ds_read_b64_tr_b16 v[158:159], v162 offset:45568
    s_add_u32 m0, s78, 65536
    s_add_u32 s9, s74, 262144
    v_rcp_f32 v184, v184
    v_mfma_f32_16x16x32_bf16 v[124:127], a[108:111], v[140:143], v[124:127]
    buffer_load_dwordx4 v168, s[36:39], s9 offen lds
    v_fma_f32 v188, v188, v199, v199
    v_mfma_f32_16x16x32_bf16 v[120:123], a[104:107], v[140:143], v[120:123]
    s_add_u32 m0, s79, 65536
    s_add_u32 s9, s75, 262144
    v_rcp_f32 v185, v185
    v_mfma_f32_16x16x32_bf16 v[116:119], a[100:103], v[140:143], v[116:119]
    buffer_load_dwordx4 v168, s[36:39], s9 offen lds
    s_waitcnt vmcnt(20) lgkmcnt(0)
    v_mfma_f32_16x16x32_bf16 v[112:115], a[96:99], v[140:143], v[112:115]
    s_barrier
    v_mfma_f32_16x16x32_bf16 v[64:67], v[144:147], a[112:115], v[64:67]
    ds_read_b64_tr_b16 v[128:129], v161 offset:0
    s_add_u32 m0, s59, 40960
    v_fma_f32 v189, v189, v199, v199
    v_rcp_f32 v186, v186
    v_mfma_f32_16x16x32_bf16 v[68:71], v[144:147], a[116:119], v[68:71]
    buffer_load_dwordx4 v166, s[32:35], s57 offen offset:0 lds
    v_readlane_b32 s56, v177, 30
    v_mfma_f32_16x16x32_bf16 v[72:75], v[144:147], a[120:123], v[72:75]
    ds_read_b64_tr_b16 v[130:131], v161 offset:512
    v_fma_f32 v190, v190, v199, v199
    v_rcp_f32 v187, v187
    v_mfma_f32_16x16x32_bf16 v[76:79], v[144:147], a[124:127], v[76:79]
    ds_read_b64_tr_b16 v[132:133], v162 offset:0
    v_fma_f32 v191, v191, v199, v199
    v_rcp_f32 v188, v188
    v_mfma_f32_16x16x32_bf16 v[92:95], v[148:151], a[124:127], v[92:95]
    v_mul_f32 v44, v44, v184
    v_rcp_f32 v189, v189
    v_mul_f32 v45, v45, v185
    v_mfma_f32_16x16x32_bf16 v[88:91], v[148:151], a[120:123], v[88:91]
    ds_read_b64_tr_b16 v[134:135], v162 offset:512
    v_rcp_f32 v190, v190
    v_mul_f32 v46, v46, v186
    v_mfma_f32_16x16x32_bf16 v[84:87], v[148:151], a[116:119], v[84:87]
    ds_read_b64_tr_b16 v[136:137], v161 offset:4096
    v_rcp_f32 v191, v191
    v_mul_f32 v47, v47, v187
    v_cvt_pk_bf16_f32 v12, v44, v45
    v_cvt_pk_bf16_f32 v13, v46, v47
    v_mfma_f32_16x16x32_bf16 v[80:83], v[148:151], a[112:115], v[80:83]
    buffer_load_dwordx4 v167, s[32:35], s57 offen offset:1024 lds
    v_mfma_f32_16x16x32_bf16 v[96:99], a[112:115], v[152:155], v[96:99]
    ds_read_b64_tr_b16 v[138:139], v161 offset:4608
    v_mul_f32 v60, v60, v188
    v_mul_f32 v61, v61, v189
    v_mul_f32 v62, v62, v190
    v_mul_f32 v63, v63, v191
    v_mfma_f32_16x16x32_bf16 v[100:103], a[116:119], v[152:155], v[100:103]
    ds_read_b64_tr_b16 v[140:141], v162 offset:4096
    v_cvt_pk_bf16_f32 v14, v60, v61
    v_cvt_pk_bf16_f32 v15, v62, v63
    v_mfma_f32_16x16x32_bf16 v[104:107], a[120:123], v[152:155], v[104:107]
    buffer_store_dwordx4 v[12:15], v160, s[44:47], s11 offen offset:3072 sc1
    v_mul_f32 v193, 0xbf317218, v192
    v_mul_f32 v195, 0xbf317218, v194
    v_mfma_f32_16x16x32_bf16 v[108:111], a[124:127], v[152:155], v[108:111]
    ds_read_b64_tr_b16 v[142:143], v162 offset:4608
    s_add_u32 m0, s80, 65536
    s_add_u32 s9, s76, 262144
    v_mul_f32 v197, 0xbf317218, v196
    v_mfma_f32_16x16x32_bf16 v[124:127], a[124:127], v[156:159], v[124:127]
    buffer_load_dwordx4 v168, s[36:39], s9 offen lds
    v_mul_f32 v199, 0xbf317218, v198
    v_mfma_f32_16x16x32_bf16 v[120:123], a[120:123], v[156:159], v[120:123]
    s_add_u32 m0, s81, 65536
    s_add_u32 s9, s77, 262144
    v_mov_b32 v1, 0
    v_mov_b32 v3, 0
    v_mfma_f32_16x16x32_bf16 v[116:119], a[116:119], v[156:159], v[116:119]
    buffer_load_dwordx4 v168, s[36:39], s9 offen lds
    s_waitcnt vmcnt(21) lgkmcnt(0)
    v_mfma_f32_16x16x32_bf16 v[112:115], a[112:115], v[156:159], v[112:115]
    s_barrier
    v_mfma_f32_16x16x32_bf16 v[64:67], v[128:131], a[128:131], v[64:67]
    ds_read_b64_tr_b16 v[144:145], v161 offset:8192
    s_add_u32 m0, s59, 0
    v_mov_b32 v5, 0
    v_mov_b32 v7, 0
    v_mfma_f32_16x16x32_bf16 v[68:71], v[128:131], a[132:135], v[68:71]
    buffer_load_dwordx4 v166, s[32:35], s56 offen offset:0 lds
    v_readlane_b32 s57, v177, 31
    v_mfma_f32_16x16x32_bf16 v[72:75], v[128:131], a[136:139], v[72:75]
    ds_read_b64_tr_b16 v[146:147], v161 offset:8704
    v_mov_b32 v8, 0x3e803e80
    v_mov_b32 v9, 0x3e803e80
    v_and_b32 v12, 0xffff0000, v193
    v_mfma_f32_16x16x32_bf16 v[76:79], v[128:131], a[140:143], v[76:79]
    ds_read_b64_tr_b16 v[148:149], v162 offset:8192
    v_and_b32 v13, 0xffff0000, v195
    v_and_b32 v14, 0xffff0000, v197
    v_and_b32 v15, 0xffff0000, v199
    v_mfma_f32_16x16x32_bf16 v[92:95], v[132:135], a[140:143], v[92:95]
    v_sub_f32 v16, v193, v12
    v_sub_f32 v17, v195, v13
    v_sub_f32 v18, v197, v14
    v_sub_f32 v19, v199, v15
    v_mfma_f32_16x16x32_bf16 v[88:91], v[132:135], a[136:139], v[88:91]
    ds_read_b64_tr_b16 v[150:151], v162 offset:8704
    v_cvt_pk_bf16_f32 v0, v12, v16
    v_cvt_pk_bf16_f32 v2, v13, v17
    v_cvt_pk_bf16_f32 v4, v14, v18
    v_mfma_f32_16x16x32_bf16 v[84:87], v[132:135], a[132:135], v[84:87]
    ds_read_b64_tr_b16 v[152:153], v161 offset:12288
    v_cvt_pk_bf16_f32 v6, v15, v19
    v_mul_f32 v192, 0xbe800000, v192
    v_mul_f32 v194, 0xbe800000, v194
    v_mfma_f32_16x16x32_bf16 v[80:83], v[132:135], a[128:131], v[80:83]
    buffer_load_dwordx4 v167, s[32:35], s56 offen offset:1024 lds
    v_mul_f32 v196, 0xbe800000, v196
    v_mfma_f32_16x16x32_bf16 v[96:99], a[128:131], v[136:139], v[96:99]
    ds_read_b64_tr_b16 v[154:155], v161 offset:12800
    v_mul_f32 v198, 0xbe800000, v198
    v_mfma_f32_16x16x32_bf16 v[100:103], a[132:135], v[136:139], v[100:103]
    ds_read_b64_tr_b16 v[156:157], v162 offset:12288
    v_mfma_f32_16x16x16_bf16 v[48:51], v[0:1], v[8:9], 0
    v_mfma_f32_16x16x32_bf16 v[104:107], a[136:139], v[136:139], v[104:107]
    v_mfma_f32_16x16x16_bf16 v[52:55], v[2:3], v[8:9], 0
    v_mfma_f32_16x16x16_bf16 v[56:59], v[4:5], v[8:9], 0
    v_mfma_f32_16x16x32_bf16 v[108:111], a[140:143], v[136:139], v[108:111]
    ds_read_b64_tr_b16 v[158:159], v162 offset:12800
    s_add_u32 m0, s78, 81920
    s_add_u32 s9, s74, 294912
    v_mfma_f32_16x16x32_bf16 v[124:127], a[140:143], v[140:143], v[124:127]
    buffer_load_dwordx4 v168, s[36:39], s9 offen lds
    v_mfma_f32_16x16x32_bf16 v[120:123], a[136:139], v[140:143], v[120:123]
    s_add_u32 m0, s79, 81920
    s_add_u32 s9, s75, 294912
    v_mfma_f32_16x16x16_bf16 v[60:63], v[6:7], v[8:9], 0
    v_mfma_f32_16x16x32_bf16 v[116:119], a[132:135], v[140:143], v[116:119]
    buffer_load_dwordx4 v168, s[36:39], s9 offen lds
    s_waitcnt vmcnt(20) lgkmcnt(0)
    v_mfma_f32_16x16x32_bf16 v[112:115], a[128:131], v[140:143], v[112:115]
    s_barrier
    v_mfma_f32_16x16x32_bf16 v[64:67], v[144:147], a[144:147], v[64:67]
    ds_read_b64_tr_b16 v[128:129], v161 offset:16384
    s_add_u32 m0, s59, 8192
    v_mfma_f32_16x16x32_bf16 v[68:71], v[144:147], a[148:151], v[68:71]
    buffer_load_dwordx4 v166, s[32:35], s57 offen offset:0 lds
    v_readlane_b32 s56, v177, 32
    v_mfma_f32_16x16x32_bf16 v[72:75], v[144:147], a[152:155], v[72:75]
    ds_read_b64_tr_b16 v[130:131], v161 offset:16896
    v_mfma_f32_16x16x32_bf16 v[76:79], v[144:147], a[156:159], v[76:79]
    ds_read_b64_tr_b16 v[132:133], v162 offset:16384
    v_mfma_f32_16x16x32_bf16 v[92:95], v[148:151], a[156:159], v[92:95]
    v_mfma_f32_16x16x32_bf16 v[88:91], v[148:151], a[152:155], v[88:91]
    ds_read_b64_tr_b16 v[134:135], v162 offset:16896
    v_mfma_f32_16x16x32_bf16 v[84:87], v[148:151], a[148:151], v[84:87]
    ds_read_b64_tr_b16 v[136:137], v161 offset:20480
    v_mfma_f32_16x16x32_bf16 v[80:83], v[148:151], a[144:147], v[80:83]
    buffer_load_dwordx4 v167, s[32:35], s57 offen offset:1024 lds
    v_mfma_f32_16x16x32_bf16 v[96:99], a[144:147], v[152:155], v[96:99]
    ds_read_b64_tr_b16 v[138:139], v161 offset:20992
    v_mfma_f32_16x16x32_bf16 v[100:103], a[148:151], v[152:155], v[100:103]
    ds_read_b64_tr_b16 v[140:141], v162 offset:20480
    v_mfma_f32_16x16x32_bf16 v[104:107], a[152:155], v[152:155], v[104:107]
    v_mfma_f32_16x16x32_bf16 v[108:111], a[156:159], v[152:155], v[108:111]
    ds_read_b64_tr_b16 v[142:143], v162 offset:20992
    s_add_u32 m0, s80, 81920
    s_add_u32 s9, s76, 294912
    v_mfma_f32_16x16x32_bf16 v[124:127], a[156:159], v[156:159], v[124:127]
    buffer_load_dwordx4 v168, s[36:39], s9 offen lds
    v_mfma_f32_16x16x32_bf16 v[120:123], a[152:155], v[156:159], v[120:123]
    s_add_u32 m0, s81, 81920
    s_add_u32 s9, s77, 294912
    v_mfma_f32_16x16x32_bf16 v[116:119], a[148:151], v[156:159], v[116:119]
    buffer_load_dwordx4 v168, s[36:39], s9 offen lds
    s_waitcnt vmcnt(20) lgkmcnt(0)
    v_mfma_f32_16x16x32_bf16 v[112:115], a[144:147], v[156:159], v[112:115]
    s_barrier
    v_mfma_f32_16x16x32_bf16 v[64:67], v[128:131], a[160:163], v[64:67]
    ds_read_b64_tr_b16 v[144:145], v161 offset:24576
    v_mfma_f32_16x16x32_bf16 v[68:71], v[128:131], a[164:167], v[68:71]
    v_mfma_f32_16x16x32_bf16 v[72:75], v[128:131], a[168:171], v[72:75]
    ds_read_b64_tr_b16 v[146:147], v161 offset:25088
    v_mfma_f32_16x16x32_bf16 v[76:79], v[128:131], a[172:175], v[76:79]
    ds_read_b64_tr_b16 v[148:149], v162 offset:24576
    s_add_u32 m0, s59, 16384
    v_mfma_f32_16x16x32_bf16 v[92:95], v[132:135], a[172:175], v[92:95]
    buffer_load_dwordx4 v166, s[32:35], s56 offen offset:0 lds
    v_readlane_b32 s57, v177, 33
    v_mfma_f32_16x16x32_bf16 v[88:91], v[132:135], a[168:171], v[88:91]
    ds_read_b64_tr_b16 v[150:151], v162 offset:25088
    v_mfma_f32_16x16x32_bf16 v[84:87], v[132:135], a[164:167], v[84:87]
    ds_read_b64_tr_b16 v[152:153], v161 offset:28672
    v_mfma_f32_16x16x32_bf16 v[80:83], v[132:135], a[160:163], v[80:83]
    v_mfma_f32_16x16x32_bf16 v[96:99], a[160:163], v[136:139], v[96:99]
    ds_read_b64_tr_b16 v[154:155], v161 offset:29184
    v_mfma_f32_16x16x32_bf16 v[100:103], a[164:167], v[136:139], v[100:103]
    ds_read_b64_tr_b16 v[156:157], v162 offset:28672
    v_mfma_f32_16x16x32_bf16 v[104:107], a[168:171], v[136:139], v[104:107]
    v_mfma_f32_16x16x32_bf16 v[108:111], a[172:175], v[136:139], v[108:111]
    ds_read_b64_tr_b16 v[158:159], v162 offset:29184
    v_mfma_f32_16x16x32_bf16 v[124:127], a[172:175], v[140:143], v[124:127]
    v_mfma_f32_16x16x32_bf16 v[120:123], a[168:171], v[140:143], v[120:123]
    buffer_load_dwordx4 v167, s[32:35], s56 offen offset:1024 lds
    v_mfma_f32_16x16x32_bf16 v[116:119], a[164:167], v[140:143], v[116:119]
    s_waitcnt vmcnt(17) lgkmcnt(0)
    v_mfma_f32_16x16x32_bf16 v[112:115], a[160:163], v[140:143], v[112:115]
    s_barrier
    v_mfma_f32_16x16x32_bf16 v[64:67], v[144:147], a[176:179], v[64:67]
    ds_read_b64_tr_b16 v[128:129], v161 offset:32768
    v_mfma_f32_16x16x32_bf16 v[68:71], v[144:147], a[180:183], v[68:71]
    v_mfma_f32_16x16x32_bf16 v[72:75], v[144:147], a[184:187], v[72:75]
    ds_read_b64_tr_b16 v[130:131], v161 offset:33280
    v_mfma_f32_16x16x32_bf16 v[76:79], v[144:147], a[188:191], v[76:79]
    ds_read_b64_tr_b16 v[132:133], v162 offset:32768
    s_add_u32 m0, s59, 24576
    v_mfma_f32_16x16x32_bf16 v[92:95], v[148:151], a[188:191], v[92:95]
    buffer_load_dwordx4 v166, s[32:35], s57 offen offset:0 lds
    v_readlane_b32 s56, v177, 34
    v_mfma_f32_16x16x32_bf16 v[88:91], v[148:151], a[184:187], v[88:91]
    ds_read_b64_tr_b16 v[134:135], v162 offset:33280
    v_mfma_f32_16x16x32_bf16 v[84:87], v[148:151], a[180:183], v[84:87]
    ds_read_b64_tr_b16 v[136:137], v161 offset:36864
    v_mfma_f32_16x16x32_bf16 v[80:83], v[148:151], a[176:179], v[80:83]
    v_mfma_f32_16x16x32_bf16 v[96:99], a[176:179], v[152:155], v[96:99]
    ds_read_b64_tr_b16 v[138:139], v161 offset:37376
    v_mfma_f32_16x16x32_bf16 v[100:103], a[180:183], v[152:155], v[100:103]
    ds_read_b64_tr_b16 v[140:141], v162 offset:36864
    v_mfma_f32_16x16x32_bf16 v[104:107], a[184:187], v[152:155], v[104:107]
    buffer_load_dwordx4 v167, s[32:35], s57 offen offset:1024 lds
    v_mfma_f32_16x16x32_bf16 v[108:111], a[188:191], v[152:155], v[108:111]
    ds_read_b64_tr_b16 v[142:143], v162 offset:37376
    v_mfma_f32_16x16x32_bf16 v[124:127], a[188:191], v[156:159], v[124:127]
    v_mfma_f32_16x16x32_bf16 v[120:123], a[184:187], v[156:159], v[120:123]
    s_waitcnt vmcnt(14)
    buffer_store_dword v169, v169, s[44:47], s65 offen offset:0 sc1
    v_mfma_f32_16x16x32_bf16 v[116:119], a[180:183], v[156:159], v[116:119]
    s_waitcnt lgkmcnt(0)
    v_mfma_f32_16x16x32_bf16 v[112:115], a[176:179], v[156:159], v[112:115]
    s_barrier
    v_mfma_f32_16x16x32_bf16 v[64:67], v[128:131], a[192:195], v[64:67]
    ds_read_b64_tr_b16 v[144:145], v161 offset:40960
    v_mfma_f32_16x16x32_bf16 v[68:71], v[128:131], a[196:199], v[68:71]
    v_mfma_f32_16x16x32_bf16 v[72:75], v[128:131], a[200:203], v[72:75]
    ds_read_b64_tr_b16 v[146:147], v161 offset:41472
    v_mfma_f32_16x16x32_bf16 v[76:79], v[128:131], a[204:207], v[76:79]
    ds_read_b64_tr_b16 v[148:149], v162 offset:40960
    s_add_u32 m0, s59, 32768
    v_mfma_f32_16x16x32_bf16 v[92:95], v[132:135], a[204:207], v[92:95]
    buffer_load_dwordx4 v166, s[32:35], s56 offen offset:0 lds
    v_readlane_b32 s57, v177, 35
    v_mfma_f32_16x16x32_bf16 v[88:91], v[132:135], a[200:203], v[88:91]
    ds_read_b64_tr_b16 v[150:151], v162 offset:41472
    v_mfma_f32_16x16x32_bf16 v[84:87], v[132:135], a[196:199], v[84:87]
    ds_read_b64_tr_b16 v[152:153], v161 offset:45056
    v_mfma_f32_16x16x32_bf16 v[80:83], v[132:135], a[192:195], v[80:83]
    v_mfma_f32_16x16x32_bf16 v[96:99], a[192:195], v[136:139], v[96:99]
    ds_read_b64_tr_b16 v[154:155], v161 offset:45568
    v_mfma_f32_16x16x32_bf16 v[100:103], a[196:199], v[136:139], v[100:103]
    ds_read_b64_tr_b16 v[156:157], v162 offset:45056
    v_mfma_f32_16x16x32_bf16 v[104:107], a[200:203], v[136:139], v[104:107]
    v_mfma_f32_16x16x32_bf16 v[108:111], a[204:207], v[136:139], v[108:111]
    ds_read_b64_tr_b16 v[158:159], v162 offset:45568
    v_mfma_f32_16x16x32_bf16 v[124:127], a[204:207], v[140:143], v[124:127]
    v_mfma_f32_16x16x32_bf16 v[120:123], a[200:203], v[140:143], v[120:123]
    buffer_load_dwordx4 v167, s[32:35], s56 offen offset:1024 lds
    v_mfma_f32_16x16x32_bf16 v[116:119], a[196:199], v[140:143], v[116:119]
    s_waitcnt vmcnt(13) lgkmcnt(0)
    v_mfma_f32_16x16x32_bf16 v[112:115], a[192:195], v[140:143], v[112:115]
    s_barrier
    v_mfma_f32_16x16x32_bf16 v[64:67], v[144:147], a[208:211], v[64:67]
    ds_read_b64_tr_b16 v[128:129], v161 offset:0
    v_mfma_f32_16x16x32_bf16 v[68:71], v[144:147], a[212:215], v[68:71]
    v_mfma_f32_16x16x32_bf16 v[72:75], v[144:147], a[216:219], v[72:75]
    ds_read_b64_tr_b16 v[130:131], v161 offset:512
    v_mfma_f32_16x16x32_bf16 v[76:79], v[144:147], a[220:223], v[76:79]
    ds_read_b64_tr_b16 v[132:133], v162 offset:0
    s_add_u32 m0, s59, 40960
    v_mfma_f32_16x16x32_bf16 v[92:95], v[148:151], a[220:223], v[92:95]
    buffer_load_dwordx4 v166, s[32:35], s57 offen offset:0 lds
    v_readlane_b32 s56, v177, 36
L_stub3:
    s_cbranch_execz L_tourret
    s_nop 0
    v_mfma_f32_16x16x32_bf16 v[88:91], v[148:151], a[216:219], v[88:91]
    ds_read_b64_tr_b16 v[134:135], v162 offset:512
    v_mfma_f32_16x16x32_bf16 v[84:87], v[148:151], a[212:215], v[84:87]
    ds_read_b64_tr_b16 v[136:137], v161 offset:4096
    v_mfma_f32_16x16x32_bf16 v[80:83], v[148:151], a[208:211], v[80:83]
    v_mfma_f32_16x16x32_bf16 v[96:99], a[208:211], v[152:155], v[96:99]
    ds_read_b64_tr_b16 v[138:139], v161 offset:4608
    v_mfma_f32_16x16x32_bf16 v[100:103], a[212:215], v[152:155], v[100:103]
    ds_read_b64_tr_b16 v[140:141], v162 offset:4096
    v_mfma_f32_16x16x32_bf16 v[104:107], a[216:219], v[152:155], v[104:107]
    v_mfma_f32_16x16x32_bf16 v[108:111], a[220:223], v[152:155], v[108:111]
    ds_read_b64_tr_b16 v[142:143], v162 offset:4608
    v_mfma_f32_16x16x32_bf16 v[124:127], a[220:223], v[156:159], v[124:127]
    v_mfma_f32_16x16x32_bf16 v[120:123], a[216:219], v[156:159], v[120:123]
    buffer_load_dwordx4 v167, s[32:35], s57 offen offset:1024 lds
    v_mfma_f32_16x16x32_bf16 v[116:119], a[212:215], v[156:159], v[116:119]
    s_waitcnt vmcnt(11) lgkmcnt(0)
    v_mfma_f32_16x16x32_bf16 v[112:115], a[208:211], v[156:159], v[112:115]
    s_barrier
    v_mfma_f32_16x16x32_bf16 v[64:67], v[128:131], a[224:227], v[64:67]
    ds_read_b64_tr_b16 v[144:145], v161 offset:8192
    v_mfma_f32_16x16x32_bf16 v[68:71], v[128:131], a[228:231], v[68:71]
    v_mfma_f32_16x16x32_bf16 v[72:75], v[128:131], a[232:235], v[72:75]
    ds_read_b64_tr_b16 v[146:147], v161 offset:8704
    v_mfma_f32_16x16x32_bf16 v[76:79], v[128:131], a[236:239], v[76:79]
    ds_read_b64_tr_b16 v[148:149], v162 offset:8192
    s_add_u32 m0, s59, 0
    v_mfma_f32_16x16x32_bf16 v[92:95], v[132:135], a[236:239], v[92:95]
    buffer_load_dwordx4 v166, s[32:35], s56 offen offset:0 lds
    v_readlane_b32 s57, v177, 37
    v_mfma_f32_16x16x32_bf16 v[88:91], v[132:135], a[232:235], v[88:91]
    ds_read_b64_tr_b16 v[150:151], v162 offset:8704
    v_mfma_f32_16x16x32_bf16 v[84:87], v[132:135], a[228:231], v[84:87]
    ds_read_b64_tr_b16 v[152:153], v161 offset:12288
    v_mfma_f32_16x16x32_bf16 v[80:83], v[132:135], a[224:227], v[80:83]
    v_mfma_f32_16x16x32_bf16 v[96:99], a[224:227], v[136:139], v[96:99]
    ds_read_b64_tr_b16 v[154:155], v161 offset:12800
    v_mfma_f32_16x16x32_bf16 v[100:103], a[228:231], v[136:139], v[100:103]
    ds_read_b64_tr_b16 v[156:157], v162 offset:12288
    v_mfma_f32_16x16x32_bf16 v[104:107], a[232:235], v[136:139], v[104:107]
    v_mfma_f32_16x16x32_bf16 v[108:111], a[236:239], v[136:139], v[108:111]
    ds_read_b64_tr_b16 v[158:159], v162 offset:12800
    v_mfma_f32_16x16x32_bf16 v[124:127], a[236:239], v[140:143], v[124:127]
    v_mfma_f32_16x16x32_bf16 v[120:123], a[232:235], v[140:143], v[120:123]
    buffer_load_dwordx4 v167, s[32:35], s56 offen offset:1024 lds
    v_mfma_f32_16x16x32_bf16 v[116:119], a[228:231], v[140:143], v[116:119]
    s_waitcnt vmcnt(9) lgkmcnt(0)
    v_mfma_f32_16x16x32_bf16 v[112:115], a[224:227], v[140:143], v[112:115]
    s_barrier
    v_mfma_f32_16x16x32_bf16 v[64:67], v[144:147], a[240:243], v[64:67]
    ds_read_b64_tr_b16 v[128:129], v161 offset:16384
    v_mfma_f32_16x16x32_bf16 v[68:71], v[144:147], a[244:247], v[68:71]
    v_mfma_f32_16x16x32_bf16 v[72:75], v[144:147], a[248:251], v[72:75]
    ds_read_b64_tr_b16 v[130:131], v161 offset:16896
    v_mfma_f32_16x16x32_bf16 v[76:79], v[144:147], a[252:255], v[76:79]
    ds_read_b64_tr_b16 v[132:133], v162 offset:16384
    s_add_u32 m0, s59, 8192
    v_mfma_f32_16x16x32_bf16 v[92:95], v[148:151], a[252:255], v[92:95]
    buffer_load_dwordx4 v166, s[32:35], s57 offen offset:0 lds
    v_readlane_b32 s56, v177, 38
    v_mfma_f32_16x16x32_bf16 v[88:91], v[148:151], a[248:251], v[88:91]
    ds_read_b64_tr_b16 v[134:135], v162 offset:16896
    v_mfma_f32_16x16x32_bf16 v[84:87], v[148:151], a[244:247], v[84:87]
    ds_read_b64_tr_b16 v[136:137], v161 offset:20480
    v_mfma_f32_16x16x32_bf16 v[80:83], v[148:151], a[240:243], v[80:83]
    v_mfma_f32_16x16x32_bf16 v[96:99], a[240:243], v[152:155], v[96:99]
    ds_read_b64_tr_b16 v[138:139], v161 offset:20992
    v_mfma_f32_16x16x32_bf16 v[100:103], a[244:247], v[152:155], v[100:103]
    ds_read_b64_tr_b16 v[140:141], v162 offset:20480
    v_mfma_f32_16x16x32_bf16 v[104:107], a[248:251], v[152:155], v[104:107]
    v_mfma_f32_16x16x32_bf16 v[108:111], a[252:255], v[152:155], v[108:111]
    ds_read_b64_tr_b16 v[142:143], v162 offset:20992
    v_mfma_f32_16x16x32_bf16 v[124:127], a[252:255], v[156:159], v[124:127]
    v_mfma_f32_16x16x32_bf16 v[120:123], a[248:251], v[156:159], v[120:123]
    buffer_load_dwordx4 v167, s[32:35], s57 offen offset:1024 lds
    v_mfma_f32_16x16x32_bf16 v[116:119], a[244:247], v[156:159], v[116:119]
    s_waitcnt vmcnt(9) lgkmcnt(0)
    v_mfma_f32_16x16x32_bf16 v[112:115], a[240:243], v[156:159], v[112:115]
    s_barrier
    v_mfma_f32_16x16x32_bf16 v[0:3], v[128:131], a[0:3], 0
    ds_read_b64_tr_b16 v[144:145], v161 offset:24576
    v_mul_f32 v76, v76, v199
    v_mul_f32 v77, v77, v199
    v_mul_f32 v78, v78, v199
    v_mfma_f32_16x16x32_bf16 v[4:7], v[128:131], a[4:7], 0
    v_mul_f32 v79, v79, v199
    v_mul_f32 v92, v92, v199
    v_mul_f32 v93, v93, v199
    v_mfma_f32_16x16x32_bf16 v[8:11], v[128:131], a[8:11], 0
    ds_read_b64_tr_b16 v[146:147], v161 offset:25088
    v_mul_f32 v94, v94, v199
    v_mul_f32 v95, v95, v199
    v_cvt_pk_bf16_f32 v200, v76, v77
    v_mfma_f32_16x16x32_bf16 v[12:15], v[128:131], a[12:15], 0
    ds_read_b64_tr_b16 v[148:149], v162 offset:24576
    s_add_u32 m0, s59, 16384
    v_cvt_pk_bf16_f32 v201, v78, v79
    v_cvt_pk_bf16_f32 v202, v92, v93
    v_mfma_f32_16x16x32_bf16 v[28:31], v[132:135], a[12:15], 0
    buffer_load_dwordx4 v166, s[32:35], s56 offen offset:0 lds
    v_readlane_b32 s57, v177, 39
    v_mfma_f32_16x16x32_bf16 v[24:27], v[132:135], a[8:11], 0
    ds_read_b64_tr_b16 v[150:151], v162 offset:25088
    v_cvt_pk_bf16_f32 v203, v94, v95
    v_mfma_f32_16x16x32_bf16 v[20:23], v[132:135], a[4:7], 0
    ds_read_b64_tr_b16 v[152:153], v161 offset:28672
    v_mfma_f32_16x16x32_bf16 v[16:19], v[132:135], a[0:3], 0
    buffer_store_dwordx4 v[200:203], v160, s[44:47], s69 offen sc1
    v_mul_f32 v108, v108, v60
    v_mul_f32 v109, v109, v61
    v_mfma_f32_16x16x32_bf16 v[0:3], v[136:139], a[16:19], v[0:3]
    ds_read_b64_tr_b16 v[154:155], v161 offset:29184
    v_mul_f32 v110, v110, v62
    v_mul_f32 v111, v111, v63
    v_mul_f32 v124, v124, v60
    v_mfma_f32_16x16x32_bf16 v[4:7], v[136:139], a[20:23], v[4:7]
    ds_read_b64_tr_b16 v[156:157], v162 offset:28672
    v_mul_f32 v125, v125, v61
    v_mul_f32 v126, v126, v62
    v_mul_f32 v127, v127, v63
    v_mfma_f32_16x16x32_bf16 v[8:11], v[136:139], a[24:27], v[8:11]
    v_cvt_pk_bf16_f32 v76, v108, v109
    v_cvt_pk_bf16_f32 v77, v110, v111
    v_cvt_pk_bf16_f32 v78, v124, v125
    v_mfma_f32_16x16x32_bf16 v[12:15], v[136:139], a[28:31], v[12:15]
    ds_read_b64_tr_b16 v[158:159], v162 offset:29184
    v_cvt_pk_bf16_f32 v79, v126, v127
    v_mfma_f32_16x16x32_bf16 v[28:31], v[140:143], a[28:31], v[28:31]
    buffer_store_dwordx4 v[76:79], v160, s[44:47], s69 offen offset:1024 sc1
    v_mul_f32 v96, v96, v48
    v_mul_f32 v97, v97, v49
    v_mfma_f32_16x16x32_bf16 v[24:27], v[140:143], a[24:27], v[24:27]
    buffer_load_dwordx4 v167, s[32:35], s56 offen offset:1024 lds
    v_mfma_f32_16x16x32_bf16 v[20:23], v[140:143], a[20:23], v[20:23]
    v_mul_f32 v98, v98, v50
    v_mul_f32 v99, v99, v51
    s_waitcnt vmcnt(10) lgkmcnt(0)
    v_mfma_f32_16x16x32_bf16 v[16:19], v[140:143], a[16:19], v[16:19]
    s_barrier
    v_mfma_f32_16x16x32_bf16 v[0:3], v[144:147], a[32:35], v[0:3]
    s_buffer_load_dwordx8 s[16:23], s[44:47], s66 offset:0 glc
    ds_read_b64_tr_b16 v[128:129], v161 offset:32768
    v_mul_f32 v112, v112, v48
    v_mul_f32 v113, v113, v49
    v_mul_f32 v114, v114, v50
    v_mfma_f32_16x16x32_bf16 v[4:7], v[144:147], a[36:39], v[4:7]
    v_mul_f32 v115, v115, v51
    v_mul_f32 v100, v100, v52
    v_mul_f32 v101, v101, v53
    v_mfma_f32_16x16x32_bf16 v[8:11], v[144:147], a[40:43], v[8:11]
    ds_read_b64_tr_b16 v[130:131], v161 offset:33280
    v_mul_f32 v102, v102, v54
    v_mul_f32 v103, v103, v55
    v_mul_f32 v116, v116, v52
    v_mfma_f32_16x16x32_bf16 v[12:15], v[144:147], a[44:47], v[12:15]
    ds_read_b64_tr_b16 v[132:133], v162 offset:32768
    s_add_u32 m0, s59, 24576
    v_mul_f32 v117, v117, v53
    v_mfma_f32_16x16x32_bf16 v[28:31], v[148:151], a[44:47], v[28:31]
    buffer_load_dwordx4 v166, s[32:35], s57 offen offset:0 lds
    v_mfma_f32_16x16x32_bf16 v[24:27], v[148:151], a[40:43], v[24:27]
    ds_read_b64_tr_b16 v[134:135], v162 offset:33280
    v_mul_f32 v118, v118, v54
    v_mul_f32 v119, v119, v55
    v_mul_f32 v104, v104, v56
    v_mfma_f32_16x16x32_bf16 v[20:23], v[148:151], a[36:39], v[20:23]
    ds_read_b64_tr_b16 v[136:137], v161 offset:36864
    v_mul_f32 v105, v105, v57
    v_mul_f32 v106, v106, v58
    v_mfma_f32_16x16x32_bf16 v[16:19], v[148:151], a[32:35], v[16:19]
    v_mul_f32 v107, v107, v59
    v_mul_f32 v120, v120, v56
    v_mul_f32 v121, v121, v57
    v_mul_f32 v122, v122, v58
    v_mfma_f32_16x16x32_bf16 v[0:3], v[152:155], a[48:51], v[0:3]
    ds_read_b64_tr_b16 v[138:139], v161 offset:37376
    v_mul_f32 v123, v123, v59
    v_cvt_pk_bf16_f32 v38, v96, v97
    v_mfma_f32_16x16x32_bf16 v[4:7], v[152:155], a[52:55], v[4:7]
    ds_read_b64_tr_b16 v[140:141], v162 offset:36864
    v_cvt_pk_bf16_f32 v39, v98, v99
    v_cvt_pk_bf16_f32 v36, v100, v101
    v_cvt_pk_bf16_f32 v37, v102, v103
    v_mfma_f32_16x16x32_bf16 v[8:11], v[152:155], a[56:59], v[8:11]
    v_cvt_pk_bf16_f32 v34, v104, v105
    v_cvt_pk_bf16_f32 v35, v106, v107
    v_cvt_pk_bf16_f32 v32, v108, v109
    v_cvt_pk_bf16_f32 v33, v110, v111
    v_mfma_f32_16x16x32_bf16 v[12:15], v[152:155], a[60:63], v[12:15]
    ds_read_b64_tr_b16 v[142:143], v162 offset:37376
    ds_read_b32 v170, v160
    v_cvt_pk_bf16_f32 v44, v112, v113
    v_cvt_pk_bf16_f32 v45, v114, v115
    v_mfma_f32_16x16x32_bf16 v[28:31], v[156:159], a[60:63], v[28:31]
    ds_read_b32 v170, v160
    v_cvt_pk_bf16_f32 v46, v116, v117
    v_cvt_pk_bf16_f32 v47, v118, v119
    v_cvt_pk_bf16_f32 v48, v120, v121
    v_cvt_pk_bf16_f32 v49, v122, v123
    v_mfma_f32_16x16x32_bf16 v[24:27], v[156:159], a[56:59], v[24:27]
    buffer_load_dwordx4 v167, s[32:35], s57 offen offset:1024 lds
    v_mfma_f32_16x16x32_bf16 v[20:23], v[156:159], a[52:55], v[20:23]
    v_cvt_pk_bf16_f32 v50, v124, v125
    v_cvt_pk_bf16_f32 v51, v126, v127
    s_waitcnt vmcnt(10) lgkmcnt(2)
    v_mfma_f32_16x16x32_bf16 v[16:19], v[156:159], a[48:51], v[16:19]
    s_barrier
    v_mfma_f32_16x16x32_bf16 v[0:3], v[128:131], a[64:67], v[0:3]
    ds_read_b64_tr_b16 v[144:145], v161 offset:40960
    v_mul_f32 v64, v64, v193
    v_mul_f32 v65, v65, v193
    v_mul_f32 v66, v66, v193
    v_mfma_f32_16x16x32_bf16 v[4:7], v[128:131], a[68:71], v[4:7]
    v_mul_f32 v67, v67, v193
    v_cvt_pk_bf16_f32 v52, v64, v65
    v_cvt_pk_bf16_f32 v53, v66, v67
    v_mul_f32 v68, v68, v195
    v_mfma_f32_16x16x32_bf16 v[8:11], v[128:131], a[72:75], v[8:11]
    ds_read_b64_tr_b16 v[146:147], v161 offset:41472
    v_mul_f32 v69, v69, v195
    v_mul_f32 v70, v70, v195
    v_mfma_f32_16x16x32_bf16 v[12:15], v[128:131], a[76:79], v[12:15]
    ds_read_b64_tr_b16 v[148:149], v162 offset:40960
    v_mul_f32 v71, v71, v195
    v_cvt_pk_bf16_f32 v56, v68, v69
    v_cvt_pk_bf16_f32 v57, v70, v71
    v_mfma_f32_16x16x32_bf16 v[28:31], v[132:135], a[76:79], v[28:31]
    buffer_load_dword v172, v179, s[36:39], s73 offen offset:384
    v_mfma_f32_16x16x32_bf16 v[24:27], v[132:135], a[72:75], v[24:27]
    ds_read_b64_tr_b16 v[150:151], v162 offset:41472
    v_mul_f32 v72, v72, v197
    v_mul_f32 v73, v73, v197
    v_mul_f32 v74, v74, v197
    v_mfma_f32_16x16x32_bf16 v[20:23], v[132:135], a[68:71], v[20:23]
    ds_read_b64_tr_b16 v[152:153], v161 offset:45056
    v_mul_f32 v75, v75, v197
    v_cvt_pk_bf16_f32 v60, v72, v73
    v_cvt_pk_bf16_f32 v61, v74, v75
    v_mfma_f32_16x16x32_bf16 v[16:19], v[132:135], a[64:67], v[16:19]
    v_mul_f32 v80, v80, v193
    v_mul_f32 v81, v81, v193
    v_mul_f32 v82, v82, v193
    v_mfma_f32_16x16x32_bf16 v[0:3], v[136:139], a[80:83], v[0:3]
    ds_read_b64_tr_b16 v[154:155], v161 offset:45568
    v_mul_f32 v83, v83, v193
    v_cvt_pk_bf16_f32 v54, v80, v81
    v_cvt_pk_bf16_f32 v55, v82, v83
    v_mfma_f32_16x16x32_bf16 v[4:7], v[136:139], a[84:87], v[4:7]
    ds_read_b64_tr_b16 v[156:157], v162 offset:45056
    v_mul_f32 v84, v84, v195
    v_mul_f32 v85, v85, v195
    v_mul_f32 v86, v86, v195
    v_mfma_f32_16x16x32_bf16 v[8:11], v[136:139], a[88:91], v[8:11]
    buffer_load_dword v173, v179, s[40:43], s86 offen offset:384
    v_mfma_f32_16x16x32_bf16 v[12:15], v[136:139], a[92:95], v[12:15]
    ds_read_b64_tr_b16 v[158:159], v162 offset:45568
    ds_read_b32 v170, v160
    v_mul_f32 v87, v87, v195
    v_cvt_pk_bf16_f32 v58, v84, v85
    v_cvt_pk_bf16_f32 v59, v86, v87
    v_mfma_f32_16x16x32_bf16 v[28:31], v[140:143], a[92:95], v[28:31]
    ds_read_b32 v170, v160
    v_mul_f32 v88, v88, v197
    v_mul_f32 v89, v89, v197
    v_mul_f32 v90, v90, v197
    v_mfma_f32_16x16x32_bf16 v[24:27], v[140:143], a[88:91], v[24:27]
    s_waitcnt vmcnt(5)
    buffer_store_dword v169, v169, s[44:47], s65 offen offset:640 sc1
    v_mfma_f32_16x16x32_bf16 v[20:23], v[140:143], a[84:87], v[20:23]
    v_mul_f32 v91, v91, v197
    v_cvt_pk_bf16_f32 v62, v88, v89
    v_cvt_pk_bf16_f32 v63, v90, v91
    s_waitcnt lgkmcnt(2)
    v_mfma_f32_16x16x32_bf16 v[16:19], v[140:143], a[80:83], v[16:19]
    s_barrier
    v_mfma_f32_16x16x32_bf16 v[0:3], v[144:147], a[96:99], v[0:3]
    s_waitcnt lgkmcnt(0)
    s_and_b64 s[16:17], s[16:17], s[20:21]
    s_and_b64 s[18:19], s[18:19], s[22:23]
    s_and_b64 s[16:17], s[16:17], s[18:19]
    s_and_b32 s16, s16, s17
    s_cmp_eq_u32 s16, 64
    s_cbranch_scc0 L_try2
L_ok2:
    ds_read_b64_tr_b16 v[128:129], v161 offset:0
    s_add_u32 s10, s71, 0
    v_mov_b32 v116, 0xf149f2ca
    v_mfma_f32_16x16x32_bf16 v[4:7], v[144:147], a[100:103], v[4:7]
    buffer_load_dwordx4 a[0:3], v160, s[44:47], s10 offen offset:0 sc1
    v_mfma_f32_16x16x32_bf16 v[8:11], v[144:147], a[104:107], v[8:11]
    ds_read_b64_tr_b16 v[130:131], v161 offset:512
    s_mov_b32 vcc_lo, 0xaaafaaaa
    s_mov_b32 vcc_hi, 0xafffaaff
    v_cndmask_b32 v96, 0, v116, vcc
    v_mfma_f32_16x16x32_bf16 v[12:15], v[144:147], a[108:111], v[12:15]
    ds_read_b64_tr_b16 v[132:133], v162 offset:0
    s_mov_b32 vcc_lo, 0xfffaffff
    s_mov_b32 vcc_hi, 0xfaaaffaa
    v_cndmask_b32 v100, 0, v116, vcc
    v_mfma_f32_16x16x32_bf16 v[28:31], v[148:151], a[108:111], v[28:31]
    s_mov_b32 vcc_lo, 0x555f5555
    s_mov_b32 vcc_hi, 0x5fff55ff
    v_cndmask_b32 v97, 0, v116, vcc
    v_mfma_f32_16x16x32_bf16 v[24:27], v[148:151], a[104:107], v[24:27]
    ds_read_b64_tr_b16 v[134:135], v162 offset:512
    s_mov_b32 vcc_lo, 0xfff5ffff
    s_mov_b32 vcc_hi, 0xf555ff55
    v_cndmask_b32 v101, 0, v116, vcc
    v_mfma_f32_16x16x32_bf16 v[20:23], v[148:151], a[100:103], v[20:23]
    ds_read_b64_tr_b16 v[136:137], v161 offset:4096
    s_mov_b32 vcc_lo, 0xaabfaaab
    s_mov_b32 vcc_hi, 0xbfffabff
    v_cndmask_b32 v98, 0, v116, vcc
    v_mfma_f32_16x16x32_bf16 v[16:19], v[148:151], a[96:99], v[16:19]
    buffer_load_dwordx4 a[4:7], v160, s[44:47], s10 offen offset:1024 sc1
    v_mfma_f32_16x16x32_bf16 v[0:3], v[152:155], a[112:115], v[0:3]
    ds_read_b64_tr_b16 v[138:139], v161 offset:4608
    s_mov_b32 vcc_lo, 0xffeafffe
    s_mov_b32 vcc_hi, 0xeaaafeaa
    v_cndmask_b32 v102, 0, v116, vcc
    v_mfma_f32_16x16x32_bf16 v[4:7], v[152:155], a[116:119], v[4:7]
    ds_read_b64_tr_b16 v[140:141], v162 offset:4096
    s_mov_b32 vcc_lo, 0x557f5557
    s_mov_b32 vcc_hi, 0x7fff57ff
    v_cndmask_b32 v99, 0, v116, vcc
    v_mfma_f32_16x16x32_bf16 v[8:11], v[152:155], a[120:123], v[8:11]
    s_mov_b32 vcc_lo, 0xffd5fffd
    s_mov_b32 vcc_hi, 0xd555fd55
    v_cndmask_b32 v103, 0, v116, vcc
    v_mfma_f32_16x16x32_bf16 v[12:15], v[152:155], a[124:127], v[12:15]
    ds_read_b64_tr_b16 v[142:143], v162 offset:4608
    s_cmp_eq_u32 s68, 0
    s_cselect_b64 vcc, -1, 0
    v_cndmask_b32 v104, v100, v116, vcc
    v_cndmask_b32 v105, v101, v116, vcc
    v_cndmask_b32 v106, v102, v116, vcc
    v_cndmask_b32 v107, v103, v116, vcc
    v_mfma_f32_16x16x32_bf16 v[28:31], v[156:159], a[124:127], v[28:31]
    buffer_load_dwordx4 a[8:11], v160, s[44:47], s10 offen offset:2048 sc1
    v_mfma_f32_16x16x32_bf16 v[24:27], v[156:159], a[120:123], v[24:27]
    v_and_b32 v116, 16, v160
    v_mov_b32 v117, 0xffff
    v_lshlrev_b32 v117, v116, v117
    v_mfma_f32_16x16x32_bf16 v[20:23], v[156:159], a[116:119], v[20:23]
    buffer_load_dwordx4 a[12:15], v160, s[44:47], s10 offen offset:3072 sc1
    s_waitcnt lgkmcnt(0)
    v_mfma_f32_16x16x32_bf16 v[16:19], v[156:159], a[112:115], v[16:19]
    s_barrier
    v_mfma_f32_16x16x32_bf16 v[0:3], v[128:131], a[128:131], v[0:3]
    ds_read_b64_tr_b16 v[144:145], v161 offset:8192
    s_add_u32 s10, s71, 4096
    v_mfma_f32_16x16x32_bf16 v[4:7], v[128:131], a[132:135], v[4:7]
    buffer_load_dwordx4 a[16:19], v160, s[44:47], s10 offen offset:0 sc1
    v_mfma_f32_16x16x32_bf16 v[8:11], v[128:131], a[136:139], v[8:11]
    ds_read_b64_tr_b16 v[146:147], v161 offset:8704
    v_mfma_f32_16x16x32_bf16 v[12:15], v[128:131], a[140:143], v[12:15]
    ds_read_b64_tr_b16 v[148:149], v162 offset:8192
    v_mfma_f32_16x16x32_bf16 v[28:31], v[132:135], a[140:143], v[28:31]
    s_mov_b32 vcc_lo, 0xfff0ffff
    s_mov_b32 vcc_hi, 0xf000ff00
    v_cndmask_b32 v108, 0, v117, vcc
    v_mfma_f32_16x16x32_bf16 v[24:27], v[132:135], a[136:139], v[24:27]
    ds_read_b64_tr_b16 v[150:151], v162 offset:8704
    s_mov_b32 vcc_lo, 0xffc0fffc
    s_mov_b32 vcc_hi, 0xc000fc00
    v_cndmask_b32 v109, 0, v117, vcc
    v_xor_b32 v110, v117, v108
    v_mfma_f32_16x16x32_bf16 v[20:23], v[132:135], a[132:135], v[20:23]
    ds_read_b64_tr_b16 v[152:153], v161 offset:12288
    v_xor_b32 v111, v117, v109
    v_mfma_f32_16x16x32_bf16 v[16:19], v[132:135], a[128:131], v[16:19]
    buffer_load_dwordx4 a[20:23], v160, s[44:47], s10 offen offset:1024 sc1
    v_mfma_f32_16x16x32_bf16 v[0:3], v[136:139], a[144:147], v[0:3]
    ds_read_b64_tr_b16 v[154:155], v161 offset:12800
    v_mfma_f32_16x16x32_bf16 v[4:7], v[136:139], a[148:151], v[4:7]
    ds_read_b64_tr_b16 v[156:157], v162 offset:12288
    v_mov_b32 v112, 0x3f803f80
    v_mov_b32 v113, 0x3f803f80
    v_mfma_f32_16x16x32_bf16 v[8:11], v[136:139], a[152:155], v[8:11]
    v_mov_b32 v114, 0x3f803f80
    v_mov_b32 v115, 0x3f803f80
    s_add_u32 s11, s63, 57344
    v_mfma_f32_16x16x32_bf16 v[12:15], v[136:139], a[156:159], v[12:15]
    ds_read_b64_tr_b16 v[158:159], v162 offset:12800
    v_mfma_f32_16x16x32_bf16 v[28:31], v[140:143], a[156:159], v[28:31]
    buffer_load_dwordx4 a[24:27], v160, s[44:47], s10 offen offset:2048 sc1
    v_mfma_f32_16x16x32_bf16 v[24:27], v[140:143], a[152:155], v[24:27]
    v_mfma_f32_16x16x32_bf16 v[20:23], v[140:143], a[148:151], v[20:23]
    buffer_load_dwordx4 a[28:31], v160, s[44:47], s10 offen offset:3072 sc1
    s_waitcnt vmcnt(13) lgkmcnt(0)
    v_mfma_f32_16x16x32_bf16 v[16:19], v[140:143], a[144:147], v[16:19]
    s_barrier
    v_mfma_f32_16x16x32_bf16 v[0:3], v[144:147], a[160:163], v[0:3]
    s_buffer_load_dword s12, s[44:47], s67 offset:0 glc
    ds_read_b64_tr_b16 v[128:129], v161 offset:16384
    s_add_u32 s10, s71, 8192
    v_mfma_f32_16x16x32_bf16 v[4:7], v[144:147], a[164:167], v[4:7]
    buffer_load_dwordx4 a[32:35], v160, s[44:47], s10 offen offset:0 sc1
    v_mfma_f32_16x16x32_bf16 v[8:11], v[144:147], a[168:171], v[8:11]
    ds_read_b64_tr_b16 v[130:131], v161 offset:16896
    v_mfma_f32_16x16x32_bf16 v[12:15], v[144:147], a[172:175], v[12:15]
    ds_read_b64_tr_b16 v[132:133], v162 offset:16384
    v_mfma_f32_16x16x32_bf16 v[28:31], v[148:151], a[172:175], v[28:31]
    v_mfma_f32_16x16x32_bf16 v[24:27], v[148:151], a[168:171], v[24:27]
    ds_read_b64_tr_b16 v[134:135], v162 offset:16896
    v_mfma_f32_16x16x32_bf16 v[20:23], v[148:151], a[164:167], v[20:23]
    ds_read_b64_tr_b16 v[136:137], v161 offset:20480
    v_mfma_f32_16x16x32_bf16 v[16:19], v[148:151], a[160:163], v[16:19]
    buffer_load_dwordx4 a[36:39], v160, s[44:47], s10 offen offset:1024 sc1
    v_mfma_f32_16x16x32_bf16 v[0:3], v[152:155], a[176:179], v[0:3]
    ds_read_b64_tr_b16 v[138:139], v161 offset:20992
    v_mfma_f32_16x16x32_bf16 v[4:7], v[152:155], a[180:183], v[4:7]
    ds_read_b64_tr_b16 v[140:141], v162 offset:20480
    v_mfma_f32_16x16x32_bf16 v[8:11], v[152:155], a[184:187], v[8:11]
    v_mfma_f32_16x16x32_bf16 v[12:15], v[152:155], a[188:191], v[12:15]
    ds_read_b64_tr_b16 v[142:143], v162 offset:20992
    ds_read_b32 v170, v160
    v_mfma_f32_16x16x32_bf16 v[28:31], v[156:159], a[188:191], v[28:31]
    buffer_load_dwordx4 a[40:43], v160, s[44:47], s10 offen offset:2048 sc1
    v_mfma_f32_16x16x32_bf16 v[24:27], v[156:159], a[184:187], v[24:27]
    v_mfma_f32_16x16x32_bf16 v[20:23], v[156:159], a[180:183], v[20:23]
    buffer_load_dwordx4 a[44:47], v160, s[44:47], s10 offen offset:3072 sc1
    s_waitcnt vmcnt(15) lgkmcnt(1)
    v_mfma_f32_16x16x32_bf16 v[16:19], v[156:159], a[176:179], v[16:19]
    s_barrier
    v_mfma_f32_16x16x32_bf16 v[0:3], v[128:131], a[192:195], v[0:3]
    ds_read_b64_tr_b16 v[144:145], v161 offset:24576
    s_add_u32 s10, s71, 12288
    v_mfma_f32_16x16x32_bf16 v[4:7], v[128:131], a[196:199], v[4:7]
    buffer_load_dwordx4 a[48:51], v160, s[44:47], s10 offen offset:0 sc1
    v_mfma_f32_16x16x32_bf16 v[8:11], v[128:131], a[200:203], v[8:11]
    ds_read_b64_tr_b16 v[146:147], v161 offset:25088
    v_mfma_f32_16x16x32_bf16 v[12:15], v[128:131], a[204:207], v[12:15]
    ds_read_b64_tr_b16 v[148:149], v162 offset:24576
    v_mfma_f32_16x16x32_bf16 v[28:31], v[132:135], a[204:207], v[28:31]
    v_mfma_f32_16x16x32_bf16 v[24:27], v[132:135], a[200:203], v[24:27]
    ds_read_b64_tr_b16 v[150:151], v162 offset:25088
    v_mfma_f32_16x16x32_bf16 v[20:23], v[132:135], a[196:199], v[20:23]
    ds_read_b64_tr_b16 v[152:153], v161 offset:28672
    v_mfma_f32_16x16x32_bf16 v[16:19], v[132:135], a[192:195], v[16:19]
    buffer_load_dwordx4 a[52:55], v160, s[44:47], s10 offen offset:1024 sc1
    v_mfma_f32_16x16x32_bf16 v[0:3], v[136:139], a[208:211], v[0:3]
    ds_read_b64_tr_b16 v[154:155], v161 offset:29184
    v_mfma_f32_16x16x32_bf16 v[4:7], v[136:139], a[212:215], v[4:7]
    ds_read_b64_tr_b16 v[156:157], v162 offset:28672
    v_mfma_f32_16x16x32_bf16 v[8:11], v[136:139], a[216:219], v[8:11]
    v_mfma_f32_16x16x32_bf16 v[12:15], v[136:139], a[220:223], v[12:15]
    ds_read_b64_tr_b16 v[158:159], v162 offset:29184
    ds_read_b32 v170, v160
    v_mfma_f32_16x16x32_bf16 v[28:31], v[140:143], a[220:223], v[28:31]
    buffer_load_dwordx4 a[56:59], v160, s[44:47], s10 offen offset:2048 sc1
    v_mfma_f32_16x16x32_bf16 v[24:27], v[140:143], a[216:219], v[24:27]
    v_mfma_f32_16x16x32_bf16 v[20:23], v[140:143], a[212:215], v[20:23]
    buffer_load_dwordx4 a[60:63], v160, s[44:47], s10 offen offset:3072 sc1
    s_waitcnt lgkmcnt(1)
    v_mfma_f32_16x16x32_bf16 v[16:19], v[140:143], a[208:211], v[16:19]
    s_barrier
    v_mfma_f32_16x16x32_bf16 v[0:3], v[144:147], a[224:227], v[0:3]
    s_waitcnt lgkmcnt(0)
    s_cmp_eq_u32 s68, 0
    s_cselect_b32 s12, 64, s12
    s_cmp_eq_u32 s12, 64
    s_cbranch_scc0 L_try3
L_ok3:
    v_mfma_f32_16x16x32_bf16 v[4:7], v[144:147], a[228:231], v[4:7]
    v_mfma_f32_16x16x32_bf16 v[8:11], v[144:147], a[232:235], v[8:11]
    buffer_load_dwordx4 v[204:207], v160, s[44:47], s70 offen sc1
    v_mfma_f32_16x16x32_bf16 v[12:15], v[144:147], a[236:239], v[12:15]
    v_mfma_f32_16x16x32_bf16 v[28:31], v[148:151], a[236:239], v[28:31]
    buffer_load_dwordx4 v[40:43], v160, s[44:47], s70 offen offset:1024 sc1
    v_mfma_f32_16x16x32_bf16 v[24:27], v[148:151], a[232:235], v[24:27]
    v_mfma_f32_16x16x32_bf16 v[20:23], v[148:151], a[228:231], v[20:23]
    s_add_u32 s10, s71, 16384
    v_mfma_f32_16x16x32_bf16 v[16:19], v[148:151], a[224:227], v[16:19]
    buffer_load_dwordx4 a[64:67], v160, s[44:47], s10 offen offset:0 sc1
    v_mfma_f32_16x16x32_bf16 v[0:3], v[152:155], a[240:243], v[0:3]
    v_mfma_f32_16x16x32_bf16 v[4:7], v[152:155], a[244:247], v[4:7]
    buffer_load_dwordx4 a[68:71], v160, s[44:47], s10 offen offset:1024 sc1
    v_mfma_f32_16x16x32_bf16 v[8:11], v[152:155], a[248:251], v[8:11]
    v_mfma_f32_16x16x32_bf16 v[12:15], v[152:155], a[252:255], v[12:15]
    v_mfma_f32_16x16x32_bf16 v[28:31], v[156:159], a[252:255], v[28:31]
    buffer_load_dwordx4 a[72:75], v160, s[44:47], s10 offen offset:2048 sc1
    v_mfma_f32_16x16x32_bf16 v[24:27], v[156:159], a[248:251], v[24:27]
    v_mfma_f32_16x16x32_bf16 v[20:23], v[156:159], a[244:247], v[20:23]
    buffer_load_dwordx4 a[76:79], v160, s[44:47], s10 offen offset:3072 sc1
    s_waitcnt vmcnt(18)
    v_mfma_f32_16x16x32_bf16 v[16:19], v[156:159], a[240:243], v[16:19]
    v_mfma_f32_16x16x32_bf16 a[192:195], v[208:211], a[0:3], 0
    s_add_u32 s10, s71, 20480
    v_cvt_pk_bf16_f32 v8, v8, v9
    v_cvt_pk_bf16_f32 v9, v10, v11
    v_cvt_pk_bf16_f32 v24, v24, v25
    v_cvt_pk_bf16_f32 v25, v26, v27
    v_cvt_pk_bf16_f32 v12, v12, v13
    v_cvt_pk_bf16_f32 v13, v14, v15
    v_cvt_pk_bf16_f32 v28, v28, v29
    v_cvt_pk_bf16_f32 v29, v30, v31
    v_mfma_f32_16x16x32_bf16 a[196:199], v[208:211], a[4:7], 0
    buffer_load_dwordx4 a[80:83], v160, s[44:47], s10 offen offset:0 sc1
    v_mfma_f32_16x16x16_bf16 v[68:71], v[60:61], v[8:9], v[96:99]
    v_mfma_f32_16x16x16_bf16 v[76:79], v[62:63], v[24:25], v[96:99]
    v_mfma_f32_16x16x32_bf16 a[200:203], v[208:211], a[8:11], 0
    v_mfma_f32_16x16x16_bf16 v[84:87], v[200:201], v[12:13], v[96:99]
    v_mfma_f32_16x16x16_bf16 v[92:95], v[202:203], v[28:29], v[96:99]
    v_mfma_f32_16x16x16_bf16 v[88:91], v[62:63], v[28:29], v[100:103]
    v_mfma_f32_16x16x32_bf16 a[204:207], v[208:211], a[12:15], 0
    buffer_load_dwordx4 a[84:87], v160, s[44:47], s10 offen offset:1024 sc1
    v_mfma_f32_16x16x16_bf16 v[80:83], v[60:61], v[12:13], v[100:103]
    v_mfma_f32_16x16x16_bf16 v[72:75], v[58:59], v[24:25], v[100:103]
    v_mfma_f32_16x16x32_bf16 a[220:223], v[212:215], a[12:15], 0
    v_mfma_f32_16x16x16_bf16 v[64:67], v[56:57], v[8:9], v[100:103]
    s_nop 1
    v_max3_f32 v88, v88, v89, v92
    v_max3_f32 v90, v90, v91, v94
    v_max_f32 v88, v88, v93
    v_max_f32 v90, v90, v95
    v_max_f32 v187, v88, v90
    v_max3_f32 v80, v80, v81, v84
    v_max3_f32 v82, v82, v83, v86
    v_mfma_f32_16x16x32_bf16 a[216:219], v[212:215], a[8:11], 0
    buffer_load_dwordx4 a[88:91], v160, s[44:47], s10 offen offset:2048 sc1
    v_max_f32 v80, v80, v85
    v_max_f32 v82, v82, v87
    v_max_f32 v186, v80, v82
    v_max3_f32 v72, v72, v73, v76
    v_max3_f32 v74, v74, v75, v78
    v_max_f32 v72, v72, v77
    v_mfma_f32_16x16x32_bf16 a[212:215], v[212:215], a[4:7], 0
    v_max_f32 v74, v74, v79
    v_max_f32 v185, v72, v74
    v_max3_f32 v64, v64, v65, v68
    v_max3_f32 v66, v66, v67, v70
    v_max_f32 v64, v64, v69
    v_max_f32 v66, v66, v71
    v_max_f32 v184, v64, v66
    v_permlane32_swap_b32 v186, v187
    s_nop 0
    v_permlane32_swap_b32 v184, v185
    v_max_f32 v186, v186, v187
    v_mfma_f32_16x16x32_bf16 a[208:211], v[212:215], a[0:3], 0
    buffer_load_dwordx4 a[92:95], v160, s[44:47], s10 offen offset:3072 sc1
    v_max_f32 v184, v184, v185
    s_nop 1
    v_permlane16_swap_b32 v184, v186
    v_max_f32 v185, v184, v186
    v_max_f32 v187, v184, v186
    s_nop 1
    v_permlane16_swap_b32 v185, v187
    v_mul_f32 v184, v196, v185
    v_mfma_f32_16x16x32_bf16 a[224:227], v[216:219], a[0:3], 0
    s_add_u32 s10, s71, 24576
    v_mul_f32 v186, v198, v187
    v_mul_f32 v185, v196, v185
    v_mul_f32 v187, v198, v187
    s_nop 0
    v_permlane32_swap_b32 v184, v185
    v_permlane32_swap_b32 v186, v187
    v_fma_f32 v64, v64, v196, -v184
    v_fma_f32 v66, v66, v196, -v184
    v_fma_f32 v72, v72, v196, -v185
    v_mfma_f32_16x16x32_bf16 a[228:231], v[216:219], a[4:7], 0
    buffer_load_dwordx4 a[96:99], v160, s[44:47], s10 offen offset:0 sc1
    v_fma_f32 v74, v74, v196, -v185
    v_fma_f32 v80, v80, v198, -v186
    v_fma_f32 v82, v82, v198, -v186
    v_fma_f32 v88, v88, v198, -v187
    v_fma_f32 v90, v90, v198, -v187
    v_mfma_f32_16x16x32_bf16 a[232:235], v[216:219], a[8:11], 0
    v_exp_f32 v64, v64
    v_exp_f32 v66, v66
    v_exp_f32 v72, v72
    v_exp_f32 v74, v74
    v_exp_f32 v80, v80
    v_mfma_f32_16x16x32_bf16 a[236:239], v[216:219], a[12:15], 0
    buffer_load_dwordx4 a[100:103], v160, s[44:47], s10 offen offset:1024 sc1
    v_exp_f32 v82, v82
    v_exp_f32 v88, v88
    v_exp_f32 v90, v90
    v_mfma_f32_16x16x32_bf16 a[252:255], v[220:223], a[12:15], 0
    v_cvt_pk_bf16_f32 v64, v64, v64
    v_cvt_pk_bf16_f32 v66, v66, v66
    v_and_b32 v68, v108, v64
    v_and_b32 v69, v109, v66
    v_and_b32 v70, v110, v64
    v_and_b32 v71, v111, v66
    v_cvt_pk_bf16_f32 v72, v72, v72
    v_cvt_pk_bf16_f32 v74, v74, v74
    v_and_b32 v76, v110, v72
    v_and_b32 v77, v111, v74
    v_mfma_f32_16x16x32_bf16 a[248:251], v[220:223], a[8:11], 0
    buffer_load_dwordx4 a[104:107], v160, s[44:47], s10 offen offset:2048 sc1
    v_and_b32 v78, v108, v72
    v_and_b32 v79, v109, v74
    v_cvt_pk_bf16_f32 v80, v80, v80
    v_cvt_pk_bf16_f32 v82, v82, v82
    v_and_b32 v84, v108, v80
    v_and_b32 v85, v109, v82
L_stub4:
    s_cbranch_execz L_stub0
    s_nop 0
    v_mfma_f32_16x16x32_bf16 a[244:247], v[220:223], a[4:7], 0
    v_and_b32 v86, v110, v80
    v_and_b32 v87, v111, v82
    v_cvt_pk_bf16_f32 v88, v88, v88
    v_cvt_pk_bf16_f32 v90, v90, v90
    v_and_b32 v92, v110, v88
    v_and_b32 v93, v111, v90
    v_and_b32 v94, v108, v88
    v_and_b32 v95, v109, v90
    s_waitcnt vmcnt(21)
    v_mfma_f32_16x16x32_bf16 a[240:243], v[220:223], a[0:3], 0
    buffer_load_dwordx4 a[108:111], v160, s[44:47], s10 offen offset:3072 sc1
    v_mfma_f32_16x16x32_bf16 v[64:67], v[112:115], v[68:71], 0
    v_mfma_f32_16x16x32_bf16 v[8:11], v[34:37], v[68:71], 0
    v_mfma_f32_16x16x32_bf16 a[192:195], v[224:227], a[16:19], a[192:195]
    s_add_u32 s10, s71, 28672
    v_mfma_f32_16x16x32_bf16 v[72:75], v[112:115], v[76:79], 0
    v_mfma_f32_16x16x32_bf16 v[24:27], v[46:49], v[76:79], 0
    v_mfma_f32_16x16x32_bf16 v[80:83], v[112:115], v[84:87], 0
    v_mfma_f32_16x16x32_bf16 a[196:199], v[224:227], a[20:23], a[196:199]
    buffer_load_dwordx4 a[112:115], v160, s[44:47], s10 offen offset:0 sc1
    v_mfma_f32_16x16x32_bf16 v[12:15], v[32:35], v[84:87], 0
    v_mfma_f32_16x16x32_bf16 v[88:91], v[112:115], v[92:95], 0
    v_mfma_f32_16x16x32_bf16 a[200:203], v[224:227], a[24:27], a[200:203]
    v_mfma_f32_16x16x32_bf16 v[28:31], v[48:51], v[92:95], 0
    v_rcp_f32 v184, v64
    v_rcp_f32 v185, v72
    v_rcp_f32 v186, v80
    v_mfma_f32_16x16x32_bf16 a[204:207], v[224:227], a[28:31], a[204:207]
    buffer_load_dwordx4 a[116:119], v160, s[44:47], s10 offen offset:1024 sc1
    s_nop 0
    v_rcp_f32 v187, v88
    v_mul_f32 v8, v8, v184
    v_mul_f32 v9, v9, v184
    v_mul_f32 v10, v10, v184
    v_mul_f32 v11, v11, v184
    v_cvt_pk_bf16_f32 v120, v8, v9
    v_cvt_pk_bf16_f32 v121, v10, v11
    v_mfma_f32_16x16x32_bf16 a[220:223], v[228:231], a[28:31], a[220:223]
    v_mul_f32 v24, v24, v185
    v_mul_f32 v25, v25, v185
    v_mul_f32 v26, v26, v185
    v_mul_f32 v27, v27, v185
    v_cvt_pk_bf16_f32 v122, v24, v25
    v_cvt_pk_bf16_f32 v123, v26, v27
    buffer_store_dwordx4 v[120:123], v160, s[44:47], s11 offen offset:2048 sc1
    v_mfma_f32_16x16x32_bf16 a[216:219], v[228:231], a[24:27], a[216:219]
    buffer_load_dwordx4 a[120:123], v160, s[44:47], s10 offen offset:2048 sc1
    v_mul_f32 v12, v12, v186
    v_mul_f32 v13, v13, v186
    v_mul_f32 v14, v14, v186
    v_mul_f32 v15, v15, v186
    v_cvt_pk_bf16_f32 v124, v12, v13
    v_cvt_pk_bf16_f32 v125, v14, v15
    v_mfma_f32_16x16x32_bf16 a[212:215], v[228:231], a[20:23], a[212:215]
    v_mul_f32 v28, v28, v187
    v_mul_f32 v29, v29, v187
    v_mul_f32 v30, v30, v187
    v_mul_f32 v31, v31, v187
    v_cvt_pk_bf16_f32 v126, v28, v29
    v_cvt_pk_bf16_f32 v127, v30, v31
    buffer_store_dwordx4 v[124:127], v160, s[44:47], s11 offen offset:3072 sc1
    v_mfma_f32_16x16x32_bf16 a[208:211], v[228:231], a[16:19], a[208:211]
    buffer_load_dwordx4 a[124:127], v160, s[44:47], s10 offen offset:3072 sc1
    v_cvt_pk_bf16_f32 v0, v0, v1
    v_cvt_pk_bf16_f32 v1, v2, v3
    v_cvt_pk_bf16_f32 v16, v16, v17
    v_cvt_pk_bf16_f32 v17, v18, v19
    v_cvt_pk_bf16_f32 v4, v4, v5
    v_cvt_pk_bf16_f32 v5, v6, v7
    v_mfma_f32_16x16x32_bf16 a[224:227], v[232:235], a[16:19], a[224:227]
    s_add_u32 m0, s60, 32768
    s_add_u32 s9, s61, 327680
    v_cvt_pk_bf16_f32 v20, v20, v21
    v_cvt_pk_bf16_f32 v21, v22, v23
    v_mfma_f32_16x16x16_bf16 v[68:71], v[52:53], v[0:1], v[96:99]
    v_mfma_f32_16x16x16_bf16 v[76:79], v[54:55], v[16:17], v[96:99]
    v_mfma_f32_16x16x32_bf16 a[228:231], v[232:235], a[20:23], a[228:231]
    buffer_load_dwordx4 v168, s[36:39], s9 offen lds
    v_mfma_f32_16x16x16_bf16 v[84:87], v[56:57], v[4:5], v[96:99]
    v_mfma_f32_16x16x16_bf16 v[92:95], v[58:59], v[20:21], v[96:99]
    v_mfma_f32_16x16x32_bf16 a[232:235], v[232:235], a[24:27], a[232:235]
    s_add_u32 m0, s60, 33792
    s_add_u32 s9, s61, 335872
    v_mfma_f32_16x16x16_bf16 v[88:91], v[54:55], v[20:21], v[100:103]
    v_mfma_f32_16x16x16_bf16 v[80:83], v[52:53], v[4:5], v[100:103]
    v_mfma_f32_16x16x32_bf16 a[236:239], v[232:235], a[28:31], a[236:239]
    buffer_load_dwordx4 v168, s[36:39], s9 offen lds
    s_waitcnt vmcnt(21)
    v_mfma_f32_16x16x16_bf16 v[72:75], v[206:207], v[16:17], v[104:107]
    v_mfma_f32_16x16x16_bf16 v[64:67], v[204:205], v[0:1], v[104:107]
    s_nop 1
    v_max3_f32 v88, v88, v89, v92
    v_max3_f32 v90, v90, v91, v94
    v_max_f32 v88, v88, v93
    v_mfma_f32_16x16x32_bf16 a[252:255], v[236:239], a[28:31], a[252:255]
    s_add_u32 m0, s60, 34816
    s_add_u32 s9, s61, 344064
    v_max_f32 v90, v90, v95
    v_max_f32 v187, v88, v90
    v_max3_f32 v80, v80, v81, v84
    v_max3_f32 v82, v82, v83, v86
    v_max_f32 v80, v80, v85
    v_max_f32 v82, v82, v87
    v_max_f32 v186, v80, v82
    v_max3_f32 v72, v72, v73, v76
    v_mfma_f32_16x16x32_bf16 a[248:251], v[236:239], a[24:27], a[248:251]
    buffer_load_dwordx4 v168, s[36:39], s9 offen lds
    v_max3_f32 v74, v74, v75, v78
    v_max_f32 v72, v72, v77
    v_max_f32 v74, v74, v79
    v_max_f32 v185, v72, v74
    v_max3_f32 v64, v64, v65, v68
    v_max3_f32 v66, v66, v67, v70
    v_mfma_f32_16x16x32_bf16 a[244:247], v[236:239], a[20:23], a[244:247]
    s_add_u32 m0, s60, 35840
    s_add_u32 s9, s61, 352256
    v_max_f32 v64, v64, v69
    v_max_f32 v66, v66, v71
    v_max_f32 v184, v64, v66
    v_permlane32_swap_b32 v186, v187
    s_nop 0
    v_permlane32_swap_b32 v184, v185
    v_max_f32 v186, v186, v187
    v_max_f32 v184, v184, v185
    s_nop 1
    v_permlane16_swap_b32 v184, v186
    v_mfma_f32_16x16x32_bf16 a[240:243], v[236:239], a[16:19], a[240:243]
    buffer_load_dwordx4 v168, s[36:39], s9 offen lds
    v_max_f32 v185, v184, v186
    v_max_f32 v187, v184, v186
    s_nop 1
    v_permlane16_swap_b32 v185, v187
    v_mul_f32 v184, v192, v185
    v_mul_f32 v186, v194, v187
    v_mfma_f32_16x16x32_bf16 a[192:195], v[240:243], a[32:35], a[192:195]
    ds_read_b64_tr_b16 v[144:145], v180 offset:49152
    s_add_u32 m0, s60, 0
    s_add_u32 s9, s61, 360448
    v_mul_f32 v185, v192, v185
    v_mul_f32 v187, v194, v187
    s_nop 0
    v_permlane32_swap_b32 v184, v185
    v_permlane32_swap_b32 v186, v187
    v_fma_f32 v64, v64, v192, -v184
    v_fma_f32 v66, v66, v192, -v184
    v_fma_f32 v72, v72, v192, -v185
    v_fma_f32 v74, v74, v192, -v185
    v_mfma_f32_16x16x32_bf16 a[196:199], v[240:243], a[36:39], a[196:199]
    buffer_load_dwordx4 v168, s[36:39], s9 offen lds
    v_fma_f32 v80, v80, v194, -v186
    v_fma_f32 v82, v82, v194, -v186
    v_fma_f32 v88, v88, v194, -v187
    v_fma_f32 v90, v90, v194, -v187
    v_exp_f32 v64, v64
    v_mfma_f32_16x16x32_bf16 a[200:203], v[240:243], a[40:43], a[200:203]
    ds_read_b64_tr_b16 v[146:147], v180 offset:51200
    v_exp_f32 v66, v66
    v_exp_f32 v72, v72
    v_exp_f32 v74, v74
    v_exp_f32 v80, v80
    v_exp_f32 v82, v82
    v_mfma_f32_16x16x32_bf16 a[204:207], v[240:243], a[44:47], a[204:207]
    ds_read_b64_tr_b16 v[148:149], v181 offset:49152
    s_add_u32 m0, s60, 1024
    s_add_u32 s9, s61, 368640
    v_exp_f32 v88, v88
    v_exp_f32 v90, v90
    v_cvt_pk_bf16_f32 v64, v64, v64
    v_cvt_pk_bf16_f32 v66, v66, v66
    v_and_b32 v68, v108, v64
    v_and_b32 v69, v109, v66
    v_mfma_f32_16x16x32_bf16 a[220:223], v[244:247], a[44:47], a[220:223]
    buffer_load_dwordx4 v168, s[36:39], s9 offen lds
    v_and_b32 v70, v110, v64
    v_and_b32 v71, v111, v66
    v_cvt_pk_bf16_f32 v72, v72, v72
    v_cvt_pk_bf16_f32 v74, v74, v74
    v_and_b32 v76, v110, v72
    v_and_b32 v77, v111, v74
    v_and_b32 v78, v108, v72
    v_mfma_f32_16x16x32_bf16 a[216:219], v[244:247], a[40:43], a[216:219]
    ds_read_b64_tr_b16 v[150:151], v181 offset:51200
    v_and_b32 v79, v109, v74
    v_cvt_pk_bf16_f32 v80, v80, v80
    v_cvt_pk_bf16_f32 v82, v82, v82
    v_and_b32 v84, v108, v80
    v_and_b32 v85, v109, v82
    v_and_b32 v86, v110, v80
    v_and_b32 v87, v111, v82
    v_cvt_pk_bf16_f32 v88, v88, v88
    v_cvt_pk_bf16_f32 v90, v90, v90
    v_and_b32 v92, v110, v88
    v_mfma_f32_16x16x32_bf16 a[212:215], v[244:247], a[36:39], a[212:215]
    ds_read_b64_tr_b16 v[152:153], v182 offset:49152
    s_add_u32 m0, s60, 2048
    s_add_u32 s9, s61, 376832
    v_and_b32 v93, v111, v90
    v_and_b32 v94, v108, v88
    v_and_b32 v95, v109, v90
    v_mfma_f32_16x16x32_bf16 v[64:67], v[112:115], v[68:71], 0
    v_mfma_f32_16x16x32_bf16 a[208:211], v[244:247], a[32:35], a[208:211]
    buffer_load_dwordx4 v168, s[36:39], s9 offen lds
    s_waitcnt vmcnt(25)
    v_mfma_f32_16x16x32_bf16 v[0:3], v[38:41], v[68:71], 0
    v_mfma_f32_16x16x32_bf16 v[72:75], v[112:115], v[76:79], 0
    v_mfma_f32_16x16x32_bf16 v[16:19], v[42:45], v[76:79], 0
    v_mfma_f32_16x16x32_bf16 a[224:227], v[248:251], a[32:35], a[224:227]
    ds_read_b64_tr_b16 v[154:155], v182 offset:51200
    v_mfma_f32_16x16x32_bf16 v[80:83], v[112:115], v[84:87], 0
    v_mfma_f32_16x16x32_bf16 v[4:7], v[36:39], v[84:87], 0
    v_mfma_f32_16x16x32_bf16 v[88:91], v[112:115], v[92:95], 0
    v_mfma_f32_16x16x32_bf16 a[228:231], v[248:251], a[36:39], a[228:231]
    ds_read_b64_tr_b16 v[156:157], v183 offset:49152
    s_add_u32 m0, s60, 3072
    s_add_u32 s9, s61, 385024
    v_mfma_f32_16x16x32_bf16 v[20:23], v[44:47], v[92:95], 0
    v_rcp_f32 v184, v64
    v_rcp_f32 v185, v72
    v_mfma_f32_16x16x32_bf16 a[232:235], v[248:251], a[40:43], a[232:235]
    buffer_load_dwordx4 v168, s[36:39], s9 offen lds
    v_rcp_f32 v186, v80
    v_rcp_f32 v187, v88
    v_mul_f32 v0, v0, v184
    v_mul_f32 v1, v1, v184
    v_mul_f32 v2, v2, v184
    v_mul_f32 v3, v3, v184
    v_mfma_f32_16x16x32_bf16 a[236:239], v[248:251], a[44:47], a[236:239]
    ds_read_b64_tr_b16 v[158:159], v183 offset:51200
    s_add_u32 m0, s60, 16384
    s_add_u32 s9, s61, 393216
    v_cvt_pk_bf16_f32 v120, v0, v1
    v_cvt_pk_bf16_f32 v121, v2, v3
    v_mul_f32 v16, v16, v185
    v_mul_f32 v17, v17, v185
    v_mul_f32 v18, v18, v185
    v_mul_f32 v19, v19, v185
    v_cvt_pk_bf16_f32 v122, v16, v17
    v_cvt_pk_bf16_f32 v123, v18, v19
    v_mfma_f32_16x16x32_bf16 a[252:255], v[252:255], a[44:47], a[252:255]
    buffer_load_dwordx4 v168, s[36:39], s9 offen lds
    s_add_u32 m0, s60, 17408
    s_add_u32 s9, s61, 409600
    buffer_store_dwordx4 v[120:123], v160, s[44:47], s11 offen offset:0 sc1
    v_mul_f32 v4, v4, v186
    v_mfma_f32_16x16x32_bf16 a[248:251], v[252:255], a[40:43], a[248:251]
    buffer_load_dwordx4 v168, s[36:39], s9 offen lds
    s_add_u32 m0, s60, 18432
    s_add_u32 s9, s61, 401408
    v_mul_f32 v5, v5, v186
    v_mul_f32 v6, v6, v186
    v_mul_f32 v7, v7, v186
    v_cvt_pk_bf16_f32 v124, v4, v5
    v_mfma_f32_16x16x32_bf16 a[244:247], v[252:255], a[36:39], a[244:247]
    buffer_load_dwordx4 v168, s[36:39], s9 offen lds
    s_add_u32 m0, s60, 19456
    s_add_u32 s9, s61, 417792
    v_cvt_pk_bf16_f32 v125, v6, v7
    v_mul_f32 v20, v20, v187
    v_mul_f32 v21, v21, v187
    v_mul_f32 v22, v22, v187
    v_mul_f32 v23, v23, v187
    s_waitcnt lgkmcnt(0)
    v_mfma_f32_16x16x32_bf16 a[240:243], v[252:255], a[32:35], a[240:243]
    buffer_load_dwordx4 v168, s[36:39], s9 offen lds
    v_cvt_pk_bf16_f32 v126, v20, v21
    v_cvt_pk_bf16_f32 v127, v22, v23
    buffer_store_dwordx4 v[124:127], v160, s[44:47], s11 offen offset:1024 sc1
    v_mfma_f32_16x16x32_bf16 a[192:195], v[144:147], a[48:51], a[192:195]
    s_buffer_load_dwordx4 s[16:19], s[44:47], s66 offset:144 glc
    v_add_u32 v180, 0xc000, v180
    ds_read_b64_tr_b16 v[128:129], v180 offset:16384
    v_mfma_f32_16x16x32_bf16 a[196:199], v[144:147], a[52:55], a[196:199]
    v_mfma_f32_16x16x32_bf16 a[200:203], v[144:147], a[56:59], a[200:203]
    ds_read_b64_tr_b16 v[130:131], v180 offset:18432
    v_mfma_f32_16x16x32_bf16 a[204:207], v[144:147], a[60:63], a[204:207]
    v_add_u32 v181, 0xc000, v181
    ds_read_b64_tr_b16 v[132:133], v181 offset:16384
    s_add_u32 m0, s60, 98304
    s_add_u32 s9, s61, 425984
    v_mfma_f32_16x16x32_bf16 a[220:223], v[148:151], a[60:63], a[220:223]
    buffer_load_dwordx4 v168, s[36:39], s9 offen lds
    v_mfma_f32_16x16x32_bf16 a[216:219], v[148:151], a[56:59], a[216:219]
    ds_read_b64_tr_b16 v[134:135], v181 offset:18432
    v_mfma_f32_16x16x32_bf16 a[212:215], v[148:151], a[52:55], a[212:215]
    v_add_u32 v182, 0xc000, v182
    ds_read_b64_tr_b16 v[136:137], v182 offset:16384
    v_mfma_f32_16x16x32_bf16 a[208:211], v[148:151], a[48:51], a[208:211]
    v_mfma_f32_16x16x32_bf16 a[224:227], v[152:155], a[48:51], a[224:227]
    ds_read_b64_tr_b16 v[138:139], v182 offset:18432
    v_mfma_f32_16x16x32_bf16 a[228:231], v[152:155], a[52:55], a[228:231]
    v_add_u32 v183, 0xc000, v183
    ds_read_b64_tr_b16 v[140:141], v183 offset:16384
    s_add_u32 m0, s60, 99328
    s_add_u32 s9, s61, 442368
    v_mfma_f32_16x16x32_bf16 a[232:235], v[152:155], a[56:59], a[232:235]
    buffer_load_dwordx4 v168, s[36:39], s9 offen lds
    v_mfma_f32_16x16x32_bf16 a[236:239], v[152:155], a[60:63], a[236:239]
    ds_read_b64_tr_b16 v[142:143], v183 offset:18432
    ds_read_b32 v170, v160
    v_mfma_f32_16x16x32_bf16 a[252:255], v[156:159], a[60:63], a[252:255]
    ds_read_b32 v170, v160
    s_add_u32 m0, s60, 100352
    s_add_u32 s9, s61, 434176
    v_mfma_f32_16x16x32_bf16 a[248:251], v[156:159], a[56:59], a[248:251]
    buffer_load_dwordx4 v168, s[36:39], s9 offen lds
    v_mfma_f32_16x16x32_bf16 a[244:247], v[156:159], a[52:55], a[244:247]
    s_add_u32 m0, s60, 101376
    s_add_u32 s9, s61, 450560
    s_waitcnt vmcnt(31) lgkmcnt(2)
    v_mfma_f32_16x16x32_bf16 a[240:243], v[156:159], a[48:51], a[240:243]
    buffer_load_dwordx4 v168, s[36:39], s9 offen lds
    v_mfma_f32_16x16x32_bf16 a[192:195], v[128:131], a[64:67], a[192:195]
    ds_read_b64_tr_b16 v[144:145], v180 offset:32768
    v_mfma_f32_16x16x32_bf16 a[196:199], v[128:131], a[68:71], a[196:199]
    v_mfma_f32_16x16x32_bf16 a[200:203], v[128:131], a[72:75], a[200:203]
    ds_read_b64_tr_b16 v[146:147], v180 offset:34816
    v_mfma_f32_16x16x32_bf16 a[204:207], v[128:131], a[76:79], a[204:207]
    ds_read_b64_tr_b16 v[148:149], v181 offset:32768
    s_add_u32 m0, s60, 114688
    s_add_u32 s9, s62, 0
    v_mfma_f32_16x16x32_bf16 a[220:223], v[132:135], a[76:79], a[220:223]
    buffer_load_dwordx4 v168, s[40:43], s9 offen lds
    v_mfma_f32_16x16x32_bf16 a[216:219], v[132:135], a[72:75], a[216:219]
    ds_read_b64_tr_b16 v[150:151], v181 offset:34816
    v_mfma_f32_16x16x32_bf16 a[212:215], v[132:135], a[68:71], a[212:215]
    ds_read_b64_tr_b16 v[152:153], v182 offset:32768
    v_mfma_f32_16x16x32_bf16 a[208:211], v[132:135], a[64:67], a[208:211]
    v_mfma_f32_16x16x32_bf16 a[224:227], v[136:139], a[64:67], a[224:227]
    ds_read_b64_tr_b16 v[154:155], v182 offset:34816
    v_mfma_f32_16x16x32_bf16 a[228:231], v[136:139], a[68:71], a[228:231]
    ds_read_b64_tr_b16 v[156:157], v183 offset:32768
    s_add_u32 m0, s60, 115712
    s_add_u32 s9, s62, 8192
    v_mfma_f32_16x16x32_bf16 a[232:235], v[136:139], a[72:75], a[232:235]
    buffer_load_dwordx4 v168, s[40:43], s9 offen lds
    v_mfma_f32_16x16x32_bf16 a[236:239], v[136:139], a[76:79], a[236:239]
    ds_read_b64_tr_b16 v[158:159], v183 offset:34816
    ds_read_b32 v170, v160
    v_mfma_f32_16x16x32_bf16 a[252:255], v[140:143], a[76:79], a[252:255]
    ds_read_b32 v170, v160
    s_add_u32 m0, s60, 116736
    s_add_u32 s9, s62, 16384
    v_mfma_f32_16x16x32_bf16 a[248:251], v[140:143], a[72:75], a[248:251]
    buffer_load_dwordx4 v168, s[40:43], s9 offen lds
    v_mfma_f32_16x16x32_bf16 a[244:247], v[140:143], a[68:71], a[244:247]
    s_add_u32 m0, s60, 117760
    s_add_u32 s9, s62, 24576
    s_waitcnt vmcnt(31) lgkmcnt(2)
    v_mfma_f32_16x16x32_bf16 a[240:243], v[140:143], a[64:67], a[240:243]
    buffer_load_dwordx4 v168, s[40:43], s9 offen lds
    v_mfma_f32_16x16x32_bf16 a[192:195], v[144:147], a[80:83], a[192:195]
    s_waitcnt lgkmcnt(0)
    s_and_b64 s[16:17], s[16:17], s[18:19]
    s_and_b32 s16, s16, s17
    s_cmp_eq_u32 s16, 64
    s_cbranch_scc0 L_try4
L_ok4:
    ds_read_b64_tr_b16 v[128:129], v180 offset:49152
    v_mfma_f32_16x16x32_bf16 a[196:199], v[144:147], a[84:87], a[196:199]
    s_waitcnt vmcnt(8)
    buffer_store_dword v169, v169, s[44:47], s65 offen offset:256 sc1
    v_mfma_f32_16x16x32_bf16 a[200:203], v[144:147], a[88:91], a[200:203]
    ds_read_b64_tr_b16 v[130:131], v180 offset:51200
    v_mfma_f32_16x16x32_bf16 a[204:207], v[144:147], a[92:95], a[204:207]
    ds_read_b64_tr_b16 v[132:133], v181 offset:49152
    v_mfma_f32_16x16x32_bf16 a[220:223], v[148:151], a[92:95], a[220:223]
    v_mfma_f32_16x16x32_bf16 a[216:219], v[148:151], a[88:91], a[216:219]
    ds_read_b64_tr_b16 v[134:135], v181 offset:51200
    v_mfma_f32_16x16x32_bf16 a[212:215], v[148:151], a[84:87], a[212:215]
    ds_read_b64_tr_b16 v[136:137], v182 offset:49152
    s_add_u32 s10, s71, 32768
    v_mfma_f32_16x16x32_bf16 a[208:211], v[148:151], a[80:83], a[208:211]
    buffer_load_dwordx4 a[128:131], v160, s[44:47], s10 offen offset:0 sc1
    v_mfma_f32_16x16x32_bf16 a[224:227], v[152:155], a[80:83], a[224:227]
    ds_read_b64_tr_b16 v[138:139], v182 offset:51200
    v_mfma_f32_16x16x32_bf16 a[228:231], v[152:155], a[84:87], a[228:231]
    ds_read_b64_tr_b16 v[140:141], v183 offset:49152
    v_mfma_f32_16x16x32_bf16 a[232:235], v[152:155], a[88:91], a[232:235]
    buffer_load_dwordx4 a[132:135], v160, s[44:47], s10 offen offset:1024 sc1
    v_mfma_f32_16x16x32_bf16 a[236:239], v[152:155], a[92:95], a[236:239]
    ds_read_b64_tr_b16 v[142:143], v183 offset:51200
    v_mfma_f32_16x16x32_bf16 a[252:255], v[156:159], a[92:95], a[252:255]
    buffer_load_dwordx4 a[136:139], v160, s[44:47], s10 offen offset:2048 sc1
    v_mfma_f32_16x16x32_bf16 a[248:251], v[156:159], a[88:91], a[248:251]
    v_mfma_f32_16x16x32_bf16 a[244:247], v[156:159], a[84:87], a[244:247]
    buffer_load_dwordx4 a[140:143], v160, s[44:47], s10 offen offset:3072 sc1
    s_add_u32 s10, s71, 36864
    s_waitcnt lgkmcnt(0)
    v_mfma_f32_16x16x32_bf16 a[240:243], v[156:159], a[80:83], a[240:243]
    buffer_load_dwordx4 a[144:147], v160, s[44:47], s10 offen offset:0 sc1
    v_mfma_f32_16x16x32_bf16 a[192:195], v[128:131], a[96:99], a[192:195]
    s_buffer_load_dwordx4 s[16:19], s[44:47], s66 offset:528 glc
    v_add_u32 v180, 0xffff4000, v180
    ds_read_b64_tr_b16 v[144:145], v180 offset:0
    v_mfma_f32_16x16x32_bf16 a[196:199], v[128:131], a[100:103], a[196:199]
    buffer_load_dwordx4 a[148:151], v160, s[44:47], s10 offen offset:1024 sc1
    v_mfma_f32_16x16x32_bf16 a[200:203], v[128:131], a[104:107], a[200:203]
    ds_read_b64_tr_b16 v[146:147], v180 offset:2048
    v_mfma_f32_16x16x32_bf16 a[204:207], v[128:131], a[108:111], a[204:207]
    v_add_u32 v181, 0xffff4000, v181
    ds_read_b64_tr_b16 v[148:149], v181 offset:0
    v_mfma_f32_16x16x32_bf16 a[220:223], v[132:135], a[108:111], a[220:223]
    v_mfma_f32_16x16x32_bf16 a[216:219], v[132:135], a[104:107], a[216:219]
    ds_read_b64_tr_b16 v[150:151], v181 offset:2048
    v_mfma_f32_16x16x32_bf16 a[212:215], v[132:135], a[100:103], a[212:215]
    v_add_u32 v182, 0xffff4000, v182
    ds_read_b64_tr_b16 v[152:153], v182 offset:0
    v_mfma_f32_16x16x32_bf16 a[208:211], v[132:135], a[96:99], a[208:211]
    buffer_load_dwordx4 a[152:155], v160, s[44:47], s10 offen offset:2048 sc1
    v_mfma_f32_16x16x32_bf16 a[224:227], v[136:139], a[96:99], a[224:227]
    ds_read_b64_tr_b16 v[154:155], v182 offset:2048
    v_mfma_f32_16x16x32_bf16 a[228:231], v[136:139], a[100:103], a[228:231]
    v_add_u32 v183, 0xffff4000, v183
    ds_read_b64_tr_b16 v[156:157], v183 offset:0
    v_mfma_f32_16x16x32_bf16 a[232:235], v[136:139], a[104:107], a[232:235]
    v_mfma_f32_16x16x32_bf16 a[236:239], v[136:139], a[108:111], a[236:239]
    ds_read_b64_tr_b16 v[158:159], v183 offset:2048
    ds_read_b32 v170, v160
    v_mfma_f32_16x16x32_bf16 a[252:255], v[140:143], a[108:111], a[252:255]
    ds_read_b32 v170, v160
    buffer_load_dwordx4 a[156:159], v160, s[44:47], s10 offen offset:3072 sc1
    s_add_u32 s10, s71, 40960
    v_mfma_f32_16x16x32_bf16 a[248:251], v[140:143], a[104:107], a[248:251]
    buffer_load_dwordx4 a[160:163], v160, s[44:47], s10 offen offset:0 sc1
    v_mfma_f32_16x16x32_bf16 a[244:247], v[140:143], a[100:103], a[244:247]
    s_waitcnt lgkmcnt(2)
    v_mfma_f32_16x16x32_bf16 a[240:243], v[140:143], a[96:99], a[240:243]
    buffer_load_dwordx4 a[164:167], v160, s[44:47], s10 offen offset:1024 sc1
    v_mfma_f32_16x16x32_bf16 a[192:195], v[144:147], a[112:115], a[192:195]
    ds_read_b64_tr_b16 v[128:129], v180 offset:16384
    v_mfma_f32_16x16x32_bf16 a[196:199], v[144:147], a[116:119], a[196:199]
    buffer_load_dwordx4 a[168:171], v160, s[44:47], s10 offen offset:2048 sc1
    v_mfma_f32_16x16x32_bf16 a[200:203], v[144:147], a[120:123], a[200:203]
    ds_read_b64_tr_b16 v[130:131], v180 offset:18432
    v_mfma_f32_16x16x32_bf16 a[204:207], v[144:147], a[124:127], a[204:207]
    ds_read_b64_tr_b16 v[132:133], v181 offset:16384
    v_mfma_f32_16x16x32_bf16 a[220:223], v[148:151], a[124:127], a[220:223]
    v_mfma_f32_16x16x32_bf16 a[216:219], v[148:151], a[120:123], a[216:219]
    ds_read_b64_tr_b16 v[134:135], v181 offset:18432
    v_mfma_f32_16x16x32_bf16 a[212:215], v[148:151], a[116:119], a[212:215]
    ds_read_b64_tr_b16 v[136:137], v182 offset:16384
    v_mfma_f32_16x16x32_bf16 a[208:211], v[148:151], a[112:115], a[208:211]
    buffer_load_dwordx4 a[172:175], v160, s[44:47], s10 offen offset:3072 sc1
    v_mfma_f32_16x16x32_bf16 a[224:227], v[152:155], a[112:115], a[224:227]
    ds_read_b64_tr_b16 v[138:139], v182 offset:18432
    v_mfma_f32_16x16x32_bf16 a[228:231], v[152:155], a[116:119], a[228:231]
    ds_read_b64_tr_b16 v[140:141], v183 offset:16384
    v_mfma_f32_16x16x32_bf16 a[232:235], v[152:155], a[120:123], a[232:235]
    v_mfma_f32_16x16x32_bf16 a[236:239], v[152:155], a[124:127], a[236:239]
    ds_read_b64_tr_b16 v[142:143], v183 offset:18432
    ds_read_b32 v170, v160
    s_add_u32 s10, s71, 45056
    v_mfma_f32_16x16x32_bf16 a[252:255], v[156:159], a[124:127], a[252:255]
    ds_read_b32 v170, v160
    buffer_load_dwordx4 a[176:179], v160, s[44:47], s10 offen offset:0 sc1
    v_mfma_f32_16x16x32_bf16 a[248:251], v[156:159], a[120:123], a[248:251]
    buffer_load_dwordx4 a[180:183], v160, s[44:47], s10 offen offset:1024 sc1
    v_mfma_f32_16x16x32_bf16 a[244:247], v[156:159], a[116:119], a[244:247]
    s_waitcnt vmcnt(10) lgkmcnt(2)
    v_mfma_f32_16x16x32_bf16 a[240:243], v[156:159], a[112:115], a[240:243]
    buffer_load_dwordx4 a[184:187], v160, s[44:47], s10 offen offset:2048 sc1
    v_mfma_f32_16x16x32_bf16 a[192:195], v[128:131], a[128:131], a[192:195]
    s_waitcnt lgkmcnt(0)
    s_and_b64 s[16:17], s[16:17], s[18:19]
    s_and_b32 s16, s16, s17
    s_cmp_eq_u32 s16, 64
    s_cbranch_scc0 L_try5
L_ok5:
    ds_read_b64_tr_b16 v[144:145], v180 offset:32768
    v_mfma_f32_16x16x32_bf16 a[196:199], v[128:131], a[132:135], a[196:199]
    buffer_load_dwordx4 a[188:191], v160, s[44:47], s10 offen offset:3072 sc1
    v_mfma_f32_16x16x32_bf16 a[200:203], v[128:131], a[136:139], a[200:203]
    ds_read_b64_tr_b16 v[146:147], v180 offset:34816
    v_mfma_f32_16x16x32_bf16 a[204:207], v[128:131], a[140:143], a[204:207]
    ds_read_b64_tr_b16 v[148:149], v181 offset:32768
    v_mfma_f32_16x16x32_bf16 a[220:223], v[132:135], a[140:143], a[220:223]
    v_mfma_f32_16x16x32_bf16 a[216:219], v[132:135], a[136:139], a[216:219]
    ds_read_b64_tr_b16 v[150:151], v181 offset:34816
    v_mfma_f32_16x16x32_bf16 a[212:215], v[132:135], a[132:135], a[212:215]
    ds_read_b64_tr_b16 v[152:153], v182 offset:32768
    s_add_u32 s10, s71, 49152
    v_mfma_f32_16x16x32_bf16 a[208:211], v[132:135], a[128:131], a[208:211]
    buffer_load_dwordx4 a[0:3], v160, s[44:47], s10 offen offset:0 sc1
    v_mfma_f32_16x16x32_bf16 a[224:227], v[136:139], a[128:131], a[224:227]
    ds_read_b64_tr_b16 v[154:155], v182 offset:34816
    v_mfma_f32_16x16x32_bf16 a[228:231], v[136:139], a[132:135], a[228:231]
    ds_read_b64_tr_b16 v[156:157], v183 offset:32768
    v_mfma_f32_16x16x32_bf16 a[232:235], v[136:139], a[136:139], a[232:235]
    v_mfma_f32_16x16x32_bf16 a[236:239], v[136:139], a[140:143], a[236:239]
    ds_read_b64_tr_b16 v[158:159], v183 offset:34816
    v_mfma_f32_16x16x32_bf16 a[252:255], v[140:143], a[140:143], a[252:255]
    buffer_load_dwordx4 a[4:7], v160, s[44:47], s10 offen offset:1024 sc1
    v_mfma_f32_16x16x32_bf16 a[248:251], v[140:143], a[136:139], a[248:251]
    buffer_load_dwordx4 a[8:11], v160, s[44:47], s10 offen offset:2048 sc1
    v_mfma_f32_16x16x32_bf16 a[244:247], v[140:143], a[132:135], a[244:247]
    s_waitcnt vmcnt(11) lgkmcnt(0)
    v_mfma_f32_16x16x32_bf16 a[240:243], v[140:143], a[128:131], a[240:243]
    buffer_load_dwordx4 a[12:15], v160, s[44:47], s10 offen offset:3072 sc1
    v_mfma_f32_16x16x32_bf16 a[192:195], v[144:147], a[144:147], a[192:195]
    s_buffer_load_dwordx4 s[20:23], s[44:47], s66 offset:256 glc
    v_add_u32 v180, 0xffff4000, v180
    ds_read_b64_tr_b16 v[128:129], v180 offset:32768
    s_add_u32 s10, s71, 53248
    v_mfma_f32_16x16x32_bf16 a[196:199], v[144:147], a[148:151], a[196:199]
    buffer_load_dwordx4 a[16:19], v160, s[44:47], s10 offen offset:0 sc1
    v_mfma_f32_16x16x32_bf16 a[200:203], v[144:147], a[152:155], a[200:203]
    ds_read_b64_tr_b16 v[130:131], v180 offset:34816
    v_mfma_f32_16x16x32_bf16 a[204:207], v[144:147], a[156:159], a[204:207]
    v_add_u32 v181, 0xffff4000, v181
    ds_read_b64_tr_b16 v[132:133], v181 offset:32768
    v_mfma_f32_16x16x32_bf16 a[220:223], v[148:151], a[156:159], a[220:223]
    v_mfma_f32_16x16x32_bf16 a[216:219], v[148:151], a[152:155], a[216:219]
    ds_read_b64_tr_b16 v[134:135], v181 offset:34816
    v_mfma_f32_16x16x32_bf16 a[212:215], v[148:151], a[148:151], a[212:215]
    v_add_u32 v182, 0xffff4000, v182
    ds_read_b64_tr_b16 v[136:137], v182 offset:32768
    v_mfma_f32_16x16x32_bf16 a[208:211], v[148:151], a[144:147], a[208:211]
    buffer_load_dwordx4 a[20:23], v160, s[44:47], s10 offen offset:1024 sc1
    v_mfma_f32_16x16x32_bf16 a[224:227], v[152:155], a[144:147], a[224:227]
    ds_read_b64_tr_b16 v[138:139], v182 offset:34816
    v_mfma_f32_16x16x32_bf16 a[228:231], v[152:155], a[148:151], a[228:231]
    v_add_u32 v183, 0xffff4000, v183
    ds_read_b64_tr_b16 v[140:141], v183 offset:32768
    v_mfma_f32_16x16x32_bf16 a[232:235], v[152:155], a[152:155], a[232:235]
    v_mfma_f32_16x16x32_bf16 a[236:239], v[152:155], a[156:159], a[236:239]
    ds_read_b64_tr_b16 v[142:143], v183 offset:34816
    ds_read_b32 v170, v160
    v_mfma_f32_16x16x32_bf16 a[252:255], v[156:159], a[156:159], a[252:255]
    ds_read_b32 v170, v160
    buffer_load_dwordx4 a[24:27], v160, s[44:47], s10 offen offset:2048 sc1
    v_mfma_f32_16x16x32_bf16 a[248:251], v[156:159], a[152:155], a[248:251]
    buffer_load_dwordx4 a[28:31], v160, s[44:47], s10 offen offset:3072 sc1
    v_mfma_f32_16x16x32_bf16 a[244:247], v[156:159], a[148:151], a[244:247]
    s_add_u32 m0, s60, 131072
    s_add_u32 s9, s62, 32768
    s_waitcnt vmcnt(12) lgkmcnt(2)
    v_mfma_f32_16x16x32_bf16 a[240:243], v[156:159], a[144:147], a[240:243]
    buffer_load_dwordx4 v168, s[40:43], s9 offen lds
    v_mfma_f32_16x16x32_bf16 a[192:195], v[128:131], a[160:163], a[192:195]
    ds_read_b64_tr_b16 v[144:145], v180 offset:0
    v_mfma_f32_16x16x32_bf16 a[196:199], v[128:131], a[164:167], a[196:199]
    buffer_load_dwordx4 v[0:3], v174, s[24:27], s72 offen offset:1024
    v_mfma_f32_16x16x32_bf16 a[200:203], v[128:131], a[168:171], a[200:203]
    ds_read_b64_tr_b16 v[146:147], v180 offset:2048
    v_mfma_f32_16x16x32_bf16 a[204:207], v[128:131], a[172:175], a[204:207]
    ds_read_b64_tr_b16 v[148:149], v181 offset:0
    s_add_u32 s11, s72, 8192
    v_mfma_f32_16x16x32_bf16 a[220:223], v[132:135], a[172:175], a[220:223]
    buffer_load_dwordx4 v[4:7], v174, s[24:27], s11 offen offset:1024
    v_mfma_f32_16x16x32_bf16 a[216:219], v[132:135], a[168:171], a[216:219]
    ds_read_b64_tr_b16 v[150:151], v181 offset:2048
    v_mfma_f32_16x16x32_bf16 a[212:215], v[132:135], a[164:167], a[212:215]
    ds_read_b64_tr_b16 v[152:153], v182 offset:0
    s_add_u32 m0, s60, 132096
    s_add_u32 s9, s62, 40960
    v_mfma_f32_16x16x32_bf16 a[208:211], v[132:135], a[160:163], a[208:211]
    buffer_load_dwordx4 v168, s[40:43], s9 offen lds
    v_mfma_f32_16x16x32_bf16 a[224:227], v[136:139], a[160:163], a[224:227]
    ds_read_b64_tr_b16 v[154:155], v182 offset:2048
    v_mfma_f32_16x16x32_bf16 a[228:231], v[136:139], a[164:167], a[228:231]
    ds_read_b64_tr_b16 v[156:157], v183 offset:0
    v_mfma_f32_16x16x32_bf16 a[232:235], v[136:139], a[168:171], a[232:235]
    v_mfma_f32_16x16x32_bf16 a[236:239], v[136:139], a[172:175], a[236:239]
    ds_read_b64_tr_b16 v[158:159], v183 offset:2048
    ds_read_b32 v170, v160
    s_add_u32 m0, s60, 133120
    s_add_u32 s9, s62, 49152
    v_mfma_f32_16x16x32_bf16 a[252:255], v[140:143], a[172:175], a[252:255]
    ds_read_b32 v170, v160
    buffer_load_dwordx4 v168, s[40:43], s9 offen lds
    s_add_u32 m0, s60, 134144
    s_add_u32 s9, s62, 57344
    v_mfma_f32_16x16x32_bf16 a[248:251], v[140:143], a[168:171], a[248:251]
    buffer_load_dwordx4 v168, s[40:43], s9 offen lds
    s_add_u32 m0, s60, 147456
L_stub5:
    s_cbranch_execz L_tourret
    s_nop 0
    s_add_u32 s9, s62, 65536
    v_mfma_f32_16x16x32_bf16 a[244:247], v[140:143], a[164:167], a[244:247]
    buffer_load_dwordx4 v168, s[40:43], s9 offen lds
    s_add_u32 m0, s60, 148480
    s_add_u32 s9, s62, 73728
    s_waitcnt vmcnt(15) lgkmcnt(2)
    v_mfma_f32_16x16x32_bf16 a[240:243], v[140:143], a[160:163], a[240:243]
    buffer_load_dwordx4 v168, s[40:43], s9 offen lds
    v_mfma_f32_16x16x32_bf16 a[192:195], v[144:147], a[176:179], a[192:195]
    s_waitcnt lgkmcnt(0)
    s_and_b64 s[20:21], s[20:21], s[22:23]
    s_and_b32 s20, s20, s21
    s_cmp_eq_u32 s20, 64
    s_cbranch_scc0 L_try6
L_ok6:
    ds_read_b64_tr_b16 v[128:129], v180 offset:16384
    s_add_u32 s10, s71, 57344
    v_mfma_f32_16x16x32_bf16 a[196:199], v[144:147], a[180:183], a[196:199]
    buffer_load_dwordx4 a[32:35], v160, s[44:47], s10 offen offset:0 sc1
    v_mfma_f32_16x16x32_bf16 a[200:203], v[144:147], a[184:187], a[200:203]
    ds_read_b64_tr_b16 v[130:131], v180 offset:18432
    v_mfma_f32_16x16x32_bf16 a[204:207], v[144:147], a[188:191], a[204:207]
    ds_read_b64_tr_b16 v[132:133], v181 offset:16384
    v_mfma_f32_16x16x32_bf16 a[220:223], v[148:151], a[188:191], a[220:223]
    v_mfma_f32_16x16x32_bf16 a[216:219], v[148:151], a[184:187], a[216:219]
    ds_read_b64_tr_b16 v[134:135], v181 offset:18432
    v_mfma_f32_16x16x32_bf16 a[212:215], v[148:151], a[180:183], a[212:215]
    ds_read_b64_tr_b16 v[136:137], v182 offset:16384
    v_mfma_f32_16x16x32_bf16 a[208:211], v[148:151], a[176:179], a[208:211]
    buffer_load_dwordx4 a[36:39], v160, s[44:47], s10 offen offset:1024 sc1
    v_mfma_f32_16x16x32_bf16 a[224:227], v[152:155], a[176:179], a[224:227]
    ds_read_b64_tr_b16 v[138:139], v182 offset:18432
    v_mfma_f32_16x16x32_bf16 a[228:231], v[152:155], a[180:183], a[228:231]
    ds_read_b64_tr_b16 v[140:141], v183 offset:16384
    v_mfma_f32_16x16x32_bf16 a[232:235], v[152:155], a[184:187], a[232:235]
    v_mfma_f32_16x16x32_bf16 a[236:239], v[152:155], a[188:191], a[236:239]
    ds_read_b64_tr_b16 v[142:143], v183 offset:18432
    v_mfma_f32_16x16x32_bf16 a[252:255], v[156:159], a[188:191], a[252:255]
    buffer_load_dwordx4 a[40:43], v160, s[44:47], s10 offen offset:2048 sc1
    v_mfma_f32_16x16x32_bf16 a[248:251], v[156:159], a[184:187], a[248:251]
    buffer_load_dwordx4 a[44:47], v160, s[44:47], s10 offen offset:3072 sc1
    v_mfma_f32_16x16x32_bf16 a[244:247], v[156:159], a[180:183], a[244:247]
    s_add_u32 s10, s71, 61440
    s_waitcnt vmcnt(16) lgkmcnt(0)
    v_mfma_f32_16x16x32_bf16 a[240:243], v[156:159], a[176:179], a[240:243]
    buffer_load_dwordx4 a[48:51], v160, s[44:47], s10 offen offset:0 sc1
    v_mfma_f32_16x16x32_bf16 a[192:195], v[128:131], a[0:3], a[192:195]
    v_add_u32 v180, 0x18000, v180
    ds_read_b64_tr_b16 v[144:145], v180 offset:0
    v_mfma_f32_16x16x32_bf16 a[196:199], v[128:131], a[4:7], a[196:199]
    buffer_load_dwordx4 a[52:55], v160, s[44:47], s10 offen offset:1024 sc1
    v_mfma_f32_16x16x32_bf16 a[200:203], v[128:131], a[8:11], a[200:203]
    ds_read_b64_tr_b16 v[146:147], v180 offset:2048
    v_mfma_f32_16x16x32_bf16 a[204:207], v[128:131], a[12:15], a[204:207]
    v_add_u32 v181, 0x18000, v181
    ds_read_b64_tr_b16 v[148:149], v181 offset:0
    v_mfma_f32_16x16x32_bf16 a[220:223], v[132:135], a[12:15], a[220:223]
    v_mfma_f32_16x16x32_bf16 a[216:219], v[132:135], a[8:11], a[216:219]
    ds_read_b64_tr_b16 v[150:151], v181 offset:2048
    v_mfma_f32_16x16x32_bf16 a[212:215], v[132:135], a[4:7], a[212:215]
    v_add_u32 v182, 0x18000, v182
    ds_read_b64_tr_b16 v[152:153], v182 offset:0
    v_mfma_f32_16x16x32_bf16 a[208:211], v[132:135], a[0:3], a[208:211]
    buffer_load_dwordx4 a[56:59], v160, s[44:47], s10 offen offset:2048 sc1
    v_mfma_f32_16x16x32_bf16 a[224:227], v[136:139], a[0:3], a[224:227]
    ds_read_b64_tr_b16 v[154:155], v182 offset:2048
    v_mfma_f32_16x16x32_bf16 a[228:231], v[136:139], a[4:7], a[228:231]
    v_add_u32 v183, 0x18000, v183
    ds_read_b64_tr_b16 v[156:157], v183 offset:0
    v_mfma_f32_16x16x32_bf16 a[232:235], v[136:139], a[8:11], a[232:235]
    v_mfma_f32_16x16x32_bf16 a[236:239], v[136:139], a[12:15], a[236:239]
    ds_read_b64_tr_b16 v[158:159], v183 offset:2048
    v_mfma_f32_16x16x32_bf16 a[252:255], v[140:143], a[12:15], a[252:255]
    buffer_load_dwordx4 a[60:63], v160, s[44:47], s10 offen offset:3072 sc1
    s_add_u32 m0, s60, 149504
    s_add_u32 s9, s62, 81920
    v_mfma_f32_16x16x32_bf16 a[248:251], v[140:143], a[8:11], a[248:251]
    buffer_load_dwordx4 v168, s[40:43], s9 offen lds
    v_mfma_f32_16x16x32_bf16 a[244:247], v[140:143], a[4:7], a[244:247]
    s_add_u32 m0, s60, 150528
    s_add_u32 s9, s62, 90112
    s_waitcnt vmcnt(17) lgkmcnt(0)
    v_mfma_f32_16x16x32_bf16 a[240:243], v[140:143], a[0:3], a[240:243]
    buffer_load_dwordx4 v168, s[40:43], s9 offen lds
    v_mfma_f32_16x16x32_bf16 a[192:195], v[144:147], a[16:19], a[192:195]
    ds_read_b64_tr_b16 v[128:129], v180 offset:16384
    s_add_u32 s10, s71, 65536
    v_mfma_f32_16x16x32_bf16 a[196:199], v[144:147], a[20:23], a[196:199]
    buffer_load_dwordx4 a[64:67], v160, s[44:47], s10 offen offset:0 sc1
    v_mfma_f32_16x16x32_bf16 a[200:203], v[144:147], a[24:27], a[200:203]
    ds_read_b64_tr_b16 v[130:131], v180 offset:18432
    v_mfma_f32_16x16x32_bf16 a[204:207], v[144:147], a[28:31], a[204:207]
    ds_read_b64_tr_b16 v[132:133], v181 offset:16384
    v_mfma_f32_16x16x32_bf16 a[220:223], v[148:151], a[28:31], a[220:223]
    v_mfma_f32_16x16x32_bf16 a[216:219], v[148:151], a[24:27], a[216:219]
    ds_read_b64_tr_b16 v[134:135], v181 offset:18432
    v_mfma_f32_16x16x32_bf16 a[212:215], v[148:151], a[20:23], a[212:215]
    ds_read_b64_tr_b16 v[136:137], v182 offset:16384
    v_mfma_f32_16x16x32_bf16 a[208:211], v[148:151], a[16:19], a[208:211]
    buffer_load_dwordx4 a[68:71], v160, s[44:47], s10 offen offset:1024 sc1
    v_mfma_f32_16x16x32_bf16 a[224:227], v[152:155], a[16:19], a[224:227]
    ds_read_b64_tr_b16 v[138:139], v182 offset:18432
    v_mfma_f32_16x16x32_bf16 a[228:231], v[152:155], a[20:23], a[228:231]
    ds_read_b64_tr_b16 v[140:141], v183 offset:16384
    v_mfma_f32_16x16x32_bf16 a[232:235], v[152:155], a[24:27], a[232:235]
    v_mfma_f32_16x16x32_bf16 a[236:239], v[152:155], a[28:31], a[236:239]
    ds_read_b64_tr_b16 v[142:143], v183 offset:18432
    v_mfma_f32_16x16x32_bf16 a[252:255], v[156:159], a[28:31], a[252:255]
    buffer_load_dwordx4 a[72:75], v160, s[44:47], s10 offen offset:2048 sc1
    v_mfma_f32_16x16x32_bf16 a[248:251], v[156:159], a[24:27], a[248:251]
    buffer_load_dwordx4 a[76:79], v160, s[44:47], s10 offen offset:3072 sc1
    v_mfma_f32_16x16x32_bf16 a[244:247], v[156:159], a[20:23], a[244:247]
    s_add_u32 m0, s60, 65536
    s_add_u32 s9, s62, 98304
    s_waitcnt vmcnt(10) lgkmcnt(0)
    v_mfma_f32_16x16x32_bf16 a[240:243], v[156:159], a[16:19], a[240:243]
    buffer_load_dwordx4 v168, s[40:43], s9 offen lds
    v_mfma_f32_16x16x32_bf16 a[192:195], v[128:131], a[32:35], a[192:195]
    ds_read_b64_tr_b16 v[144:145], v180 offset:32768
    s_add_u32 m0, s60, 66560
    s_add_u32 s9, s62, 106496
    v_mfma_f32_16x16x32_bf16 a[196:199], v[128:131], a[36:39], a[196:199]
    buffer_load_dwordx4 v168, s[40:43], s9 offen lds
    v_mfma_f32_16x16x32_bf16 a[200:203], v[128:131], a[40:43], a[200:203]
    ds_read_b64_tr_b16 v[146:147], v180 offset:34816
    v_mfma_f32_16x16x32_bf16 a[204:207], v[128:131], a[44:47], a[204:207]
    ds_read_b64_tr_b16 v[148:149], v181 offset:32768
    v_mfma_f32_16x16x32_bf16 a[220:223], v[132:135], a[44:47], a[220:223]
    v_mfma_f32_16x16x32_bf16 a[216:219], v[132:135], a[40:43], a[216:219]
    ds_read_b64_tr_b16 v[150:151], v181 offset:34816
    v_mfma_f32_16x16x32_bf16 a[212:215], v[132:135], a[36:39], a[212:215]
    ds_read_b64_tr_b16 v[152:153], v182 offset:32768
    s_add_u32 m0, s60, 67584
    s_add_u32 s9, s62, 114688
    v_mfma_f32_16x16x32_bf16 a[208:211], v[132:135], a[32:35], a[208:211]
    buffer_load_dwordx4 v168, s[40:43], s9 offen lds
    v_mfma_f32_16x16x32_bf16 a[224:227], v[136:139], a[32:35], a[224:227]
    ds_read_b64_tr_b16 v[154:155], v182 offset:34816
    v_mfma_f32_16x16x32_bf16 a[228:231], v[136:139], a[36:39], a[228:231]
    ds_read_b64_tr_b16 v[156:157], v183 offset:32768
    v_mfma_f32_16x16x32_bf16 a[232:235], v[136:139], a[40:43], a[232:235]
    v_mfma_f32_16x16x32_bf16 a[236:239], v[136:139], a[44:47], a[236:239]
    ds_read_b64_tr_b16 v[158:159], v183 offset:34816
    s_add_u32 m0, s60, 68608
    s_add_u32 s9, s62, 122880
    v_mfma_f32_16x16x32_bf16 a[252:255], v[140:143], a[44:47], a[252:255]
    buffer_load_dwordx4 v168, s[40:43], s9 offen lds
    s_add_u32 s10, s71, 69632
    v_mfma_f32_16x16x32_bf16 a[248:251], v[140:143], a[40:43], a[248:251]
    buffer_load_dwordx4 a[80:83], v160, s[44:47], s10 offen offset:0 sc1
    v_mfma_f32_16x16x32_bf16 a[244:247], v[140:143], a[36:39], a[244:247]
    s_waitcnt vmcnt(9) lgkmcnt(0)
    v_mfma_f32_16x16x32_bf16 a[240:243], v[140:143], a[32:35], a[240:243]
    buffer_load_dwordx4 a[84:87], v160, s[44:47], s10 offen offset:1024 sc1
    v_mfma_f32_16x16x32_bf16 a[192:195], v[144:147], a[48:51], a[192:195]
    ds_read_b64_tr_b16 v[128:129], v180 offset:49152
    v_mfma_f32_16x16x32_bf16 a[196:199], v[144:147], a[52:55], a[196:199]
    v_mfma_f32_16x16x32_bf16 a[200:203], v[144:147], a[56:59], a[200:203]
    ds_read_b64_tr_b16 v[130:131], v180 offset:51200
    v_mfma_f32_16x16x32_bf16 a[204:207], v[144:147], a[60:63], a[204:207]
    ds_read_b64_tr_b16 v[132:133], v181 offset:49152
    v_mfma_f32_16x16x32_bf16 a[220:223], v[148:151], a[60:63], a[220:223]
    v_mfma_f32_16x16x32_bf16 a[216:219], v[148:151], a[56:59], a[216:219]
    ds_read_b64_tr_b16 v[134:135], v181 offset:51200
    v_mfma_f32_16x16x32_bf16 a[212:215], v[148:151], a[52:55], a[212:215]
    ds_read_b64_tr_b16 v[136:137], v182 offset:49152
    v_mfma_f32_16x16x32_bf16 a[208:211], v[148:151], a[48:51], a[208:211]
    buffer_load_dwordx4 a[88:91], v160, s[44:47], s10 offen offset:2048 sc1
    v_mfma_f32_16x16x32_bf16 a[224:227], v[152:155], a[48:51], a[224:227]
    ds_read_b64_tr_b16 v[138:139], v182 offset:51200
    v_mfma_f32_16x16x32_bf16 a[228:231], v[152:155], a[52:55], a[228:231]
    ds_read_b64_tr_b16 v[140:141], v183 offset:49152
    v_mfma_f32_16x16x32_bf16 a[232:235], v[152:155], a[56:59], a[232:235]
    v_mfma_f32_16x16x32_bf16 a[236:239], v[152:155], a[60:63], a[236:239]
    ds_read_b64_tr_b16 v[142:143], v183 offset:51200
    v_mfma_f32_16x16x32_bf16 a[252:255], v[156:159], a[60:63], a[252:255]
    v_mfma_f32_16x16x32_bf16 a[248:251], v[156:159], a[56:59], a[248:251]
    v_mfma_f32_16x16x32_bf16 a[244:247], v[156:159], a[52:55], a[244:247]
    buffer_load_dwordx4 a[92:95], v160, s[44:47], s10 offen offset:3072 sc1
    s_waitcnt vmcnt(4) lgkmcnt(0)
    v_mfma_f32_16x16x32_bf16 a[240:243], v[156:159], a[48:51], a[240:243]
    v_mfma_f32_16x16x32_bf16 a[192:195], v[128:131], a[64:67], a[192:195]
    v_add_u32 v180, 0xffff8000, v180
    ds_read_b64_tr_b16 v[144:145], v180 offset:0
    v_mfma_f32_16x16x32_bf16 a[196:199], v[128:131], a[68:71], a[196:199]
    v_xor_b32 v185, 64, v175
    v_xor_b32 v186, 128, v175
    v_mfma_f32_16x16x32_bf16 a[200:203], v[128:131], a[72:75], a[200:203]
    ds_read_b64_tr_b16 v[146:147], v180 offset:2048
    v_xor_b32 v187, 192, v175
    v_mfma_f32_16x16x32_bf16 a[204:207], v[128:131], a[76:79], a[204:207]
    v_add_u32 v181, 0xffff8000, v181
    ds_read_b64_tr_b16 v[148:149], v181 offset:0
    v_mfma_f32_16x16x32_bf16 a[220:223], v[132:135], a[76:79], a[220:223]
    v_xor_b32 v184, 16, v176
    v_lshlrev_b32 v8, 16, v0
    v_mfma_f32_16x16x32_bf16 a[216:219], v[132:135], a[72:75], a[216:219]
    ds_read_b64_tr_b16 v[150:151], v181 offset:2048
    v_and_b32 v9, 0xffff0000, v0
    v_mfma_f32_16x16x32_bf16 a[212:215], v[132:135], a[68:71], a[212:215]
    v_add_u32 v182, 0xffff8000, v182
    ds_read_b64_tr_b16 v[152:153], v182 offset:0
    v_mfma_f32_16x16x32_bf16 a[208:211], v[132:135], a[64:67], a[208:211]
    v_lshlrev_b32 v10, 16, v1
    v_and_b32 v11, 0xffff0000, v1
    v_lshlrev_b32 v12, 16, v2
    v_mfma_f32_16x16x32_bf16 a[224:227], v[136:139], a[64:67], a[224:227]
    ds_read_b64_tr_b16 v[154:155], v182 offset:2048
    v_and_b32 v13, 0xffff0000, v2
    v_mfma_f32_16x16x32_bf16 a[228:231], v[136:139], a[68:71], a[228:231]
    v_add_u32 v183, 0xffff8000, v183
    ds_read_b64_tr_b16 v[156:157], v183 offset:0
    v_mfma_f32_16x16x32_bf16 a[232:235], v[136:139], a[72:75], a[232:235]
    v_lshlrev_b32 v14, 16, v3
    v_and_b32 v15, 0xffff0000, v3
    v_mfma_f32_16x16x32_bf16 a[236:239], v[136:139], a[76:79], a[236:239]
    ds_read_b64_tr_b16 v[158:159], v183 offset:2048
    v_lshlrev_b32 v16, 16, v4
    v_mfma_f32_16x16x32_bf16 a[252:255], v[140:143], a[76:79], a[252:255]
    v_and_b32 v17, 0xffff0000, v4
    v_lshlrev_b32 v18, 16, v5
    v_mfma_f32_16x16x32_bf16 a[248:251], v[140:143], a[72:75], a[248:251]
    v_and_b32 v19, 0xffff0000, v5
    v_lshlrev_b32 v20, 16, v6
    v_mfma_f32_16x16x32_bf16 a[244:247], v[140:143], a[68:71], a[244:247]
    v_and_b32 v21, 0xffff0000, v6
    v_lshlrev_b32 v22, 16, v7
    s_waitcnt vmcnt(0) lgkmcnt(0)
    v_mfma_f32_16x16x32_bf16 a[240:243], v[140:143], a[64:67], a[240:243]
    v_and_b32 v23, 0xffff0000, v7
    v_mfma_f32_16x16x32_bf16 a[192:195], v[144:147], a[80:83], a[192:195]
    v_mfma_f32_16x16x32_bf16 a[196:199], v[144:147], a[84:87], a[196:199]
    v_mfma_f32_16x16x32_bf16 a[200:203], v[144:147], a[88:91], a[200:203]
    v_mfma_f32_16x16x32_bf16 a[204:207], v[144:147], a[92:95], a[204:207]
    v_mfma_f32_16x16x32_bf16 a[220:223], v[148:151], a[92:95], a[220:223]
    v_mfma_f32_16x16x32_bf16 a[216:219], v[148:151], a[88:91], a[216:219]
    v_mfma_f32_16x16x32_bf16 a[212:215], v[148:151], a[84:87], a[212:215]
    v_mfma_f32_16x16x32_bf16 a[208:211], v[148:151], a[80:83], a[208:211]
    s_nop 0
    ds_write_b128 v175, a[192:195] offset:0
    v_mfma_f32_16x16x32_bf16 a[224:227], v[152:155], a[80:83], a[224:227]
    ds_write_b128 v175, a[196:199] offset:16384
    v_mfma_f32_16x16x32_bf16 a[228:231], v[152:155], a[84:87], a[228:231]
    ds_write_b128 v175, a[200:203] offset:32768
    v_mfma_f32_16x16x32_bf16 a[232:235], v[152:155], a[88:91], a[232:235]
    ds_write_b128 v175, a[204:207] offset:49152
    v_mfma_f32_16x16x32_bf16 a[236:239], v[152:155], a[92:95], a[236:239]
    ds_write_b128 v185, a[220:223] offset:49152
    v_mfma_f32_16x16x32_bf16 a[252:255], v[156:159], a[92:95], a[252:255]
    ds_write_b128 v185, a[216:219] offset:32768
    v_mfma_f32_16x16x32_bf16 a[248:251], v[156:159], a[88:91], a[248:251]
    ds_write_b128 v185, a[212:215] offset:16384
    v_mfma_f32_16x16x32_bf16 a[244:247], v[156:159], a[84:87], a[244:247]
    ds_write_b128 v185, a[208:211] offset:0
    v_mfma_f32_16x16x32_bf16 a[240:243], v[156:159], a[80:83], a[240:243]
    ds_write_b128 v186, a[224:227] offset:0
    ds_write_b128 v186, a[228:231] offset:16384
    ds_write_b128 v186, a[232:235] offset:32768
    ds_write_b128 v186, a[236:239] offset:49152
    ds_write_b128 v187, a[252:255] offset:49152
    ds_write_b128 v187, a[248:251] offset:32768
    ds_write_b128 v187, a[244:247] offset:16384
    s_nop 0
    ds_write_b128 v187, a[240:243] offset:0
    s_waitcnt lgkmcnt(0)
    s_barrier
    ds_read_b128 v[64:67], v176 offset:0
    ds_read_b128 v[68:71], v184 offset:0
    ds_read_b128 v[72:75], v176 offset:4096
    ds_read_b128 v[76:79], v184 offset:4096
    ds_read_b128 v[80:83], v176 offset:8192
    ds_read_b128 v[84:87], v184 offset:8192
    ds_read_b128 v[88:91], v176 offset:12288
    ds_read_b128 v[92:95], v184 offset:12288
    ds_read_b128 v[96:99], v176 offset:2048
    ds_read_b128 v[100:103], v184 offset:2048
    ds_read_b128 v[104:107], v176 offset:6144
    ds_read_b128 v[108:111], v184 offset:6144
    ds_read_b128 v[112:115], v176 offset:10240
    ds_read_b128 v[116:119], v184 offset:10240
    ds_read_b128 v[120:123], v176 offset:14336
    ds_read_b128 v[124:127], v184 offset:14336
    s_waitcnt lgkmcnt(15)
    v_add_f32 v8, v8, v64
    v_add_f32 v9, v9, v65
    v_add_f32 v10, v10, v66
    v_add_f32 v11, v11, v67
    s_waitcnt lgkmcnt(14)
    v_add_f32 v12, v12, v68
    v_add_f32 v13, v13, v69
    v_add_f32 v14, v14, v70
    v_add_f32 v15, v15, v71
    s_waitcnt lgkmcnt(13)
    v_add_f32 v8, v8, v72
    v_add_f32 v9, v9, v73
    v_add_f32 v10, v10, v74
    v_add_f32 v11, v11, v75
    s_waitcnt lgkmcnt(12)
    v_add_f32 v12, v12, v76
    v_add_f32 v13, v13, v77
    v_add_f32 v14, v14, v78
    v_add_f32 v15, v15, v79
    s_waitcnt lgkmcnt(11)
    v_add_f32 v8, v8, v80
    v_add_f32 v9, v9, v81
    v_add_f32 v10, v10, v82
    v_add_f32 v11, v11, v83
    s_waitcnt lgkmcnt(10)
    v_add_f32 v12, v12, v84
    v_add_f32 v13, v13, v85
    v_add_f32 v14, v14, v86
    v_add_f32 v15, v15, v87
    s_waitcnt lgkmcnt(9)
    v_add_f32 v8, v8, v88
    v_add_f32 v9, v9, v89
    v_add_f32 v10, v10, v90
    v_add_f32 v11, v11, v91
    s_waitcnt lgkmcnt(8)
    v_add_f32 v12, v12, v92
    v_add_f32 v13, v13, v93
    v_add_f32 v14, v14, v94
    v_add_f32 v15, v15, v95
    v_cvt_pk_bf16_f32 v0, v8, v9
    v_cvt_pk_bf16_f32 v1, v10, v11
    v_cvt_pk_bf16_f32 v2, v12, v13
    v_cvt_pk_bf16_f32 v3, v14, v15
    buffer_store_dwordx4 v[0:3], v174, s[52:55], s72 offen sc0 sc1
    s_waitcnt lgkmcnt(7)
    v_add_f32 v16, v16, v96
    v_add_f32 v17, v17, v97
    v_add_f32 v18, v18, v98
    v_add_f32 v19, v19, v99
    s_waitcnt lgkmcnt(6)
    v_add_f32 v20, v20, v100
    v_add_f32 v21, v21, v101
    v_add_f32 v22, v22, v102
    v_add_f32 v23, v23, v103
    s_waitcnt lgkmcnt(5)
    v_add_f32 v16, v16, v104
    v_add_f32 v17, v17, v105
    v_add_f32 v18, v18, v106
    v_add_f32 v19, v19, v107
    s_waitcnt lgkmcnt(4)
    v_add_f32 v20, v20, v108
    v_add_f32 v21, v21, v109
    v_add_f32 v22, v22, v110
    v_add_f32 v23, v23, v111
    s_waitcnt lgkmcnt(3)
    v_add_f32 v16, v16, v112
    v_add_f32 v17, v17, v113
    v_add_f32 v18, v18, v114
    v_add_f32 v19, v19, v115
    s_waitcnt lgkmcnt(2)
    v_add_f32 v20, v20, v116
    v_add_f32 v21, v21, v117
    v_add_f32 v22, v22, v118
    v_add_f32 v23, v23, v119
    s_waitcnt lgkmcnt(1)
    v_add_f32 v16, v16, v120
    v_add_f32 v17, v17, v121
    v_add_f32 v18, v18, v122
    v_add_f32 v19, v19, v123
    s_waitcnt lgkmcnt(0)
    v_add_f32 v20, v20, v124
    v_add_f32 v21, v21, v125
    v_add_f32 v22, v22, v126
    v_add_f32 v23, v23, v127
    v_cvt_pk_bf16_f32 v4, v16, v17
    v_cvt_pk_bf16_f32 v5, v18, v19
    v_cvt_pk_bf16_f32 v6, v20, v21
    v_cvt_pk_bf16_f32 v7, v22, v23
    buffer_store_dwordx4 v[4:7], v174, s[52:55], s11 offen sc0 sc1
    s_endpgm
.p2align 6
L_typeB:
L_stub6:
    s_cbranch_execz L_stub10
    s_nop 0
    s_waitcnt vmcnt(7) lgkmcnt(0)
    s_barrier
    v_mfma_f32_16x16x32_bf16 v[0:3], v[128:131], a[0:3], 0
    ds_read_b128 a[32:35], v172 offset:16384
    v_mfma_f32_16x16x32_bf16 v[4:7], v[128:131], a[4:7], 0
    ds_read_b128 a[36:39], v172 offset:17408
    s_add_u32 m0, s59, 32768
    v_mfma_f32_16x16x32_bf16 v[8:11], v[128:131], a[8:11], 0
    ds_read_b128 a[40:43], v172 offset:18432
    buffer_load_dwordx4 v164, s[28:31], s56 offen offset:0 lds
    v_readlane_b32 s57, v177, 5
    v_mfma_f32_16x16x32_bf16 v[12:15], v[128:131], a[12:15], 0
    ds_read_b128 a[44:47], v172 offset:19456
    v_mfma_f32_16x16x32_bf16 v[28:31], v[132:135], a[12:15], 0
    ds_read_b64_tr_b16 v[144:145], v161 offset:8192
    v_mfma_f32_16x16x32_bf16 v[24:27], v[132:135], a[8:11], 0
    ds_read_b64_tr_b16 v[146:147], v161 offset:8704
    v_mfma_f32_16x16x32_bf16 v[20:23], v[132:135], a[4:7], 0
    ds_read_b64_tr_b16 v[148:149], v162 offset:8192
    buffer_load_dwordx4 v165, s[28:31], s56 offen offset:1024 lds
    v_mfma_f32_16x16x32_bf16 v[16:19], v[132:135], a[0:3], 0
    ds_read_b64_tr_b16 v[150:151], v162 offset:8704
    v_mfma_f32_16x16x32_bf16 v[32:35], v[136:139], a[0:3], 0
    ds_read_b64_tr_b16 v[152:153], v161 offset:12288
    s_add_u32 m0, s59, 40960
    v_mfma_f32_16x16x32_bf16 v[36:39], v[136:139], a[4:7], 0
    ds_read_b64_tr_b16 v[154:155], v161 offset:12800
    buffer_load_dwordx4 v164, s[28:31], s57 offen offset:0 lds
    v_readlane_b32 s56, v177, 6
    v_mfma_f32_16x16x32_bf16 v[40:43], v[136:139], a[8:11], 0
    ds_read_b64_tr_b16 v[156:157], v162 offset:12288
    v_mfma_f32_16x16x32_bf16 v[44:47], v[136:139], a[12:15], 0
    ds_read_b64_tr_b16 v[158:159], v162 offset:12800
    v_mfma_f32_16x16x32_bf16 v[60:63], v[140:143], a[12:15], 0
    v_mfma_f32_16x16x32_bf16 v[56:59], v[140:143], a[8:11], 0
    buffer_load_dwordx4 v165, s[28:31], s57 offen offset:1024 lds
    v_mfma_f32_16x16x32_bf16 v[52:55], v[140:143], a[4:7], 0
    s_waitcnt vmcnt(9) lgkmcnt(0)
    v_mfma_f32_16x16x32_bf16 v[48:51], v[140:143], a[0:3], 0
    s_barrier
    v_mfma_f32_16x16x32_bf16 v[0:3], v[144:147], a[16:19], v[0:3]
    ds_read_b128 a[48:51], v173 offset:24576
    v_mfma_f32_16x16x32_bf16 v[4:7], v[144:147], a[20:23], v[4:7]
    ds_read_b128 a[52:55], v173 offset:25600
    s_add_u32 m0, s59, 0
    v_mfma_f32_16x16x32_bf16 v[8:11], v[144:147], a[24:27], v[8:11]
    ds_read_b128 a[56:59], v173 offset:26624
    buffer_load_dwordx4 v164, s[28:31], s56 offen offset:0 lds
    v_readlane_b32 s57, v177, 7
    v_mfma_f32_16x16x32_bf16 v[12:15], v[144:147], a[28:31], v[12:15]
    ds_read_b128 a[60:63], v173 offset:27648
    v_mfma_f32_16x16x32_bf16 v[28:31], v[148:151], a[28:31], v[28:31]
    ds_read_b64_tr_b16 v[128:129], v161 offset:16384
    v_mfma_f32_16x16x32_bf16 v[24:27], v[148:151], a[24:27], v[24:27]
    ds_read_b64_tr_b16 v[130:131], v161 offset:16896
    v_mfma_f32_16x16x32_bf16 v[20:23], v[148:151], a[20:23], v[20:23]
    ds_read_b64_tr_b16 v[132:133], v162 offset:16384
    buffer_load_dwordx4 v165, s[28:31], s56 offen offset:1024 lds
    v_mfma_f32_16x16x32_bf16 v[16:19], v[148:151], a[16:19], v[16:19]
    ds_read_b64_tr_b16 v[134:135], v162 offset:16896
    v_mfma_f32_16x16x32_bf16 v[32:35], v[152:155], a[16:19], v[32:35]
    ds_read_b64_tr_b16 v[136:137], v161 offset:20480
    s_add_u32 m0, s59, 8192
    v_mfma_f32_16x16x32_bf16 v[36:39], v[152:155], a[20:23], v[36:39]
    ds_read_b64_tr_b16 v[138:139], v161 offset:20992
    buffer_load_dwordx4 v164, s[28:31], s57 offen offset:0 lds
    v_readlane_b32 s56, v177, 8
    v_mfma_f32_16x16x32_bf16 v[40:43], v[152:155], a[24:27], v[40:43]
    ds_read_b64_tr_b16 v[140:141], v162 offset:20480
    v_mfma_f32_16x16x32_bf16 v[44:47], v[152:155], a[28:31], v[44:47]
    ds_read_b64_tr_b16 v[142:143], v162 offset:20992
    v_mfma_f32_16x16x32_bf16 v[60:63], v[156:159], a[28:31], v[60:63]
    v_mfma_f32_16x16x32_bf16 v[56:59], v[156:159], a[24:27], v[56:59]
    buffer_load_dwordx4 v165, s[28:31], s57 offen offset:1024 lds
    v_mfma_f32_16x16x32_bf16 v[52:55], v[156:159], a[20:23], v[52:55]
    s_waitcnt vmcnt(11) lgkmcnt(0)
    v_mfma_f32_16x16x32_bf16 v[48:51], v[156:159], a[16:19], v[48:51]
    s_barrier
    v_mfma_f32_16x16x32_bf16 v[0:3], v[128:131], a[32:35], v[0:3]
    ds_read_b128 a[64:67], v172 offset:32768
    v_mfma_f32_16x16x32_bf16 v[4:7], v[128:131], a[36:39], v[4:7]
    ds_read_b128 a[68:71], v172 offset:33792
    s_add_u32 m0, s59, 16384
    v_mfma_f32_16x16x32_bf16 v[8:11], v[128:131], a[40:43], v[8:11]
    ds_read_b128 a[72:75], v172 offset:34816
    buffer_load_dwordx4 v164, s[28:31], s56 offen offset:0 lds
    v_readlane_b32 s57, v177, 9
    v_mfma_f32_16x16x32_bf16 v[12:15], v[128:131], a[44:47], v[12:15]
    ds_read_b128 a[76:79], v172 offset:35840
    v_mfma_f32_16x16x32_bf16 v[28:31], v[132:135], a[44:47], v[28:31]
    ds_read_b64_tr_b16 v[144:145], v161 offset:24576
    v_mfma_f32_16x16x32_bf16 v[24:27], v[132:135], a[40:43], v[24:27]
    ds_read_b64_tr_b16 v[146:147], v161 offset:25088
    v_mfma_f32_16x16x32_bf16 v[20:23], v[132:135], a[36:39], v[20:23]
    ds_read_b64_tr_b16 v[148:149], v162 offset:24576
    buffer_load_dwordx4 v165, s[28:31], s56 offen offset:1024 lds
    v_mfma_f32_16x16x32_bf16 v[16:19], v[132:135], a[32:35], v[16:19]
    ds_read_b64_tr_b16 v[150:151], v162 offset:25088
    v_mfma_f32_16x16x32_bf16 v[32:35], v[136:139], a[32:35], v[32:35]
    ds_read_b64_tr_b16 v[152:153], v161 offset:28672
    s_add_u32 m0, s78, 49152
    s_add_u32 s9, s74, 0
    v_mfma_f32_16x16x32_bf16 v[36:39], v[136:139], a[36:39], v[36:39]
    ds_read_b64_tr_b16 v[154:155], v161 offset:29184
    buffer_load_dwordx4 v168, s[36:39], s9 offen lds
    v_mfma_f32_16x16x32_bf16 v[40:43], v[136:139], a[40:43], v[40:43]
    ds_read_b64_tr_b16 v[156:157], v162 offset:28672
    v_mfma_f32_16x16x32_bf16 v[44:47], v[136:139], a[44:47], v[44:47]
    ds_read_b64_tr_b16 v[158:159], v162 offset:29184
    v_mfma_f32_16x16x32_bf16 v[60:63], v[140:143], a[44:47], v[60:63]
    s_add_u32 m0, s79, 49152
    s_add_u32 s9, s75, 0
    v_mfma_f32_16x16x32_bf16 v[56:59], v[140:143], a[40:43], v[56:59]
    buffer_load_dwordx4 v168, s[36:39], s9 offen lds
    v_mfma_f32_16x16x32_bf16 v[52:55], v[140:143], a[36:39], v[52:55]
    s_waitcnt vmcnt(10) lgkmcnt(0)
    v_mfma_f32_16x16x32_bf16 v[48:51], v[140:143], a[32:35], v[48:51]
    s_barrier
    v_mfma_f32_16x16x32_bf16 v[0:3], v[144:147], a[48:51], v[0:3]
    ds_read_b128 a[80:83], v173 offset:40960
    v_mfma_f32_16x16x32_bf16 v[4:7], v[144:147], a[52:55], v[4:7]
    ds_read_b128 a[84:87], v173 offset:41984
    s_add_u32 m0, s59, 24576
    v_mfma_f32_16x16x32_bf16 v[8:11], v[144:147], a[56:59], v[8:11]
    ds_read_b128 a[88:91], v173 offset:43008
    buffer_load_dwordx4 v164, s[28:31], s57 offen offset:0 lds
    v_readlane_b32 s56, v177, 10
    v_mfma_f32_16x16x32_bf16 v[12:15], v[144:147], a[60:63], v[12:15]
    ds_read_b128 a[92:95], v173 offset:44032
    v_mfma_f32_16x16x32_bf16 v[28:31], v[148:151], a[60:63], v[28:31]
    ds_read_b64_tr_b16 v[128:129], v161 offset:32768
    v_mfma_f32_16x16x32_bf16 v[24:27], v[148:151], a[56:59], v[24:27]
    ds_read_b64_tr_b16 v[130:131], v161 offset:33280
    v_mfma_f32_16x16x32_bf16 v[20:23], v[148:151], a[52:55], v[20:23]
    ds_read_b64_tr_b16 v[132:133], v162 offset:32768
    buffer_load_dwordx4 v165, s[28:31], s57 offen offset:1024 lds
    v_mfma_f32_16x16x32_bf16 v[16:19], v[148:151], a[48:51], v[16:19]
    ds_read_b64_tr_b16 v[134:135], v162 offset:33280
    v_mfma_f32_16x16x32_bf16 v[32:35], v[152:155], a[48:51], v[32:35]
    ds_read_b64_tr_b16 v[136:137], v161 offset:36864
    s_add_u32 m0, s80, 49152
    s_add_u32 s9, s76, 0
    v_mfma_f32_16x16x32_bf16 v[36:39], v[152:155], a[52:55], v[36:39]
    ds_read_b64_tr_b16 v[138:139], v161 offset:37376
    buffer_load_dwordx4 v168, s[36:39], s9 offen lds
    v_mfma_f32_16x16x32_bf16 v[40:43], v[152:155], a[56:59], v[40:43]
    ds_read_b64_tr_b16 v[140:141], v162 offset:36864
    v_mfma_f32_16x16x32_bf16 v[44:47], v[152:155], a[60:63], v[44:47]
    ds_read_b64_tr_b16 v[142:143], v162 offset:37376
    v_mfma_f32_16x16x32_bf16 v[60:63], v[156:159], a[60:63], v[60:63]
    s_add_u32 m0, s81, 49152
    s_add_u32 s9, s77, 0
    v_mfma_f32_16x16x32_bf16 v[56:59], v[156:159], a[56:59], v[56:59]
    buffer_load_dwordx4 v168, s[36:39], s9 offen lds
    v_mfma_f32_16x16x32_bf16 v[52:55], v[156:159], a[52:55], v[52:55]
    s_waitcnt vmcnt(12) lgkmcnt(0)
    v_mfma_f32_16x16x32_bf16 v[48:51], v[156:159], a[48:51], v[48:51]
    s_barrier
    v_mfma_f32_16x16x32_bf16 v[0:3], v[128:131], a[64:67], v[0:3]
    ds_read_b128 a[96:99], v172 offset:49152
    v_mfma_f32_16x16x32_bf16 v[4:7], v[128:131], a[68:71], v[4:7]
    ds_read_b128 a[100:103], v172 offset:50176
    s_add_u32 m0, s59, 32768
    v_mfma_f32_16x16x32_bf16 v[8:11], v[128:131], a[72:75], v[8:11]
    ds_read_b128 a[104:107], v172 offset:51200
    buffer_load_dwordx4 v164, s[28:31], s56 offen offset:0 lds
    v_readlane_b32 s57, v177, 11
    v_mfma_f32_16x16x32_bf16 v[12:15], v[128:131], a[76:79], v[12:15]
    ds_read_b128 a[108:111], v172 offset:52224
    v_mfma_f32_16x16x32_bf16 v[28:31], v[132:135], a[76:79], v[28:31]
    ds_read_b64_tr_b16 v[144:145], v161 offset:40960
    v_mfma_f32_16x16x32_bf16 v[24:27], v[132:135], a[72:75], v[24:27]
    ds_read_b64_tr_b16 v[146:147], v161 offset:41472
    v_mfma_f32_16x16x32_bf16 v[20:23], v[132:135], a[68:71], v[20:23]
    ds_read_b64_tr_b16 v[148:149], v162 offset:40960
    buffer_load_dwordx4 v165, s[28:31], s56 offen offset:1024 lds
    v_mfma_f32_16x16x32_bf16 v[16:19], v[132:135], a[64:67], v[16:19]
    ds_read_b64_tr_b16 v[150:151], v162 offset:41472
    v_mfma_f32_16x16x32_bf16 v[32:35], v[136:139], a[64:67], v[32:35]
    ds_read_b64_tr_b16 v[152:153], v161 offset:45056
    s_add_u32 m0, s78, 65536
    s_add_u32 s9, s74, 32768
    v_mfma_f32_16x16x32_bf16 v[36:39], v[136:139], a[68:71], v[36:39]
    ds_read_b64_tr_b16 v[154:155], v161 offset:45568
    buffer_load_dwordx4 v168, s[36:39], s9 offen lds
    v_mfma_f32_16x16x32_bf16 v[40:43], v[136:139], a[72:75], v[40:43]
    ds_read_b64_tr_b16 v[156:157], v162 offset:45056
    v_mfma_f32_16x16x32_bf16 v[44:47], v[136:139], a[76:79], v[44:47]
    ds_read_b64_tr_b16 v[158:159], v162 offset:45568
    v_mfma_f32_16x16x32_bf16 v[60:63], v[140:143], a[76:79], v[60:63]
    s_add_u32 m0, s79, 65536
    s_add_u32 s9, s75, 32768
    v_mfma_f32_16x16x32_bf16 v[56:59], v[140:143], a[72:75], v[56:59]
    buffer_load_dwordx4 v168, s[36:39], s9 offen lds
    v_mfma_f32_16x16x32_bf16 v[52:55], v[140:143], a[68:71], v[52:55]
    s_waitcnt vmcnt(14) lgkmcnt(0)
    v_mfma_f32_16x16x32_bf16 v[48:51], v[140:143], a[64:67], v[48:51]
    s_barrier
    v_mfma_f32_16x16x32_bf16 v[0:3], v[144:147], a[80:83], v[0:3]
    ds_read_b128 a[112:115], v173 offset:57344
L_stub7:
    s_cbranch_execz L_stub11
    s_nop 0
    v_mfma_f32_16x16x32_bf16 v[4:7], v[144:147], a[84:87], v[4:7]
    ds_read_b128 a[116:119], v173 offset:58368
    s_add_u32 m0, s59, 40960
    v_mfma_f32_16x16x32_bf16 v[8:11], v[144:147], a[88:91], v[8:11]
    ds_read_b128 a[120:123], v173 offset:59392
    buffer_load_dwordx4 v164, s[28:31], s57 offen offset:0 lds
    v_readlane_b32 s56, v177, 12
    v_mfma_f32_16x16x32_bf16 v[12:15], v[144:147], a[92:95], v[12:15]
    ds_read_b128 a[124:127], v173 offset:60416
    v_mfma_f32_16x16x32_bf16 v[28:31], v[148:151], a[92:95], v[28:31]
    ds_read_b64_tr_b16 v[128:129], v161 offset:0
    v_mfma_f32_16x16x32_bf16 v[24:27], v[148:151], a[88:91], v[24:27]
    ds_read_b64_tr_b16 v[130:131], v161 offset:512
    v_mfma_f32_16x16x32_bf16 v[20:23], v[148:151], a[84:87], v[20:23]
    ds_read_b64_tr_b16 v[132:133], v162 offset:0
    buffer_load_dwordx4 v165, s[28:31], s57 offen offset:1024 lds
    v_mfma_f32_16x16x32_bf16 v[16:19], v[148:151], a[80:83], v[16:19]
    ds_read_b64_tr_b16 v[134:135], v162 offset:512
    v_mfma_f32_16x16x32_bf16 v[32:35], v[152:155], a[80:83], v[32:35]
    ds_read_b64_tr_b16 v[136:137], v161 offset:4096
    s_add_u32 m0, s80, 65536
    s_add_u32 s9, s76, 32768
    v_mfma_f32_16x16x32_bf16 v[36:39], v[152:155], a[84:87], v[36:39]
    ds_read_b64_tr_b16 v[138:139], v161 offset:4608
    buffer_load_dwordx4 v168, s[36:39], s9 offen lds
    v_mfma_f32_16x16x32_bf16 v[40:43], v[152:155], a[88:91], v[40:43]
    ds_read_b64_tr_b16 v[140:141], v162 offset:4096
    v_mfma_f32_16x16x32_bf16 v[44:47], v[152:155], a[92:95], v[44:47]
    ds_read_b64_tr_b16 v[142:143], v162 offset:4608
    v_mfma_f32_16x16x32_bf16 v[60:63], v[156:159], a[92:95], v[60:63]
    s_add_u32 m0, s81, 65536
    s_add_u32 s9, s77, 32768
    v_mfma_f32_16x16x32_bf16 v[56:59], v[156:159], a[88:91], v[56:59]
    buffer_load_dwordx4 v168, s[36:39], s9 offen lds
    v_mfma_f32_16x16x32_bf16 v[52:55], v[156:159], a[84:87], v[52:55]
    s_waitcnt vmcnt(16) lgkmcnt(0)
    v_mfma_f32_16x16x32_bf16 v[48:51], v[156:159], a[80:83], v[48:51]
    s_barrier
    v_mfma_f32_16x16x32_bf16 v[0:3], v[128:131], a[96:99], v[0:3]
    v_add_u32 v172, 0x10000, v172
    ds_read_b128 a[128:131], v172 offset:0
    v_mfma_f32_16x16x32_bf16 v[4:7], v[128:131], a[100:103], v[4:7]
    ds_read_b128 a[132:135], v172 offset:1024
    s_add_u32 m0, s59, 0
    v_mfma_f32_16x16x32_bf16 v[8:11], v[128:131], a[104:107], v[8:11]
    ds_read_b128 a[136:139], v172 offset:2048
    buffer_load_dwordx4 v164, s[28:31], s56 offen offset:0 lds
    v_readlane_b32 s57, v177, 13
    v_mfma_f32_16x16x32_bf16 v[12:15], v[128:131], a[108:111], v[12:15]
    ds_read_b128 a[140:143], v172 offset:3072
    v_mfma_f32_16x16x32_bf16 v[28:31], v[132:135], a[108:111], v[28:31]
    ds_read_b64_tr_b16 v[144:145], v161 offset:8192
    v_mfma_f32_16x16x32_bf16 v[24:27], v[132:135], a[104:107], v[24:27]
    ds_read_b64_tr_b16 v[146:147], v161 offset:8704
    v_mfma_f32_16x16x32_bf16 v[20:23], v[132:135], a[100:103], v[20:23]
    ds_read_b64_tr_b16 v[148:149], v162 offset:8192
    buffer_load_dwordx4 v165, s[28:31], s56 offen offset:1024 lds
    v_mfma_f32_16x16x32_bf16 v[16:19], v[132:135], a[96:99], v[16:19]
    ds_read_b64_tr_b16 v[150:151], v162 offset:8704
    v_mfma_f32_16x16x32_bf16 v[32:35], v[136:139], a[96:99], v[32:35]
    ds_read_b64_tr_b16 v[152:153], v161 offset:12288
    s_add_u32 m0, s78, 81920
    s_add_u32 s9, s74, 65536
    v_mfma_f32_16x16x32_bf16 v[36:39], v[136:139], a[100:103], v[36:39]
    ds_read_b64_tr_b16 v[154:155], v161 offset:12800
    buffer_load_dwordx4 v168, s[36:39], s9 offen lds
    v_mfma_f32_16x16x32_bf16 v[40:43], v[136:139], a[104:107], v[40:43]
    ds_read_b64_tr_b16 v[156:157], v162 offset:12288
    v_mfma_f32_16x16x32_bf16 v[44:47], v[136:139], a[108:111], v[44:47]
    ds_read_b64_tr_b16 v[158:159], v162 offset:12800
    v_mfma_f32_16x16x32_bf16 v[60:63], v[140:143], a[108:111], v[60:63]
    s_add_u32 m0, s79, 81920
    s_add_u32 s9, s75, 65536
    v_mfma_f32_16x16x32_bf16 v[56:59], v[140:143], a[104:107], v[56:59]
    buffer_load_dwordx4 v168, s[36:39], s9 offen lds
    v_mfma_f32_16x16x32_bf16 v[52:55], v[140:143], a[100:103], v[52:55]
    s_waitcnt vmcnt(18) lgkmcnt(0)
    v_mfma_f32_16x16x32_bf16 v[48:51], v[140:143], a[96:99], v[48:51]
    s_barrier
    v_mfma_f32_16x16x32_bf16 v[0:3], v[144:147], a[112:115], v[0:3]
    v_add_u32 v173, 0x10000, v173
    ds_read_b128 a[144:147], v173 offset:8192
    v_mfma_f32_16x16x32_bf16 v[4:7], v[144:147], a[116:119], v[4:7]
    ds_read_b128 a[148:151], v173 offset:9216
    s_add_u32 m0, s59, 8192
    v_mfma_f32_16x16x32_bf16 v[8:11], v[144:147], a[120:123], v[8:11]
    ds_read_b128 a[152:155], v173 offset:10240
    buffer_load_dwordx4 v164, s[28:31], s57 offen offset:0 lds
    v_readlane_b32 s56, v177, 14
    v_mfma_f32_16x16x32_bf16 v[12:15], v[144:147], a[124:127], v[12:15]
    ds_read_b128 a[156:159], v173 offset:11264
    v_mfma_f32_16x16x32_bf16 v[28:31], v[148:151], a[124:127], v[28:31]
    ds_read_b64_tr_b16 v[128:129], v161 offset:16384
    v_mfma_f32_16x16x32_bf16 v[24:27], v[148:151], a[120:123], v[24:27]
    ds_read_b64_tr_b16 v[130:131], v161 offset:16896
    v_mfma_f32_16x16x32_bf16 v[20:23], v[148:151], a[116:119], v[20:23]
    ds_read_b64_tr_b16 v[132:133], v162 offset:16384
    buffer_load_dwordx4 v165, s[28:31], s57 offen offset:1024 lds
    v_mfma_f32_16x16x32_bf16 v[16:19], v[148:151], a[112:115], v[16:19]
    ds_read_b64_tr_b16 v[134:135], v162 offset:16896
    v_mfma_f32_16x16x32_bf16 v[32:35], v[152:155], a[112:115], v[32:35]
    ds_read_b64_tr_b16 v[136:137], v161 offset:20480
    s_add_u32 m0, s80, 81920
    s_add_u32 s9, s76, 65536
    v_mfma_f32_16x16x32_bf16 v[36:39], v[152:155], a[116:119], v[36:39]
    ds_read_b64_tr_b16 v[138:139], v161 offset:20992
    buffer_load_dwordx4 v168, s[36:39], s9 offen lds
    v_mfma_f32_16x16x32_bf16 v[40:43], v[152:155], a[120:123], v[40:43]
    ds_read_b64_tr_b16 v[140:141], v162 offset:20480
    v_mfma_f32_16x16x32_bf16 v[44:47], v[152:155], a[124:127], v[44:47]
    ds_read_b64_tr_b16 v[142:143], v162 offset:20992
    v_mfma_f32_16x16x32_bf16 v[60:63], v[156:159], a[124:127], v[60:63]
    s_add_u32 m0, s81, 81920
    s_add_u32 s9, s77, 65536
    v_mfma_f32_16x16x32_bf16 v[56:59], v[156:159], a[120:123], v[56:59]
    buffer_load_dwordx4 v168, s[36:39], s9 offen lds
    v_mfma_f32_16x16x32_bf16 v[52:55], v[156:159], a[116:119], v[52:55]
    s_waitcnt vmcnt(18) lgkmcnt(0)
    v_mfma_f32_16x16x32_bf16 v[48:51], v[156:159], a[112:115], v[48:51]
    s_barrier
    v_mfma_f32_16x16x32_bf16 v[0:3], v[128:131], a[128:131], v[0:3]
    ds_read_b128 a[160:163], v172 offset:16384
    v_mfma_f32_16x16x32_bf16 v[4:7], v[128:131], a[132:135], v[4:7]
    ds_read_b128 a[164:167], v172 offset:17408
    s_add_u32 m0, s59, 16384
    v_mfma_f32_16x16x32_bf16 v[8:11], v[128:131], a[136:139], v[8:11]
    ds_read_b128 a[168:171], v172 offset:18432
    buffer_load_dwordx4 v164, s[28:31], s56 offen offset:0 lds
    v_readlane_b32 s57, v177, 15
    v_mfma_f32_16x16x32_bf16 v[12:15], v[128:131], a[140:143], v[12:15]
    ds_read_b128 a[172:175], v172 offset:19456
    v_mfma_f32_16x16x32_bf16 v[28:31], v[132:135], a[140:143], v[28:31]
    ds_read_b64_tr_b16 v[144:145], v161 offset:24576
    v_mfma_f32_16x16x32_bf16 v[24:27], v[132:135], a[136:139], v[24:27]
    ds_read_b64_tr_b16 v[146:147], v161 offset:25088
    buffer_load_dwordx4 v165, s[28:31], s56 offen offset:1024 lds
    v_mfma_f32_16x16x32_bf16 v[20:23], v[132:135], a[132:135], v[20:23]
    ds_read_b64_tr_b16 v[148:149], v162 offset:24576
    v_mfma_f32_16x16x32_bf16 v[16:19], v[132:135], a[128:131], v[16:19]
    ds_read_b64_tr_b16 v[150:151], v162 offset:25088
    v_mfma_f32_16x16x32_bf16 v[32:35], v[136:139], a[128:131], v[32:35]
    ds_read_b64_tr_b16 v[152:153], v161 offset:28672
    buffer_load_dword v170, v170, s[48:51], 0 offen offset:64 sc1
    v_mfma_f32_16x16x32_bf16 v[36:39], v[136:139], a[132:135], v[36:39]
    ds_read_b64_tr_b16 v[154:155], v161 offset:29184
    s_add_u32 m0, s78, 98304
    s_add_u32 s9, s74, 98304
    v_mfma_f32_16x16x32_bf16 v[40:43], v[136:139], a[136:139], v[40:43]
    ds_read_b64_tr_b16 v[156:157], v162 offset:28672
    buffer_load_dwordx4 v168, s[36:39], s9 offen lds
    v_mfma_f32_16x16x32_bf16 v[44:47], v[136:139], a[140:143], v[44:47]
    ds_read_b64_tr_b16 v[158:159], v162 offset:29184
    v_mfma_f32_16x16x32_bf16 v[60:63], v[140:143], a[140:143], v[60:63]
    s_add_u32 m0, s79, 98304
    s_add_u32 s9, s75, 98304
    v_mfma_f32_16x16x32_bf16 v[56:59], v[140:143], a[136:139], v[56:59]
    buffer_load_dwordx4 v168, s[36:39], s9 offen lds
    v_mfma_f32_16x16x32_bf16 v[52:55], v[140:143], a[132:135], v[52:55]
    s_waitcnt vmcnt(19) lgkmcnt(0)
    v_mfma_f32_16x16x32_bf16 v[48:51], v[140:143], a[128:131], v[48:51]
    s_barrier
    v_mfma_f32_16x16x32_bf16 v[0:3], v[144:147], a[144:147], v[0:3]
    ds_read_b128 a[176:179], v173 offset:24576
    v_mfma_f32_16x16x32_bf16 v[4:7], v[144:147], a[148:151], v[4:7]
    ds_read_b128 a[180:183], v173 offset:25600
    s_add_u32 m0, s59, 24576
    v_mfma_f32_16x16x32_bf16 v[8:11], v[144:147], a[152:155], v[8:11]
    ds_read_b128 a[184:187], v173 offset:26624
    buffer_load_dwordx4 v164, s[28:31], s57 offen offset:0 lds
    v_readlane_b32 s56, v177, 16
    v_mfma_f32_16x16x32_bf16 v[12:15], v[144:147], a[156:159], v[12:15]
    ds_read_b128 a[188:191], v173 offset:27648
    v_mfma_f32_16x16x32_bf16 v[28:31], v[148:151], a[156:159], v[28:31]
    ds_read_b64_tr_b16 v[128:129], v161 offset:32768
    v_mfma_f32_16x16x32_bf16 v[24:27], v[148:151], a[152:155], v[24:27]
    ds_read_b64_tr_b16 v[130:131], v161 offset:33280
    v_mfma_f32_16x16x32_bf16 v[20:23], v[148:151], a[148:151], v[20:23]
    ds_read_b64_tr_b16 v[132:133], v162 offset:32768
    buffer_load_dwordx4 v165, s[28:31], s57 offen offset:1024 lds
    v_mfma_f32_16x16x32_bf16 v[16:19], v[148:151], a[144:147], v[16:19]
    ds_read_b64_tr_b16 v[134:135], v162 offset:33280
    v_mfma_f32_16x16x32_bf16 v[32:35], v[152:155], a[144:147], v[32:35]
    ds_read_b64_tr_b16 v[136:137], v161 offset:36864
    s_add_u32 m0, s80, 98304
    s_add_u32 s9, s76, 98304
    v_mfma_f32_16x16x32_bf16 v[36:39], v[152:155], a[148:151], v[36:39]
    ds_read_b64_tr_b16 v[138:139], v161 offset:37376
    buffer_load_dwordx4 v168, s[36:39], s9 offen lds
    v_mfma_f32_16x16x32_bf16 v[40:43], v[152:155], a[152:155], v[40:43]
    ds_read_b64_tr_b16 v[140:141], v162 offset:36864
    v_mfma_f32_16x16x32_bf16 v[44:47], v[152:155], a[156:159], v[44:47]
    ds_read_b64_tr_b16 v[142:143], v162 offset:37376
    v_mfma_f32_16x16x32_bf16 v[60:63], v[156:159], a[156:159], v[60:63]
    s_add_u32 m0, s81, 98304
    s_add_u32 s9, s77, 98304
    v_mfma_f32_16x16x32_bf16 v[56:59], v[156:159], a[152:155], v[56:59]
    buffer_load_dwordx4 v168, s[36:39], s9 offen lds
    v_mfma_f32_16x16x32_bf16 v[52:55], v[156:159], a[148:151], v[52:55]
    s_waitcnt vmcnt(19) lgkmcnt(0)
    v_mfma_f32_16x16x32_bf16 v[48:51], v[156:159], a[144:147], v[48:51]
    s_barrier
    v_mfma_f32_16x16x32_bf16 v[0:3], v[128:131], a[160:163], v[0:3]
    ds_read_b128 a[192:195], v172 offset:32768
    v_mfma_f32_16x16x32_bf16 v[4:7], v[128:131], a[164:167], v[4:7]
    ds_read_b128 a[196:199], v172 offset:33792
    v_mfma_f32_16x16x32_bf16 v[8:11], v[128:131], a[168:171], v[8:11]
    ds_read_b128 a[200:203], v172 offset:34816
    v_mfma_f32_16x16x32_bf16 v[12:15], v[128:131], a[172:175], v[12:15]
    ds_read_b128 a[204:207], v172 offset:35840
    v_mfma_f32_16x16x32_bf16 v[28:31], v[132:135], a[172:175], v[28:31]
    ds_read_b64_tr_b16 v[144:145], v161 offset:40960
    v_mfma_f32_16x16x32_bf16 v[24:27], v[132:135], a[168:171], v[24:27]
    ds_read_b64_tr_b16 v[146:147], v161 offset:41472
    v_mfma_f32_16x16x32_bf16 v[20:23], v[132:135], a[164:167], v[20:23]
    ds_read_b64_tr_b16 v[148:149], v162 offset:40960
    v_mfma_f32_16x16x32_bf16 v[16:19], v[132:135], a[160:163], v[16:19]
    ds_read_b64_tr_b16 v[150:151], v162 offset:41472
    v_mfma_f32_16x16x32_bf16 v[32:35], v[136:139], a[160:163], v[32:35]
    ds_read_b64_tr_b16 v[152:153], v161 offset:45056
    v_mfma_f32_16x16x32_bf16 v[36:39], v[136:139], a[164:167], v[36:39]
    ds_read_b64_tr_b16 v[154:155], v161 offset:45568
    v_mfma_f32_16x16x32_bf16 v[40:43], v[136:139], a[168:171], v[40:43]
    ds_read_b64_tr_b16 v[156:157], v162 offset:45056
    v_mfma_f32_16x16x32_bf16 v[44:47], v[136:139], a[172:175], v[44:47]
    ds_read_b64_tr_b16 v[158:159], v162 offset:45568
    s_add_u32 m0, s59, 32768
    v_mfma_f32_16x16x32_bf16 v[60:63], v[140:143], a[172:175], v[60:63]
    buffer_load_dwordx4 v164, s[28:31], s56 offen offset:0 lds
    v_readlane_b32 s57, v177, 17
    v_mfma_f32_16x16x32_bf16 v[56:59], v[140:143], a[168:171], v[56:59]
    v_mfma_f32_16x16x32_bf16 v[52:55], v[140:143], a[164:167], v[52:55]
    buffer_load_dwordx4 v165, s[28:31], s56 offen offset:1024 lds
    s_waitcnt vmcnt(17) lgkmcnt(0)
    v_mfma_f32_16x16x32_bf16 v[48:51], v[140:143], a[160:163], v[48:51]
    s_barrier
    v_mfma_f32_16x16x32_bf16 v[0:3], v[144:147], a[176:179], v[0:3]
    ds_read_b128 a[208:211], v173 offset:40960
    v_mfma_f32_16x16x32_bf16 v[4:7], v[144:147], a[180:183], v[4:7]
    ds_read_b128 a[212:215], v173 offset:41984
    v_mfma_f32_16x16x32_bf16 v[8:11], v[144:147], a[184:187], v[8:11]
    ds_read_b128 a[216:219], v173 offset:43008
    v_mfma_f32_16x16x32_bf16 v[12:15], v[144:147], a[188:191], v[12:15]
    ds_read_b128 a[220:223], v173 offset:44032
    v_mfma_f32_16x16x32_bf16 v[28:31], v[148:151], a[188:191], v[28:31]
    ds_read_b64_tr_b16 v[128:129], v161 offset:0
    v_mfma_f32_16x16x32_bf16 v[24:27], v[148:151], a[184:187], v[24:27]
    ds_read_b64_tr_b16 v[130:131], v161 offset:512
    v_mfma_f32_16x16x32_bf16 v[20:23], v[148:151], a[180:183], v[20:23]
    ds_read_b64_tr_b16 v[132:133], v162 offset:0
    v_mfma_f32_16x16x32_bf16 v[16:19], v[148:151], a[176:179], v[16:19]
    ds_read_b64_tr_b16 v[134:135], v162 offset:512
    v_mfma_f32_16x16x32_bf16 v[32:35], v[152:155], a[176:179], v[32:35]
    ds_read_b64_tr_b16 v[136:137], v161 offset:4096
    v_mfma_f32_16x16x32_bf16 v[36:39], v[152:155], a[180:183], v[36:39]
    ds_read_b64_tr_b16 v[138:139], v161 offset:4608
    v_mfma_f32_16x16x32_bf16 v[40:43], v[152:155], a[184:187], v[40:43]
    ds_read_b64_tr_b16 v[140:141], v162 offset:4096
    v_mfma_f32_16x16x32_bf16 v[44:47], v[152:155], a[188:191], v[44:47]
    ds_read_b64_tr_b16 v[142:143], v162 offset:4608
    s_add_u32 m0, s59, 40960
    v_mfma_f32_16x16x32_bf16 v[60:63], v[156:159], a[188:191], v[60:63]
    buffer_load_dwordx4 v164, s[28:31], s57 offen offset:0 lds
    v_readlane_b32 s56, v177, 18
    v_mfma_f32_16x16x32_bf16 v[56:59], v[156:159], a[184:187], v[56:59]
    v_mfma_f32_16x16x32_bf16 v[52:55], v[156:159], a[180:183], v[52:55]
    buffer_load_dwordx4 v165, s[28:31], s57 offen offset:1024 lds
    s_waitcnt vmcnt(15) lgkmcnt(0)
    v_mfma_f32_16x16x32_bf16 v[48:51], v[156:159], a[176:179], v[48:51]
    s_barrier
    v_mfma_f32_16x16x32_bf16 v[0:3], v[128:131], a[192:195], v[0:3]
    ds_read_b128 a[224:227], v172 offset:49152
    v_mfma_f32_16x16x32_bf16 v[4:7], v[128:131], a[196:199], v[4:7]
    ds_read_b128 a[228:231], v172 offset:50176
    v_mfma_f32_16x16x32_bf16 v[8:11], v[128:131], a[200:203], v[8:11]
    ds_read_b128 a[232:235], v172 offset:51200
    v_mfma_f32_16x16x32_bf16 v[12:15], v[128:131], a[204:207], v[12:15]
    ds_read_b128 a[236:239], v172 offset:52224
    v_mfma_f32_16x16x32_bf16 v[28:31], v[132:135], a[204:207], v[28:31]
    ds_read_b64_tr_b16 v[144:145], v161 offset:8192
    v_mfma_f32_16x16x32_bf16 v[24:27], v[132:135], a[200:203], v[24:27]
    ds_read_b64_tr_b16 v[146:147], v161 offset:8704
    v_mfma_f32_16x16x32_bf16 v[20:23], v[132:135], a[196:199], v[20:23]
    ds_read_b64_tr_b16 v[148:149], v162 offset:8192
    v_mfma_f32_16x16x32_bf16 v[16:19], v[132:135], a[192:195], v[16:19]
    ds_read_b64_tr_b16 v[150:151], v162 offset:8704
    v_mfma_f32_16x16x32_bf16 v[32:35], v[136:139], a[192:195], v[32:35]
    ds_read_b64_tr_b16 v[152:153], v161 offset:12288
    v_mfma_f32_16x16x32_bf16 v[36:39], v[136:139], a[196:199], v[36:39]
    ds_read_b64_tr_b16 v[154:155], v161 offset:12800
    v_mfma_f32_16x16x32_bf16 v[40:43], v[136:139], a[200:203], v[40:43]
    ds_read_b64_tr_b16 v[156:157], v162 offset:12288
    v_mfma_f32_16x16x32_bf16 v[44:47], v[136:139], a[204:207], v[44:47]
    ds_read_b64_tr_b16 v[158:159], v162 offset:12800
    s_add_u32 m0, s59, 0
    v_mfma_f32_16x16x32_bf16 v[60:63], v[140:143], a[204:207], v[60:63]
    buffer_load_dwordx4 v164, s[28:31], s56 offen offset:0 lds
    v_readlane_b32 s57, v177, 19
    v_mfma_f32_16x16x32_bf16 v[56:59], v[140:143], a[200:203], v[56:59]
    v_mfma_f32_16x16x32_bf16 v[52:55], v[140:143], a[196:199], v[52:55]
    buffer_load_dwordx4 v165, s[28:31], s56 offen offset:1024 lds
    s_waitcnt vmcnt(13) lgkmcnt(0)
    v_mfma_f32_16x16x32_bf16 v[48:51], v[140:143], a[192:195], v[48:51]
    s_barrier
    v_mfma_f32_16x16x32_bf16 v[0:3], v[144:147], a[208:211], v[0:3]
    ds_read_b128 a[240:243], v173 offset:57344
    v_mfma_f32_16x16x32_bf16 v[4:7], v[144:147], a[212:215], v[4:7]
    ds_read_b128 a[244:247], v173 offset:58368
    v_mfma_f32_16x16x32_bf16 v[8:11], v[144:147], a[216:219], v[8:11]
    ds_read_b128 a[248:251], v173 offset:59392
    v_mfma_f32_16x16x32_bf16 v[12:15], v[144:147], a[220:223], v[12:15]
    ds_read_b128 a[252:255], v173 offset:60416
    v_mfma_f32_16x16x32_bf16 v[28:31], v[148:151], a[220:223], v[28:31]
    ds_read_b64_tr_b16 v[128:129], v161 offset:16384
    v_mfma_f32_16x16x32_bf16 v[24:27], v[148:151], a[216:219], v[24:27]
    ds_read_b64_tr_b16 v[130:131], v161 offset:16896
    v_mfma_f32_16x16x32_bf16 v[20:23], v[148:151], a[212:215], v[20:23]
    ds_read_b64_tr_b16 v[132:133], v162 offset:16384
    v_mfma_f32_16x16x32_bf16 v[16:19], v[148:151], a[208:211], v[16:19]
    ds_read_b64_tr_b16 v[134:135], v162 offset:16896
    v_mfma_f32_16x16x32_bf16 v[32:35], v[152:155], a[208:211], v[32:35]
    ds_read_b64_tr_b16 v[136:137], v161 offset:20480
    v_mfma_f32_16x16x32_bf16 v[36:39], v[152:155], a[212:215], v[36:39]
    ds_read_b64_tr_b16 v[138:139], v161 offset:20992
    v_mfma_f32_16x16x32_bf16 v[40:43], v[152:155], a[216:219], v[40:43]
    ds_read_b64_tr_b16 v[140:141], v162 offset:20480
    v_mfma_f32_16x16x32_bf16 v[44:47], v[152:155], a[220:223], v[44:47]
    ds_read_b64_tr_b16 v[142:143], v162 offset:20992
    s_add_u32 m0, s59, 8192
    v_mfma_f32_16x16x32_bf16 v[60:63], v[156:159], a[220:223], v[60:63]
    buffer_load_dwordx4 v164, s[28:31], s57 offen offset:0 lds
    v_readlane_b32 s56, v177, 20
    v_mfma_f32_16x16x32_bf16 v[56:59], v[156:159], a[216:219], v[56:59]
    v_mfma_f32_16x16x32_bf16 v[52:55], v[156:159], a[212:215], v[52:55]
    buffer_load_dwordx4 v165, s[28:31], s57 offen offset:1024 lds
    s_waitcnt vmcnt(10) lgkmcnt(0)
    v_mfma_f32_16x16x32_bf16 v[48:51], v[156:159], a[208:211], v[48:51]
    s_barrier
    v_mfma_f32_16x16x32_bf16 v[0:3], v[128:131], a[224:227], v[0:3]
    ds_write_b64 v200, v[184:185]
    ds_write_b64 v201, v[186:187]
    v_mfma_f32_16x16x32_bf16 v[4:7], v[128:131], a[228:231], v[4:7]
    ds_write_b64 v202, v[188:189]
    s_add_u32 m0, s59, 16384
    v_mfma_f32_16x16x32_bf16 v[8:11], v[128:131], a[232:235], v[8:11]
    ds_write_b64 v203, v[190:191]
    buffer_load_dwordx4 v164, s[28:31], s56 offen offset:0 lds
    v_readlane_b32 s57, v177, 21
    v_mfma_f32_16x16x32_bf16 v[12:15], v[128:131], a[236:239], v[12:15]
    ds_read_b64_tr_b16 v[144:145], v161 offset:24576
    ds_read_b64_tr_b16 v[146:147], v161 offset:25088
    v_mfma_f32_16x16x32_bf16 v[28:31], v[132:135], a[236:239], v[28:31]
    ds_read_b64_tr_b16 v[148:149], v162 offset:24576
    v_mfma_f32_16x16x32_bf16 v[24:27], v[132:135], a[232:235], v[24:27]
    ds_read_b64_tr_b16 v[150:151], v162 offset:25088
    buffer_load_dwordx4 v165, s[28:31], s56 offen offset:1024 lds
    v_mfma_f32_16x16x32_bf16 v[20:23], v[132:135], a[228:231], v[20:23]
    ds_read_b64_tr_b16 v[152:153], v161 offset:28672
    ds_read_b64_tr_b16 v[154:155], v161 offset:29184
    v_mfma_f32_16x16x32_bf16 v[16:19], v[132:135], a[224:227], v[16:19]
    ds_read_b64_tr_b16 v[156:157], v162 offset:28672
    v_mfma_f32_16x16x32_bf16 v[32:35], v[136:139], a[224:227], v[32:35]
    ds_read_b64_tr_b16 v[158:159], v162 offset:29184
    v_cmp_eq_u32 vcc, 64, v170
    s_nop 1
    s_and_b32 s8, vcc_lo, 65535
    s_cmp_eq_u32 s8, 65535
    s_cbranch_scc0 L_slow7
L_ok7:
    v_mfma_f32_16x16x32_bf16 v[36:39], v[136:139], a[228:231], v[36:39]
    ds_read_b64_tr_b16 v[208:209], v180 offset:0
    ds_read_b64_tr_b16 v[210:211], v180 offset:2048
    s_add_u32 m0, s78, 114688
    s_add_u32 s9, s74, 131072
    v_mfma_f32_16x16x32_bf16 v[40:43], v[136:139], a[232:235], v[40:43]
    ds_read_b64_tr_b16 v[212:213], v181 offset:0
    buffer_load_dwordx4 v168, s[36:39], s9 offen lds
    v_mfma_f32_16x16x32_bf16 v[44:47], v[136:139], a[236:239], v[44:47]
    ds_read_b64_tr_b16 v[214:215], v181 offset:2048
    v_mfma_f32_16x16x32_bf16 v[60:63], v[140:143], a[236:239], v[60:63]
    s_add_u32 m0, s79, 114688
    s_add_u32 s9, s75, 131072
    v_mfma_f32_16x16x32_bf16 v[56:59], v[140:143], a[232:235], v[56:59]
    buffer_load_dwordx4 v168, s[36:39], s9 offen lds
    v_mfma_f32_16x16x32_bf16 v[52:55], v[140:143], a[228:231], v[52:55]
    s_waitcnt vmcnt(10) lgkmcnt(0)
    v_mfma_f32_16x16x32_bf16 v[48:51], v[140:143], a[224:227], v[48:51]
    s_barrier
    v_mfma_f32_16x16x32_bf16 v[0:3], v[144:147], a[240:243], v[0:3]
    ds_read_b64 v[192:193], v204 offset:0
    ds_read_b64 v[194:195], v204 offset:128
    v_mfma_f32_16x16x32_bf16 v[4:7], v[144:147], a[244:247], v[4:7]
    ds_read_b64 v[196:197], v204 offset:256
    s_add_u32 m0, s59, 24576
    v_mfma_f32_16x16x32_bf16 v[8:11], v[144:147], a[248:251], v[8:11]
    ds_read_b64 v[198:199], v204 offset:384
    buffer_load_dwordx4 v164, s[28:31], s57 offen offset:0 lds
    v_readlane_b32 s56, v177, 22
    v_mfma_f32_16x16x32_bf16 v[12:15], v[144:147], a[252:255], v[12:15]
    ds_read_b64_tr_b16 v[128:129], v161 offset:32768
    ds_read_b64_tr_b16 v[130:131], v161 offset:33280
    v_mfma_f32_16x16x32_bf16 v[28:31], v[148:151], a[252:255], v[28:31]
    ds_read_b64_tr_b16 v[132:133], v162 offset:32768
    v_mfma_f32_16x16x32_bf16 v[24:27], v[148:151], a[248:251], v[24:27]
    ds_read_b64_tr_b16 v[134:135], v162 offset:33280
    v_mfma_f32_16x16x32_bf16 v[20:23], v[148:151], a[244:247], v[20:23]
    ds_read_b64_tr_b16 v[136:137], v161 offset:36864
    ds_read_b64_tr_b16 v[138:139], v161 offset:37376
    buffer_load_dwordx4 v165, s[28:31], s57 offen offset:1024 lds
    v_mfma_f32_16x16x32_bf16 v[16:19], v[148:151], a[240:243], v[16:19]
    ds_read_b64_tr_b16 v[140:141], v162 offset:36864
    v_mfma_f32_16x16x32_bf16 v[32:35], v[152:155], a[240:243], v[32:35]
    ds_read_b64_tr_b16 v[142:143], v162 offset:37376
    s_add_u32 m0, s80, 114688
    s_add_u32 s9, s76, 131072
    v_mfma_f32_16x16x32_bf16 v[36:39], v[152:155], a[244:247], v[36:39]
    ds_read_b64_tr_b16 v[216:217], v182 offset:0
    ds_read_b64_tr_b16 v[218:219], v182 offset:2048
    buffer_load_dwordx4 v168, s[36:39], s9 offen lds
    v_mfma_f32_16x16x32_bf16 v[40:43], v[152:155], a[248:251], v[40:43]
    ds_read_b64_tr_b16 v[220:221], v183 offset:0
    v_mfma_f32_16x16x32_bf16 v[44:47], v[152:155], a[252:255], v[44:47]
    ds_read_b64_tr_b16 v[222:223], v183 offset:2048
    v_mfma_f32_16x16x32_bf16 v[60:63], v[156:159], a[252:255], v[60:63]
    s_add_u32 m0, s81, 114688
    s_add_u32 s9, s77, 131072
    v_mfma_f32_16x16x32_bf16 v[56:59], v[156:159], a[248:251], v[56:59]
    buffer_load_dwordx4 v168, s[36:39], s9 offen lds
    v_mfma_f32_16x16x32_bf16 v[52:55], v[156:159], a[244:247], v[52:55]
    s_waitcnt vmcnt(12) lgkmcnt(0)
    v_mfma_f32_16x16x32_bf16 v[48:51], v[156:159], a[240:243], v[48:51]
    s_barrier
    v_mfma_f32_16x16x32_bf16 v[64:67], v[128:131], a[0:3], 0
    ds_read_b64_tr_b16 v[144:145], v161 offset:40960
    s_add_u32 s11, s63, 0
    v_mul_f32 v184, v192, v0
    v_mul_f32 v185, v192, v1
    v_mul_f32 v186, v192, v2
    v_mfma_f32_16x16x32_bf16 v[68:71], v[128:131], a[4:7], 0
    ds_read_b64_tr_b16 v[146:147], v161 offset:41472
    s_add_u32 m0, s59, 32768
    v_mul_f32 v187, v192, v3
    v_exp_f32 v184, v184
    v_mfma_f32_16x16x32_bf16 v[72:75], v[128:131], a[8:11], 0
    ds_read_b64_tr_b16 v[148:149], v162 offset:40960
    buffer_load_dwordx4 v164, s[28:31], s56 offen offset:0 lds
    v_readlane_b32 s57, v177, 23
    v_mfma_f32_16x16x32_bf16 v[76:79], v[128:131], a[12:15], 0
    ds_read_b64_tr_b16 v[150:151], v162 offset:41472
    v_mul_f32 v188, v192, v16
    v_mul_f32 v32, v0, v32
    v_mfma_f32_16x16x32_bf16 v[92:95], v[132:135], a[12:15], 0
    ds_read_b64_tr_b16 v[152:153], v161 offset:45056
    v_exp_f32 v185, v185
    v_mul_f32 v189, v192, v17
    v_mul_f32 v33, v1, v33
    v_mfma_f32_16x16x32_bf16 v[88:91], v[132:135], a[8:11], 0
    ds_read_b64_tr_b16 v[154:155], v161 offset:45568
    v_exp_f32 v186, v186
    v_mul_f32 v190, v192, v18
    v_mul_f32 v34, v2, v34
    v_mfma_f32_16x16x32_bf16 v[84:87], v[132:135], a[4:7], 0
    ds_read_b64_tr_b16 v[156:157], v162 offset:45056
    buffer_load_dwordx4 v165, s[28:31], s56 offen offset:1024 lds
    v_mfma_f32_16x16x32_bf16 v[80:83], v[132:135], a[0:3], 0
    ds_read_b64_tr_b16 v[158:159], v162 offset:45568
    v_exp_f32 v187, v187
    v_mul_f32 v191, v192, v19
    v_mfma_f32_16x16x32_bf16 v[96:99], v[136:139], a[0:3], 0
    ds_read_b64_tr_b16 v[224:225], v180 offset:16384
    s_add_u32 m0, s78, 131072
    s_add_u32 s9, s74, 163840
    v_mul_f32 v35, v3, v35
    v_mfma_f32_16x16x32_bf16 v[100:103], v[136:139], a[4:7], 0
    ds_read_b64_tr_b16 v[226:227], v180 offset:18432
    buffer_load_dwordx4 v168, s[36:39], s9 offen lds
    v_mfma_f32_16x16x32_bf16 v[104:107], v[136:139], a[8:11], 0
    ds_read_b64_tr_b16 v[228:229], v181 offset:16384
    v_exp_f32 v188, v188
    v_fma_f32 v184, v184, v193, v193
    v_mul_f32 v48, v16, v48
    v_mfma_f32_16x16x32_bf16 v[108:111], v[136:139], a[12:15], 0
    ds_read_b64_tr_b16 v[230:231], v181 offset:18432
    v_exp_f32 v189, v189
    v_fma_f32 v185, v185, v193, v193
    v_mul_f32 v49, v17, v49
    v_mfma_f32_16x16x32_bf16 v[124:127], v[140:143], a[12:15], 0
    s_add_u32 m0, s79, 131072
    s_add_u32 s9, s75, 163840
    v_exp_f32 v190, v190
    v_fma_f32 v186, v186, v193, v193
    v_mfma_f32_16x16x32_bf16 v[120:123], v[140:143], a[8:11], 0
    buffer_load_dwordx4 v168, s[36:39], s9 offen lds
    v_mul_f32 v50, v18, v50
    v_mfma_f32_16x16x32_bf16 v[116:119], v[140:143], a[4:7], 0
    v_exp_f32 v191, v191
    v_fma_f32 v187, v187, v193, v193
    v_mul_f32 v51, v19, v51
    s_waitcnt vmcnt(14) lgkmcnt(0)
    v_mfma_f32_16x16x32_bf16 v[112:115], v[140:143], a[0:3], 0
    s_barrier
    v_mfma_f32_16x16x32_bf16 v[64:67], v[144:147], a[16:19], v[64:67]
    ds_read_b64_tr_b16 v[128:129], v161 offset:0
    v_rcp_f32 v184, v184
    v_fma_f32 v188, v188, v193, v193
    v_mfma_f32_16x16x32_bf16 v[68:71], v[144:147], a[20:23], v[68:71]
    ds_read_b64_tr_b16 v[130:131], v161 offset:512
    s_add_u32 m0, s59, 40960
    v_rcp_f32 v185, v185
    v_fma_f32 v189, v189, v193, v193
    v_mfma_f32_16x16x32_bf16 v[72:75], v[144:147], a[24:27], v[72:75]
    ds_read_b64_tr_b16 v[132:133], v162 offset:0
    buffer_load_dwordx4 v164, s[28:31], s57 offen offset:0 lds
    v_readlane_b32 s56, v177, 24
    v_mfma_f32_16x16x32_bf16 v[76:79], v[144:147], a[28:31], v[76:79]
    ds_read_b64_tr_b16 v[134:135], v162 offset:512
    v_rcp_f32 v186, v186
    v_fma_f32 v190, v190, v193, v193
    v_mfma_f32_16x16x32_bf16 v[92:95], v[148:151], a[28:31], v[92:95]
    ds_read_b64_tr_b16 v[136:137], v161 offset:4096
    v_rcp_f32 v187, v187
    v_fma_f32 v191, v191, v193, v193
    v_mfma_f32_16x16x32_bf16 v[88:91], v[148:151], a[24:27], v[88:91]
    ds_read_b64_tr_b16 v[138:139], v161 offset:4608
    v_rcp_f32 v188, v188
    v_mul_f32 v32, v32, v184
    v_rcp_f32 v189, v189
    v_mfma_f32_16x16x32_bf16 v[84:87], v[148:151], a[20:23], v[84:87]
    ds_read_b64_tr_b16 v[140:141], v162 offset:4096
    buffer_load_dwordx4 v165, s[28:31], s57 offen offset:1024 lds
    v_mfma_f32_16x16x32_bf16 v[80:83], v[148:151], a[16:19], v[80:83]
    ds_read_b64_tr_b16 v[142:143], v162 offset:4608
    v_mul_f32 v33, v33, v185
    v_rcp_f32 v190, v190
    v_mfma_f32_16x16x32_bf16 v[96:99], v[152:155], a[16:19], v[96:99]
    ds_read_b64_tr_b16 v[232:233], v182 offset:16384
    s_add_u32 m0, s80, 131072
    s_add_u32 s9, s76, 163840
    v_mul_f32 v34, v34, v186
    v_mfma_f32_16x16x32_bf16 v[100:103], v[152:155], a[20:23], v[100:103]
    ds_read_b64_tr_b16 v[234:235], v182 offset:18432
    buffer_load_dwordx4 v168, s[36:39], s9 offen lds
    v_mfma_f32_16x16x32_bf16 v[104:107], v[152:155], a[24:27], v[104:107]
    ds_read_b64_tr_b16 v[236:237], v183 offset:16384
    v_rcp_f32 v191, v191
L_stub8:
    s_cbranch_execz L_tourret
    s_nop 0
    v_mul_f32 v35, v35, v187
    v_cvt_pk_bf16_f32 v0, v32, v33
    v_cvt_pk_bf16_f32 v1, v34, v35
    v_mfma_f32_16x16x32_bf16 v[108:111], v[152:155], a[28:31], v[108:111]
    ds_read_b64_tr_b16 v[238:239], v183 offset:18432
    v_mul_f32 v48, v48, v188
    v_mul_f32 v49, v49, v189
    v_mul_f32 v50, v50, v190
    v_mul_f32 v51, v51, v191
    v_mfma_f32_16x16x32_bf16 v[124:127], v[156:159], a[28:31], v[124:127]
    s_add_u32 m0, s81, 131072
    s_add_u32 s9, s77, 163840
    v_cvt_pk_bf16_f32 v2, v48, v49
    v_cvt_pk_bf16_f32 v3, v50, v51
    v_mfma_f32_16x16x32_bf16 v[120:123], v[156:159], a[24:27], v[120:123]
    buffer_load_dwordx4 v168, s[36:39], s9 offen lds
    v_mfma_f32_16x16x32_bf16 v[116:119], v[156:159], a[20:23], v[116:119]
    buffer_store_dwordx4 v[0:3], v160, s[44:47], s11 offen offset:0 sc1
    v_mul_f32 v184, v194, v4
    s_waitcnt vmcnt(17) lgkmcnt(0)
    v_mfma_f32_16x16x32_bf16 v[112:115], v[156:159], a[16:19], v[112:115]
    s_barrier
    v_mfma_f32_16x16x32_bf16 v[64:67], v[128:131], a[32:35], v[64:67]
    ds_read_b64_tr_b16 v[144:145], v161 offset:8192
    v_mul_f32 v185, v194, v5
    v_mul_f32 v186, v194, v6
    v_mul_f32 v187, v194, v7
    v_mfma_f32_16x16x32_bf16 v[68:71], v[128:131], a[36:39], v[68:71]
    ds_read_b64_tr_b16 v[146:147], v161 offset:8704
    s_add_u32 m0, s59, 0
    v_exp_f32 v184, v184
    v_mul_f32 v188, v194, v20
    v_mul_f32 v36, v4, v36
    v_mfma_f32_16x16x32_bf16 v[72:75], v[128:131], a[40:43], v[72:75]
    ds_read_b64_tr_b16 v[148:149], v162 offset:8192
    buffer_load_dwordx4 v164, s[28:31], s56 offen offset:0 lds
    v_readlane_b32 s57, v177, 25
    v_mfma_f32_16x16x32_bf16 v[76:79], v[128:131], a[44:47], v[76:79]
    ds_read_b64_tr_b16 v[150:151], v162 offset:8704
    v_exp_f32 v185, v185
    v_mfma_f32_16x16x32_bf16 v[92:95], v[132:135], a[44:47], v[92:95]
    ds_read_b64_tr_b16 v[152:153], v161 offset:12288
    v_mul_f32 v189, v194, v21
    v_mul_f32 v37, v5, v37
    v_exp_f32 v186, v186
    v_mfma_f32_16x16x32_bf16 v[88:91], v[132:135], a[40:43], v[88:91]
    ds_read_b64_tr_b16 v[154:155], v161 offset:12800
    v_mul_f32 v190, v194, v22
    v_mul_f32 v38, v6, v38
    v_exp_f32 v187, v187
    v_mfma_f32_16x16x32_bf16 v[84:87], v[132:135], a[36:39], v[84:87]
    ds_read_b64_tr_b16 v[156:157], v162 offset:12288
    buffer_load_dwordx4 v165, s[28:31], s56 offen offset:1024 lds
    v_mfma_f32_16x16x32_bf16 v[80:83], v[132:135], a[32:35], v[80:83]
    ds_read_b64_tr_b16 v[158:159], v162 offset:12800
    v_mul_f32 v191, v194, v23
    v_mul_f32 v39, v7, v39
    v_mfma_f32_16x16x32_bf16 v[96:99], v[136:139], a[32:35], v[96:99]
    ds_read_b64_tr_b16 v[240:241], v180 offset:32768
    s_add_u32 m0, s78, 147456
    s_add_u32 s9, s74, 196608
    v_exp_f32 v188, v188
    v_fma_f32 v184, v184, v195, v195
    v_mfma_f32_16x16x32_bf16 v[100:103], v[136:139], a[36:39], v[100:103]
    ds_read_b64_tr_b16 v[242:243], v180 offset:34816
    buffer_load_dwordx4 v168, s[36:39], s9 offen lds
    v_mfma_f32_16x16x32_bf16 v[104:107], v[136:139], a[40:43], v[104:107]
    ds_read_b64_tr_b16 v[244:245], v181 offset:32768
    v_mul_f32 v52, v20, v52
    v_exp_f32 v189, v189
    v_fma_f32 v185, v185, v195, v195
    v_mfma_f32_16x16x32_bf16 v[108:111], v[136:139], a[44:47], v[108:111]
    ds_read_b64_tr_b16 v[246:247], v181 offset:34816
    v_mul_f32 v53, v21, v53
    v_exp_f32 v190, v190
    v_fma_f32 v186, v186, v195, v195
    v_mfma_f32_16x16x32_bf16 v[124:127], v[140:143], a[44:47], v[124:127]
    s_add_u32 m0, s79, 147456
    s_add_u32 s9, s75, 196608
    v_mul_f32 v54, v22, v54
    v_mfma_f32_16x16x32_bf16 v[120:123], v[140:143], a[40:43], v[120:123]
    buffer_load_dwordx4 v168, s[36:39], s9 offen lds
    v_exp_f32 v191, v191
    v_mfma_f32_16x16x32_bf16 v[116:119], v[140:143], a[36:39], v[116:119]
    v_fma_f32 v187, v187, v195, v195
    v_mul_f32 v55, v23, v55
    v_rcp_f32 v184, v184
    s_waitcnt vmcnt(19) lgkmcnt(0)
    v_mfma_f32_16x16x32_bf16 v[112:115], v[140:143], a[32:35], v[112:115]
    s_barrier
    v_mfma_f32_16x16x32_bf16 v[64:67], v[144:147], a[48:51], v[64:67]
    ds_read_b64_tr_b16 v[128:129], v161 offset:16384
    v_fma_f32 v188, v188, v195, v195
    v_rcp_f32 v185, v185
    v_fma_f32 v189, v189, v195, v195
    v_mfma_f32_16x16x32_bf16 v[68:71], v[144:147], a[52:55], v[68:71]
    ds_read_b64_tr_b16 v[130:131], v161 offset:16896
    s_add_u32 m0, s59, 8192
    v_rcp_f32 v186, v186
    v_fma_f32 v190, v190, v195, v195
    v_mfma_f32_16x16x32_bf16 v[72:75], v[144:147], a[56:59], v[72:75]
    ds_read_b64_tr_b16 v[132:133], v162 offset:16384
    buffer_load_dwordx4 v164, s[28:31], s57 offen offset:0 lds
    v_readlane_b32 s56, v177, 26
    v_mfma_f32_16x16x32_bf16 v[76:79], v[144:147], a[60:63], v[76:79]
    ds_read_b64_tr_b16 v[134:135], v162 offset:16896
    v_rcp_f32 v187, v187
    v_mfma_f32_16x16x32_bf16 v[92:95], v[148:151], a[60:63], v[92:95]
    ds_read_b64_tr_b16 v[136:137], v161 offset:20480
    v_fma_f32 v191, v191, v195, v195
    v_rcp_f32 v188, v188
    v_mul_f32 v36, v36, v184
    v_mfma_f32_16x16x32_bf16 v[88:91], v[148:151], a[56:59], v[88:91]
    ds_read_b64_tr_b16 v[138:139], v161 offset:20992
    v_rcp_f32 v189, v189
    v_mul_f32 v37, v37, v185
    v_mfma_f32_16x16x32_bf16 v[84:87], v[148:151], a[52:55], v[84:87]
    ds_read_b64_tr_b16 v[140:141], v162 offset:20480
    buffer_load_dwordx4 v165, s[28:31], s57 offen offset:1024 lds
    v_mfma_f32_16x16x32_bf16 v[80:83], v[148:151], a[48:51], v[80:83]
    ds_read_b64_tr_b16 v[142:143], v162 offset:20992
    v_rcp_f32 v190, v190
    v_mul_f32 v38, v38, v186
    v_mfma_f32_16x16x32_bf16 v[96:99], v[152:155], a[48:51], v[96:99]
    ds_read_b64_tr_b16 v[248:249], v182 offset:32768
    s_add_u32 m0, s80, 147456
    s_add_u32 s9, s76, 196608
    v_rcp_f32 v191, v191
    v_mul_f32 v39, v39, v187
    v_mfma_f32_16x16x32_bf16 v[100:103], v[152:155], a[52:55], v[100:103]
    ds_read_b64_tr_b16 v[250:251], v182 offset:34816
    buffer_load_dwordx4 v168, s[36:39], s9 offen lds
    v_mfma_f32_16x16x32_bf16 v[104:107], v[152:155], a[56:59], v[104:107]
    ds_read_b64_tr_b16 v[252:253], v183 offset:32768
    v_cvt_pk_bf16_f32 v4, v36, v37
    v_cvt_pk_bf16_f32 v5, v38, v39
    v_mul_f32 v52, v52, v188
    v_mul_f32 v53, v53, v189
    v_mfma_f32_16x16x32_bf16 v[108:111], v[152:155], a[60:63], v[108:111]
    ds_read_b64_tr_b16 v[254:255], v183 offset:34816
    v_mul_f32 v54, v54, v190
    v_mul_f32 v55, v55, v191
    v_cvt_pk_bf16_f32 v6, v52, v53
    v_cvt_pk_bf16_f32 v7, v54, v55
    v_mfma_f32_16x16x32_bf16 v[124:127], v[156:159], a[60:63], v[124:127]
    s_add_u32 m0, s81, 147456
    s_add_u32 s9, s77, 196608
    v_mfma_f32_16x16x32_bf16 v[120:123], v[156:159], a[56:59], v[120:123]
    buffer_load_dwordx4 v168, s[36:39], s9 offen lds
    v_mfma_f32_16x16x32_bf16 v[116:119], v[156:159], a[52:55], v[116:119]
    buffer_store_dwordx4 v[4:7], v160, s[44:47], s11 offen offset:1024 sc1
    v_mul_f32 v184, v196, v8
    v_mul_f32 v185, v196, v9
    v_mul_f32 v186, v196, v10
    s_waitcnt vmcnt(20) lgkmcnt(0)
    v_mfma_f32_16x16x32_bf16 v[112:115], v[156:159], a[48:51], v[112:115]
    s_barrier
    v_mfma_f32_16x16x32_bf16 v[64:67], v[128:131], a[64:67], v[64:67]
    ds_read_b64_tr_b16 v[144:145], v161 offset:24576
    s_add_u32 m0, s59, 16384
    v_mul_f32 v187, v196, v11
    v_mfma_f32_16x16x32_bf16 v[68:71], v[128:131], a[68:71], v[68:71]
    buffer_load_dwordx4 v164, s[28:31], s56 offen offset:0 lds
    v_readlane_b32 s57, v177, 27
    v_mfma_f32_16x16x32_bf16 v[72:75], v[128:131], a[72:75], v[72:75]
    ds_read_b64_tr_b16 v[146:147], v161 offset:25088
    v_exp_f32 v184, v184
    v_mul_f32 v188, v196, v24
    v_mul_f32 v40, v8, v40
    v_mfma_f32_16x16x32_bf16 v[76:79], v[128:131], a[76:79], v[76:79]
    ds_read_b64_tr_b16 v[148:149], v162 offset:24576
    v_exp_f32 v185, v185
    v_mul_f32 v189, v196, v25
    v_mul_f32 v41, v9, v41
    v_mfma_f32_16x16x32_bf16 v[92:95], v[132:135], a[76:79], v[92:95]
    v_exp_f32 v186, v186
    v_mul_f32 v190, v196, v26
    v_mul_f32 v42, v10, v42
    v_mfma_f32_16x16x32_bf16 v[88:91], v[132:135], a[72:75], v[88:91]
    ds_read_b64_tr_b16 v[150:151], v162 offset:25088
    v_exp_f32 v187, v187
    v_mul_f32 v191, v196, v27
    v_mul_f32 v43, v11, v43
    v_mfma_f32_16x16x32_bf16 v[84:87], v[132:135], a[68:71], v[84:87]
    ds_read_b64_tr_b16 v[152:153], v161 offset:28672
    v_exp_f32 v188, v188
    v_fma_f32 v184, v184, v197, v197
    v_mfma_f32_16x16x32_bf16 v[80:83], v[132:135], a[64:67], v[80:83]
    buffer_load_dwordx4 v165, s[28:31], s56 offen offset:1024 lds
    v_mul_f32 v56, v24, v56
    v_mfma_f32_16x16x32_bf16 v[96:99], v[136:139], a[64:67], v[96:99]
    ds_read_b64_tr_b16 v[154:155], v161 offset:29184
    v_exp_f32 v189, v189
    v_fma_f32 v185, v185, v197, v197
    v_mfma_f32_16x16x32_bf16 v[100:103], v[136:139], a[68:71], v[100:103]
    ds_read_b64_tr_b16 v[156:157], v162 offset:28672
    v_mul_f32 v57, v25, v57
    v_exp_f32 v190, v190
    v_fma_f32 v186, v186, v197, v197
    v_mfma_f32_16x16x32_bf16 v[104:107], v[136:139], a[72:75], v[104:107]
    v_mul_f32 v58, v26, v58
    v_exp_f32 v191, v191
    v_fma_f32 v187, v187, v197, v197
    v_mfma_f32_16x16x32_bf16 v[108:111], v[136:139], a[76:79], v[108:111]
    ds_read_b64_tr_b16 v[158:159], v162 offset:29184
    s_add_u32 m0, s78, 49152
    s_add_u32 s9, s74, 229376
    v_mul_f32 v59, v27, v59
    v_mfma_f32_16x16x32_bf16 v[124:127], v[140:143], a[76:79], v[124:127]
    buffer_load_dwordx4 v168, s[36:39], s9 offen lds
    v_mfma_f32_16x16x32_bf16 v[120:123], v[140:143], a[72:75], v[120:123]
    s_add_u32 m0, s79, 49152
    s_add_u32 s9, s75, 229376
    v_rcp_f32 v184, v184
    v_fma_f32 v188, v188, v197, v197
    v_mfma_f32_16x16x32_bf16 v[116:119], v[140:143], a[68:71], v[116:119]
    buffer_load_dwordx4 v168, s[36:39], s9 offen lds
    s_waitcnt vmcnt(20) lgkmcnt(0)
    v_mfma_f32_16x16x32_bf16 v[112:115], v[140:143], a[64:67], v[112:115]
    s_barrier
    v_mfma_f32_16x16x32_bf16 v[64:67], v[144:147], a[80:83], v[64:67]
    ds_read_b64_tr_b16 v[128:129], v161 offset:32768
    s_add_u32 m0, s59, 24576
    v_rcp_f32 v185, v185
    v_fma_f32 v189, v189, v197, v197
    v_mfma_f32_16x16x32_bf16 v[68:71], v[144:147], a[84:87], v[68:71]
    buffer_load_dwordx4 v164, s[28:31], s57 offen offset:0 lds
    v_readlane_b32 s56, v177, 28
    v_mfma_f32_16x16x32_bf16 v[72:75], v[144:147], a[88:91], v[72:75]
    ds_read_b64_tr_b16 v[130:131], v161 offset:33280
    v_rcp_f32 v186, v186
    v_fma_f32 v190, v190, v197, v197
    v_mfma_f32_16x16x32_bf16 v[76:79], v[144:147], a[92:95], v[76:79]
    ds_read_b64_tr_b16 v[132:133], v162 offset:32768
    v_rcp_f32 v187, v187
    v_fma_f32 v191, v191, v197, v197
    v_mfma_f32_16x16x32_bf16 v[92:95], v[148:151], a[92:95], v[92:95]
    v_rcp_f32 v188, v188
    v_mul_f32 v40, v40, v184
    v_rcp_f32 v189, v189
    v_mfma_f32_16x16x32_bf16 v[88:91], v[148:151], a[88:91], v[88:91]
    ds_read_b64_tr_b16 v[134:135], v162 offset:33280
    v_mul_f32 v41, v41, v185
    v_rcp_f32 v190, v190
    v_mfma_f32_16x16x32_bf16 v[84:87], v[148:151], a[84:87], v[84:87]
    ds_read_b64_tr_b16 v[136:137], v161 offset:36864
    v_mul_f32 v42, v42, v186
    v_rcp_f32 v191, v191
    v_mul_f32 v43, v43, v187
    v_mfma_f32_16x16x32_bf16 v[80:83], v[148:151], a[80:83], v[80:83]
    buffer_load_dwordx4 v165, s[28:31], s57 offen offset:1024 lds
    v_mfma_f32_16x16x32_bf16 v[96:99], v[152:155], a[80:83], v[96:99]
    ds_read_b64_tr_b16 v[138:139], v161 offset:37376
    v_cvt_pk_bf16_f32 v8, v40, v41
    v_cvt_pk_bf16_f32 v9, v42, v43
    v_mul_f32 v56, v56, v188
    v_mul_f32 v57, v57, v189
    v_mfma_f32_16x16x32_bf16 v[100:103], v[152:155], a[84:87], v[100:103]
    ds_read_b64_tr_b16 v[140:141], v162 offset:36864
    v_mul_f32 v58, v58, v190
    v_mul_f32 v59, v59, v191
    v_cvt_pk_bf16_f32 v10, v56, v57
    v_mfma_f32_16x16x32_bf16 v[104:107], v[152:155], a[88:91], v[104:107]
    v_cvt_pk_bf16_f32 v11, v58, v59
    buffer_store_dwordx4 v[8:11], v160, s[44:47], s11 offen offset:2048 sc1
    v_mfma_f32_16x16x32_bf16 v[108:111], v[152:155], a[92:95], v[108:111]
    ds_read_b64_tr_b16 v[142:143], v162 offset:37376
    s_add_u32 m0, s80, 49152
    s_add_u32 s9, s76, 229376
    v_mul_f32 v184, v198, v12
    v_mfma_f32_16x16x32_bf16 v[124:127], v[156:159], a[92:95], v[124:127]
    buffer_load_dwordx4 v168, s[36:39], s9 offen lds
    v_mul_f32 v185, v198, v13
    v_mfma_f32_16x16x32_bf16 v[120:123], v[156:159], a[88:91], v[120:123]
    s_add_u32 m0, s81, 49152
    s_add_u32 s9, s77, 229376
    v_mul_f32 v186, v198, v14
    v_mul_f32 v187, v198, v15
    v_mfma_f32_16x16x32_bf16 v[116:119], v[156:159], a[84:87], v[116:119]
    buffer_load_dwordx4 v168, s[36:39], s9 offen lds
    s_waitcnt vmcnt(21) lgkmcnt(0)
    v_mfma_f32_16x16x32_bf16 v[112:115], v[156:159], a[80:83], v[112:115]
    s_barrier
    v_mfma_f32_16x16x32_bf16 v[64:67], v[128:131], a[96:99], v[64:67]
    ds_read_b64_tr_b16 v[144:145], v161 offset:40960
    s_add_u32 m0, s59, 32768
    v_exp_f32 v184, v184
    v_mul_f32 v188, v198, v28
    v_mfma_f32_16x16x32_bf16 v[68:71], v[128:131], a[100:103], v[68:71]
    buffer_load_dwordx4 v164, s[28:31], s56 offen offset:0 lds
    v_readlane_b32 s57, v177, 29
    v_mfma_f32_16x16x32_bf16 v[72:75], v[128:131], a[104:107], v[72:75]
    ds_read_b64_tr_b16 v[146:147], v161 offset:41472
    v_mul_f32 v44, v12, v44
    v_exp_f32 v185, v185
    v_mfma_f32_16x16x32_bf16 v[76:79], v[128:131], a[108:111], v[76:79]
    ds_read_b64_tr_b16 v[148:149], v162 offset:40960
    v_mul_f32 v189, v198, v29
    v_mul_f32 v45, v13, v45
    v_mfma_f32_16x16x32_bf16 v[92:95], v[132:135], a[108:111], v[92:95]
    v_exp_f32 v186, v186
    v_mul_f32 v190, v198, v30
    v_mul_f32 v46, v14, v46
    v_exp_f32 v187, v187
    v_mfma_f32_16x16x32_bf16 v[88:91], v[132:135], a[104:107], v[88:91]
    ds_read_b64_tr_b16 v[150:151], v162 offset:41472
    v_mul_f32 v191, v198, v31
    v_mul_f32 v47, v15, v47
    v_mfma_f32_16x16x32_bf16 v[84:87], v[132:135], a[100:103], v[84:87]
    ds_read_b64_tr_b16 v[152:153], v161 offset:45056
    v_exp_f32 v188, v188
    v_fma_f32 v184, v184, v199, v199
    v_mul_f32 v60, v28, v60
    v_mfma_f32_16x16x32_bf16 v[80:83], v[132:135], a[96:99], v[80:83]
    buffer_load_dwordx4 v165, s[28:31], s56 offen offset:1024 lds
    v_mfma_f32_16x16x32_bf16 v[96:99], v[136:139], a[96:99], v[96:99]
    ds_read_b64_tr_b16 v[154:155], v161 offset:45568
    v_exp_f32 v189, v189
    v_fma_f32 v185, v185, v199, v199
    v_mul_f32 v61, v29, v61
    v_mfma_f32_16x16x32_bf16 v[100:103], v[136:139], a[100:103], v[100:103]
    ds_read_b64_tr_b16 v[156:157], v162 offset:45056
    v_exp_f32 v190, v190
    v_fma_f32 v186, v186, v199, v199
    v_mul_f32 v62, v30, v62
    v_mfma_f32_16x16x32_bf16 v[104:107], v[136:139], a[104:107], v[104:107]
    v_exp_f32 v191, v191
    v_fma_f32 v187, v187, v199, v199
    v_mul_f32 v63, v31, v63
    v_mfma_f32_16x16x32_bf16 v[108:111], v[136:139], a[108:111], v[108:111]
    ds_read_b64_tr_b16 v[158:159], v162 offset:45568
    s_add_u32 m0, s78, 65536
    s_add_u32 s9, s74, 262144
    v_rcp_f32 v184, v184
    v_mfma_f32_16x16x32_bf16 v[124:127], v[140:143], a[108:111], v[124:127]
    buffer_load_dwordx4 v168, s[36:39], s9 offen lds
    v_fma_f32 v188, v188, v199, v199
    v_mfma_f32_16x16x32_bf16 v[120:123], v[140:143], a[104:107], v[120:123]
    s_add_u32 m0, s79, 65536
    s_add_u32 s9, s75, 262144
    v_rcp_f32 v185, v185
    v_mfma_f32_16x16x32_bf16 v[116:119], v[140:143], a[100:103], v[116:119]
    buffer_load_dwordx4 v168, s[36:39], s9 offen lds
    s_waitcnt vmcnt(20) lgkmcnt(0)
    v_mfma_f32_16x16x32_bf16 v[112:115], v[140:143], a[96:99], v[112:115]
    s_barrier
    v_mfma_f32_16x16x32_bf16 v[64:67], v[144:147], a[112:115], v[64:67]
    ds_read_b64_tr_b16 v[128:129], v161 offset:0
    s_add_u32 m0, s59, 40960
    v_fma_f32 v189, v189, v199, v199
    v_mfma_f32_16x16x32_bf16 v[68:71], v[144:147], a[116:119], v[68:71]
    buffer_load_dwordx4 v164, s[28:31], s57 offen offset:0 lds
    v_readlane_b32 s56, v177, 30
    v_mfma_f32_16x16x32_bf16 v[72:75], v[144:147], a[120:123], v[72:75]
    ds_read_b64_tr_b16 v[130:131], v161 offset:512
    v_rcp_f32 v186, v186
    v_fma_f32 v190, v190, v199, v199
    v_mfma_f32_16x16x32_bf16 v[76:79], v[144:147], a[124:127], v[76:79]
    ds_read_b64_tr_b16 v[132:133], v162 offset:0
    v_rcp_f32 v187, v187
    v_fma_f32 v191, v191, v199, v199
    v_mfma_f32_16x16x32_bf16 v[92:95], v[148:151], a[124:127], v[92:95]
    v_rcp_f32 v188, v188
    v_mul_f32 v44, v44, v184
    v_rcp_f32 v189, v189
    v_mfma_f32_16x16x32_bf16 v[88:91], v[148:151], a[120:123], v[88:91]
    ds_read_b64_tr_b16 v[134:135], v162 offset:512
    v_mul_f32 v45, v45, v185
    v_rcp_f32 v190, v190
    v_mfma_f32_16x16x32_bf16 v[84:87], v[148:151], a[116:119], v[84:87]
    ds_read_b64_tr_b16 v[136:137], v161 offset:4096
    v_mul_f32 v46, v46, v186
    v_rcp_f32 v191, v191
    v_mfma_f32_16x16x32_bf16 v[80:83], v[148:151], a[112:115], v[80:83]
    buffer_load_dwordx4 v165, s[28:31], s57 offen offset:1024 lds
    v_mfma_f32_16x16x32_bf16 v[96:99], v[152:155], a[112:115], v[96:99]
    ds_read_b64_tr_b16 v[138:139], v161 offset:4608
    v_mul_f32 v47, v47, v187
    v_cvt_pk_bf16_f32 v12, v44, v45
    v_cvt_pk_bf16_f32 v13, v46, v47
    v_mfma_f32_16x16x32_bf16 v[100:103], v[152:155], a[116:119], v[100:103]
    ds_read_b64_tr_b16 v[140:141], v162 offset:4096
    v_mul_f32 v60, v60, v188
    v_mul_f32 v61, v61, v189
    v_mul_f32 v62, v62, v190
    v_mfma_f32_16x16x32_bf16 v[104:107], v[152:155], a[120:123], v[104:107]
    v_mul_f32 v63, v63, v191
    v_cvt_pk_bf16_f32 v14, v60, v61
    v_cvt_pk_bf16_f32 v15, v62, v63
    v_mfma_f32_16x16x32_bf16 v[108:111], v[152:155], a[124:127], v[108:111]
    ds_read_b64_tr_b16 v[142:143], v162 offset:4608
    s_add_u32 m0, s80, 65536
    s_add_u32 s9, s76, 262144
    v_mfma_f32_16x16x32_bf16 v[124:127], v[156:159], a[124:127], v[124:127]
    buffer_load_dwordx4 v168, s[36:39], s9 offen lds
    v_mfma_f32_16x16x32_bf16 v[120:123], v[156:159], a[120:123], v[120:123]
    s_add_u32 m0, s81, 65536
    s_add_u32 s9, s77, 262144
    buffer_store_dwordx4 v[12:15], v160, s[44:47], s11 offen offset:3072 sc1
    v_mfma_f32_16x16x32_bf16 v[116:119], v[156:159], a[116:119], v[116:119]
    buffer_load_dwordx4 v168, s[36:39], s9 offen lds
    s_waitcnt vmcnt(21) lgkmcnt(0)
    v_mfma_f32_16x16x32_bf16 v[112:115], v[156:159], a[112:115], v[112:115]
    s_barrier
    v_mfma_f32_16x16x32_bf16 v[64:67], v[128:131], a[128:131], v[64:67]
    ds_read_b64_tr_b16 v[144:145], v161 offset:8192
    s_add_u32 m0, s59, 0
    v_mfma_f32_16x16x32_bf16 v[68:71], v[128:131], a[132:135], v[68:71]
    buffer_load_dwordx4 v164, s[28:31], s56 offen offset:0 lds
    v_readlane_b32 s57, v177, 31
    v_mfma_f32_16x16x32_bf16 v[72:75], v[128:131], a[136:139], v[72:75]
    ds_read_b64_tr_b16 v[146:147], v161 offset:8704
    v_mfma_f32_16x16x32_bf16 v[76:79], v[128:131], a[140:143], v[76:79]
    ds_read_b64_tr_b16 v[148:149], v162 offset:8192
    v_mfma_f32_16x16x32_bf16 v[92:95], v[132:135], a[140:143], v[92:95]
    v_mfma_f32_16x16x32_bf16 v[88:91], v[132:135], a[136:139], v[88:91]
    ds_read_b64_tr_b16 v[150:151], v162 offset:8704
    v_mfma_f32_16x16x32_bf16 v[84:87], v[132:135], a[132:135], v[84:87]
    ds_read_b64_tr_b16 v[152:153], v161 offset:12288
    v_mfma_f32_16x16x32_bf16 v[80:83], v[132:135], a[128:131], v[80:83]
    buffer_load_dwordx4 v165, s[28:31], s56 offen offset:1024 lds
    v_mfma_f32_16x16x32_bf16 v[96:99], v[136:139], a[128:131], v[96:99]
    ds_read_b64_tr_b16 v[154:155], v161 offset:12800
    v_mfma_f32_16x16x32_bf16 v[100:103], v[136:139], a[132:135], v[100:103]
    ds_read_b64_tr_b16 v[156:157], v162 offset:12288
    v_mfma_f32_16x16x32_bf16 v[104:107], v[136:139], a[136:139], v[104:107]
    v_mfma_f32_16x16x32_bf16 v[108:111], v[136:139], a[140:143], v[108:111]
    ds_read_b64_tr_b16 v[158:159], v162 offset:12800
    s_add_u32 m0, s78, 81920
    s_add_u32 s9, s74, 294912
    v_mfma_f32_16x16x32_bf16 v[124:127], v[140:143], a[140:143], v[124:127]
    buffer_load_dwordx4 v168, s[36:39], s9 offen lds
    v_mfma_f32_16x16x32_bf16 v[120:123], v[140:143], a[136:139], v[120:123]
    s_add_u32 m0, s79, 81920
    s_add_u32 s9, s75, 294912
    v_mfma_f32_16x16x32_bf16 v[116:119], v[140:143], a[132:135], v[116:119]
    buffer_load_dwordx4 v168, s[36:39], s9 offen lds
    s_waitcnt vmcnt(20) lgkmcnt(0)
    v_mfma_f32_16x16x32_bf16 v[112:115], v[140:143], a[128:131], v[112:115]
    s_barrier
    v_mfma_f32_16x16x32_bf16 v[64:67], v[144:147], a[144:147], v[64:67]
    ds_read_b64_tr_b16 v[128:129], v161 offset:16384
    s_add_u32 m0, s59, 8192
    v_mfma_f32_16x16x32_bf16 v[68:71], v[144:147], a[148:151], v[68:71]
    buffer_load_dwordx4 v164, s[28:31], s57 offen offset:0 lds
    v_readlane_b32 s56, v177, 32
    v_mfma_f32_16x16x32_bf16 v[72:75], v[144:147], a[152:155], v[72:75]
    ds_read_b64_tr_b16 v[130:131], v161 offset:16896
    v_mfma_f32_16x16x32_bf16 v[76:79], v[144:147], a[156:159], v[76:79]
    ds_read_b64_tr_b16 v[132:133], v162 offset:16384
    v_mfma_f32_16x16x32_bf16 v[92:95], v[148:151], a[156:159], v[92:95]
    v_mfma_f32_16x16x32_bf16 v[88:91], v[148:151], a[152:155], v[88:91]
    ds_read_b64_tr_b16 v[134:135], v162 offset:16896
    v_mfma_f32_16x16x32_bf16 v[84:87], v[148:151], a[148:151], v[84:87]
    ds_read_b64_tr_b16 v[136:137], v161 offset:20480
    v_mfma_f32_16x16x32_bf16 v[80:83], v[148:151], a[144:147], v[80:83]
    buffer_load_dwordx4 v165, s[28:31], s57 offen offset:1024 lds
    v_mfma_f32_16x16x32_bf16 v[96:99], v[152:155], a[144:147], v[96:99]
    ds_read_b64_tr_b16 v[138:139], v161 offset:20992
    v_mfma_f32_16x16x32_bf16 v[100:103], v[152:155], a[148:151], v[100:103]
    ds_read_b64_tr_b16 v[140:141], v162 offset:20480
    v_mfma_f32_16x16x32_bf16 v[104:107], v[152:155], a[152:155], v[104:107]
    v_mfma_f32_16x16x32_bf16 v[108:111], v[152:155], a[156:159], v[108:111]
    ds_read_b64_tr_b16 v[142:143], v162 offset:20992
    s_add_u32 m0, s80, 81920
    s_add_u32 s9, s76, 294912
    v_mfma_f32_16x16x32_bf16 v[124:127], v[156:159], a[156:159], v[124:127]
    buffer_load_dwordx4 v168, s[36:39], s9 offen lds
    v_mfma_f32_16x16x32_bf16 v[120:123], v[156:159], a[152:155], v[120:123]
    s_add_u32 m0, s81, 81920
    s_add_u32 s9, s77, 294912
    v_mfma_f32_16x16x32_bf16 v[116:119], v[156:159], a[148:151], v[116:119]
    buffer_load_dwordx4 v168, s[36:39], s9 offen lds
    s_waitcnt vmcnt(20) lgkmcnt(0)
    v_mfma_f32_16x16x32_bf16 v[112:115], v[156:159], a[144:147], v[112:115]
    s_barrier
    v_mfma_f32_16x16x32_bf16 v[64:67], v[128:131], a[160:163], v[64:67]
    ds_read_b64_tr_b16 v[144:145], v161 offset:24576
    v_mfma_f32_16x16x32_bf16 v[68:71], v[128:131], a[164:167], v[68:71]
    v_mfma_f32_16x16x32_bf16 v[72:75], v[128:131], a[168:171], v[72:75]
    ds_read_b64_tr_b16 v[146:147], v161 offset:25088
    v_mfma_f32_16x16x32_bf16 v[76:79], v[128:131], a[172:175], v[76:79]
    ds_read_b64_tr_b16 v[148:149], v162 offset:24576
    s_add_u32 m0, s59, 16384
    v_mfma_f32_16x16x32_bf16 v[92:95], v[132:135], a[172:175], v[92:95]
    buffer_load_dwordx4 v166, s[28:31], s56 offen offset:0 lds
    v_readlane_b32 s57, v177, 33
    v_mfma_f32_16x16x32_bf16 v[88:91], v[132:135], a[168:171], v[88:91]
    ds_read_b64_tr_b16 v[150:151], v162 offset:25088
    v_mfma_f32_16x16x32_bf16 v[84:87], v[132:135], a[164:167], v[84:87]
    ds_read_b64_tr_b16 v[152:153], v161 offset:28672
    v_mfma_f32_16x16x32_bf16 v[80:83], v[132:135], a[160:163], v[80:83]
    v_mfma_f32_16x16x32_bf16 v[96:99], v[136:139], a[160:163], v[96:99]
    ds_read_b64_tr_b16 v[154:155], v161 offset:29184
    v_mfma_f32_16x16x32_bf16 v[100:103], v[136:139], a[164:167], v[100:103]
    ds_read_b64_tr_b16 v[156:157], v162 offset:28672
    v_mfma_f32_16x16x32_bf16 v[104:107], v[136:139], a[168:171], v[104:107]
    v_mfma_f32_16x16x32_bf16 v[108:111], v[136:139], a[172:175], v[108:111]
    ds_read_b64_tr_b16 v[158:159], v162 offset:29184
    v_mfma_f32_16x16x32_bf16 v[124:127], v[140:143], a[172:175], v[124:127]
    v_mfma_f32_16x16x32_bf16 v[120:123], v[140:143], a[168:171], v[120:123]
    buffer_load_dwordx4 v167, s[28:31], s56 offen offset:1024 lds
    v_mfma_f32_16x16x32_bf16 v[116:119], v[140:143], a[164:167], v[116:119]
    s_waitcnt vmcnt(17) lgkmcnt(0)
    v_mfma_f32_16x16x32_bf16 v[112:115], v[140:143], a[160:163], v[112:115]
    s_barrier
    v_mfma_f32_16x16x32_bf16 v[64:67], v[144:147], a[176:179], v[64:67]
    ds_read_b64_tr_b16 v[128:129], v161 offset:32768
    v_mfma_f32_16x16x32_bf16 v[68:71], v[144:147], a[180:183], v[68:71]
    v_mfma_f32_16x16x32_bf16 v[72:75], v[144:147], a[184:187], v[72:75]
    ds_read_b64_tr_b16 v[130:131], v161 offset:33280
    v_mfma_f32_16x16x32_bf16 v[76:79], v[144:147], a[188:191], v[76:79]
    ds_read_b64_tr_b16 v[132:133], v162 offset:32768
    s_add_u32 m0, s59, 24576
    v_mfma_f32_16x16x32_bf16 v[92:95], v[148:151], a[188:191], v[92:95]
    buffer_load_dwordx4 v166, s[28:31], s57 offen offset:0 lds
    v_readlane_b32 s56, v177, 34
    v_mfma_f32_16x16x32_bf16 v[88:91], v[148:151], a[184:187], v[88:91]
    ds_read_b64_tr_b16 v[134:135], v162 offset:33280
    v_mfma_f32_16x16x32_bf16 v[84:87], v[148:151], a[180:183], v[84:87]
    ds_read_b64_tr_b16 v[136:137], v161 offset:36864
    v_mfma_f32_16x16x32_bf16 v[80:83], v[148:151], a[176:179], v[80:83]
    v_mfma_f32_16x16x32_bf16 v[96:99], v[152:155], a[176:179], v[96:99]
    ds_read_b64_tr_b16 v[138:139], v161 offset:37376
    v_mfma_f32_16x16x32_bf16 v[100:103], v[152:155], a[180:183], v[100:103]
    ds_read_b64_tr_b16 v[140:141], v162 offset:36864
    v_mfma_f32_16x16x32_bf16 v[104:107], v[152:155], a[184:187], v[104:107]
    buffer_load_dwordx4 v167, s[28:31], s57 offen offset:1024 lds
    v_mfma_f32_16x16x32_bf16 v[108:111], v[152:155], a[188:191], v[108:111]
    ds_read_b64_tr_b16 v[142:143], v162 offset:37376
    v_mfma_f32_16x16x32_bf16 v[124:127], v[156:159], a[188:191], v[124:127]
    v_mfma_f32_16x16x32_bf16 v[120:123], v[156:159], a[184:187], v[120:123]
    s_waitcnt vmcnt(13)
    buffer_store_dword v169, v169, s[44:47], s65 offen offset:0 sc1
    v_mfma_f32_16x16x32_bf16 v[116:119], v[156:159], a[180:183], v[116:119]
    s_waitcnt lgkmcnt(0)
    v_mfma_f32_16x16x32_bf16 v[112:115], v[156:159], a[176:179], v[112:115]
    s_barrier
    v_mfma_f32_16x16x32_bf16 v[64:67], v[128:131], a[192:195], v[64:67]
    ds_read_b64_tr_b16 v[144:145], v161 offset:40960
    v_mfma_f32_16x16x32_bf16 v[68:71], v[128:131], a[196:199], v[68:71]
    v_mfma_f32_16x16x32_bf16 v[72:75], v[128:131], a[200:203], v[72:75]
    ds_read_b64_tr_b16 v[146:147], v161 offset:41472
    v_mfma_f32_16x16x32_bf16 v[76:79], v[128:131], a[204:207], v[76:79]
    ds_read_b64_tr_b16 v[148:149], v162 offset:40960
    s_add_u32 m0, s59, 32768
    v_mfma_f32_16x16x32_bf16 v[92:95], v[132:135], a[204:207], v[92:95]
    buffer_load_dwordx4 v166, s[28:31], s56 offen offset:0 lds
    v_readlane_b32 s57, v177, 35
    v_mfma_f32_16x16x32_bf16 v[88:91], v[132:135], a[200:203], v[88:91]
    ds_read_b64_tr_b16 v[150:151], v162 offset:41472
    v_mfma_f32_16x16x32_bf16 v[84:87], v[132:135], a[196:199], v[84:87]
    ds_read_b64_tr_b16 v[152:153], v161 offset:45056
    v_mfma_f32_16x16x32_bf16 v[80:83], v[132:135], a[192:195], v[80:83]
    v_mfma_f32_16x16x32_bf16 v[96:99], v[136:139], a[192:195], v[96:99]
    ds_read_b64_tr_b16 v[154:155], v161 offset:45568
    v_mfma_f32_16x16x32_bf16 v[100:103], v[136:139], a[196:199], v[100:103]
    ds_read_b64_tr_b16 v[156:157], v162 offset:45056
    v_mfma_f32_16x16x32_bf16 v[104:107], v[136:139], a[200:203], v[104:107]
    v_mfma_f32_16x16x32_bf16 v[108:111], v[136:139], a[204:207], v[108:111]
    ds_read_b64_tr_b16 v[158:159], v162 offset:45568
    v_mfma_f32_16x16x32_bf16 v[124:127], v[140:143], a[204:207], v[124:127]
    v_mfma_f32_16x16x32_bf16 v[120:123], v[140:143], a[200:203], v[120:123]
    buffer_load_dwordx4 v167, s[28:31], s56 offen offset:1024 lds
    v_mfma_f32_16x16x32_bf16 v[116:119], v[140:143], a[196:199], v[116:119]
    s_waitcnt vmcnt(13) lgkmcnt(0)
    v_mfma_f32_16x16x32_bf16 v[112:115], v[140:143], a[192:195], v[112:115]
    s_barrier
    v_mfma_f32_16x16x32_bf16 v[64:67], v[144:147], a[208:211], v[64:67]
    ds_read_b64_tr_b16 v[128:129], v161 offset:0
    v_mfma_f32_16x16x32_bf16 v[68:71], v[144:147], a[212:215], v[68:71]
    v_mfma_f32_16x16x32_bf16 v[72:75], v[144:147], a[216:219], v[72:75]
    ds_read_b64_tr_b16 v[130:131], v161 offset:512
    v_mfma_f32_16x16x32_bf16 v[76:79], v[144:147], a[220:223], v[76:79]
    ds_read_b64_tr_b16 v[132:133], v162 offset:0
    s_add_u32 m0, s59, 40960
    v_mfma_f32_16x16x32_bf16 v[92:95], v[148:151], a[220:223], v[92:95]
    buffer_load_dwordx4 v166, s[28:31], s57 offen offset:0 lds
    v_readlane_b32 s56, v177, 36
    v_mfma_f32_16x16x32_bf16 v[88:91], v[148:151], a[216:219], v[88:91]
    ds_read_b64_tr_b16 v[134:135], v162 offset:512
    v_mfma_f32_16x16x32_bf16 v[84:87], v[148:151], a[212:215], v[84:87]
    ds_read_b64_tr_b16 v[136:137], v161 offset:4096
    v_mfma_f32_16x16x32_bf16 v[80:83], v[148:151], a[208:211], v[80:83]
    v_mfma_f32_16x16x32_bf16 v[96:99], v[152:155], a[208:211], v[96:99]
    ds_read_b64_tr_b16 v[138:139], v161 offset:4608
    v_mfma_f32_16x16x32_bf16 v[100:103], v[152:155], a[212:215], v[100:103]
L_stub9:
    s_cbranch_execz L_stub0
    s_nop 0
    ds_read_b64_tr_b16 v[140:141], v162 offset:4096
    v_mfma_f32_16x16x32_bf16 v[104:107], v[152:155], a[216:219], v[104:107]
    v_mfma_f32_16x16x32_bf16 v[108:111], v[152:155], a[220:223], v[108:111]
    ds_read_b64_tr_b16 v[142:143], v162 offset:4608
    v_mfma_f32_16x16x32_bf16 v[124:127], v[156:159], a[220:223], v[124:127]
    v_mfma_f32_16x16x32_bf16 v[120:123], v[156:159], a[216:219], v[120:123]
    buffer_load_dwordx4 v167, s[28:31], s57 offen offset:1024 lds
    v_mfma_f32_16x16x32_bf16 v[116:119], v[156:159], a[212:215], v[116:119]
    s_waitcnt vmcnt(11) lgkmcnt(0)
    v_mfma_f32_16x16x32_bf16 v[112:115], v[156:159], a[208:211], v[112:115]
    s_barrier
    v_mfma_f32_16x16x32_bf16 v[64:67], v[128:131], a[224:227], v[64:67]
    ds_read_b64_tr_b16 v[144:145], v161 offset:8192
    v_mfma_f32_16x16x32_bf16 v[68:71], v[128:131], a[228:231], v[68:71]
    v_mfma_f32_16x16x32_bf16 v[72:75], v[128:131], a[232:235], v[72:75]
    ds_read_b64_tr_b16 v[146:147], v161 offset:8704
    v_mfma_f32_16x16x32_bf16 v[76:79], v[128:131], a[236:239], v[76:79]
    ds_read_b64_tr_b16 v[148:149], v162 offset:8192
    s_add_u32 m0, s59, 0
    v_mfma_f32_16x16x32_bf16 v[92:95], v[132:135], a[236:239], v[92:95]
    buffer_load_dwordx4 v166, s[28:31], s56 offen offset:0 lds
    v_readlane_b32 s57, v177, 37
    v_mfma_f32_16x16x32_bf16 v[88:91], v[132:135], a[232:235], v[88:91]
    ds_read_b64_tr_b16 v[150:151], v162 offset:8704
    v_mfma_f32_16x16x32_bf16 v[84:87], v[132:135], a[228:231], v[84:87]
    ds_read_b64_tr_b16 v[152:153], v161 offset:12288
    v_mfma_f32_16x16x32_bf16 v[80:83], v[132:135], a[224:227], v[80:83]
    v_mfma_f32_16x16x32_bf16 v[96:99], v[136:139], a[224:227], v[96:99]
    ds_read_b64_tr_b16 v[154:155], v161 offset:12800
    v_mfma_f32_16x16x32_bf16 v[100:103], v[136:139], a[228:231], v[100:103]
    ds_read_b64_tr_b16 v[156:157], v162 offset:12288
    v_mfma_f32_16x16x32_bf16 v[104:107], v[136:139], a[232:235], v[104:107]
    v_mfma_f32_16x16x32_bf16 v[108:111], v[136:139], a[236:239], v[108:111]
    ds_read_b64_tr_b16 v[158:159], v162 offset:12800
    v_mfma_f32_16x16x32_bf16 v[124:127], v[140:143], a[236:239], v[124:127]
    v_mfma_f32_16x16x32_bf16 v[120:123], v[140:143], a[232:235], v[120:123]
    buffer_load_dwordx4 v167, s[28:31], s56 offen offset:1024 lds
    v_mfma_f32_16x16x32_bf16 v[116:119], v[140:143], a[228:231], v[116:119]
    s_waitcnt vmcnt(9) lgkmcnt(0)
    v_mfma_f32_16x16x32_bf16 v[112:115], v[140:143], a[224:227], v[112:115]
    s_barrier
    v_mfma_f32_16x16x32_bf16 v[64:67], v[144:147], a[240:243], v[64:67]
    ds_read_b64_tr_b16 v[128:129], v163 offset:16384
    v_mfma_f32_16x16x32_bf16 v[68:71], v[144:147], a[244:247], v[68:71]
    v_mfma_f32_16x16x32_bf16 v[72:75], v[144:147], a[248:251], v[72:75]
    ds_read_b64_tr_b16 v[130:131], v163 offset:16640
    v_mfma_f32_16x16x32_bf16 v[76:79], v[144:147], a[252:255], v[76:79]
    ds_read_b64_tr_b16 v[132:133], v163 offset:18432
    s_add_u32 m0, s59, 8192
    v_mfma_f32_16x16x32_bf16 v[92:95], v[148:151], a[252:255], v[92:95]
    buffer_load_dwordx4 v166, s[28:31], s57 offen offset:0 lds
    v_readlane_b32 s56, v177, 38
    v_mfma_f32_16x16x32_bf16 v[88:91], v[148:151], a[248:251], v[88:91]
    ds_read_b64_tr_b16 v[134:135], v163 offset:18688
    v_mfma_f32_16x16x32_bf16 v[84:87], v[148:151], a[244:247], v[84:87]
    ds_read_b64_tr_b16 v[136:137], v163 offset:20480
    v_mfma_f32_16x16x32_bf16 v[80:83], v[148:151], a[240:243], v[80:83]
    v_mfma_f32_16x16x32_bf16 v[96:99], v[152:155], a[240:243], v[96:99]
    ds_read_b64_tr_b16 v[138:139], v163 offset:20736
    v_mfma_f32_16x16x32_bf16 v[100:103], v[152:155], a[244:247], v[100:103]
    ds_read_b64_tr_b16 v[140:141], v163 offset:22528
    v_mfma_f32_16x16x32_bf16 v[104:107], v[152:155], a[248:251], v[104:107]
    v_mfma_f32_16x16x32_bf16 v[108:111], v[152:155], a[252:255], v[108:111]
    ds_read_b64_tr_b16 v[142:143], v163 offset:22784
    v_mfma_f32_16x16x32_bf16 v[124:127], v[156:159], a[252:255], v[124:127]
    v_mfma_f32_16x16x32_bf16 v[120:123], v[156:159], a[248:251], v[120:123]
    buffer_load_dwordx4 v167, s[28:31], s57 offen offset:1024 lds
    v_mfma_f32_16x16x32_bf16 v[116:119], v[156:159], a[244:247], v[116:119]
    s_waitcnt vmcnt(9) lgkmcnt(0)
    v_mfma_f32_16x16x32_bf16 v[112:115], v[156:159], a[240:243], v[112:115]
    s_barrier
    v_mfma_f32_16x16x32_bf16 v[0:3], v[128:131], a[0:3], 0
    ds_read_b64_tr_b16 v[144:145], v163 offset:24576
    s_add_u32 s11, s63, 32768
    v_mul_f32 v184, v192, v64
    v_mul_f32 v185, v192, v65
    v_mfma_f32_16x16x32_bf16 v[4:7], v[128:131], a[4:7], 0
    v_mul_f32 v186, v192, v66
    v_mul_f32 v187, v192, v67
    v_mfma_f32_16x16x32_bf16 v[8:11], v[128:131], a[8:11], 0
    ds_read_b64_tr_b16 v[146:147], v163 offset:24832
    v_exp_f32 v184, v184
    v_mul_f32 v188, v192, v80
    v_mul_f32 v96, v64, v96
    v_mfma_f32_16x16x32_bf16 v[12:15], v[128:131], a[12:15], 0
    ds_read_b64_tr_b16 v[148:149], v163 offset:26624
    s_add_u32 m0, s59, 16384
    v_exp_f32 v185, v185
    v_mfma_f32_16x16x32_bf16 v[12:15], v[132:135], a[28:31], v[12:15]
    buffer_load_dwordx4 v166, s[28:31], s56 offen offset:0 lds
    v_readlane_b32 s57, v177, 39
    v_mfma_f32_16x16x32_bf16 v[8:11], v[132:135], a[24:27], v[8:11]
    ds_read_b64_tr_b16 v[150:151], v163 offset:26880
    v_mul_f32 v189, v192, v81
    v_mfma_f32_16x16x32_bf16 v[4:7], v[132:135], a[20:23], v[4:7]
    ds_read_b64_tr_b16 v[152:153], v163 offset:28672
    v_mul_f32 v97, v65, v97
    v_exp_f32 v186, v186
    v_mfma_f32_16x16x32_bf16 v[0:3], v[132:135], a[16:19], v[0:3]
    v_mul_f32 v190, v192, v82
    v_mul_f32 v98, v66, v98
    v_exp_f32 v187, v187
    v_mfma_f32_16x16x32_bf16 v[16:19], v[136:139], a[0:3], 0
    ds_read_b64_tr_b16 v[154:155], v163 offset:28928
    v_mul_f32 v191, v192, v83
    v_mul_f32 v99, v67, v99
    v_mfma_f32_16x16x32_bf16 v[20:23], v[136:139], a[4:7], 0
    ds_read_b64_tr_b16 v[156:157], v163 offset:30720
    v_exp_f32 v188, v188
    v_fma_f32 v184, v184, v193, v193
    v_mfma_f32_16x16x32_bf16 v[24:27], v[136:139], a[8:11], 0
    v_mul_f32 v112, v80, v112
    v_exp_f32 v189, v189
    v_fma_f32 v185, v185, v193, v193
    v_mfma_f32_16x16x32_bf16 v[28:31], v[136:139], a[12:15], 0
    ds_read_b64_tr_b16 v[158:159], v163 offset:30976
    v_mul_f32 v113, v81, v113
    v_exp_f32 v190, v190
    v_mfma_f32_16x16x32_bf16 v[28:31], v[140:143], a[28:31], v[28:31]
    v_fma_f32 v186, v186, v193, v193
    v_mul_f32 v114, v82, v114
    v_exp_f32 v191, v191
    v_mfma_f32_16x16x32_bf16 v[24:27], v[140:143], a[24:27], v[24:27]
    buffer_load_dwordx4 v167, s[28:31], s56 offen offset:1024 lds
    v_mfma_f32_16x16x32_bf16 v[20:23], v[140:143], a[20:23], v[20:23]
    v_fma_f32 v187, v187, v193, v193
    v_mul_f32 v115, v83, v115
    s_waitcnt vmcnt(8) lgkmcnt(0)
    v_mfma_f32_16x16x32_bf16 v[16:19], v[140:143], a[16:19], v[16:19]
    s_barrier
    v_mfma_f32_16x16x32_bf16 v[0:3], v[144:147], a[32:35], v[0:3]
    s_buffer_load_dwordx8 s[16:23], s[44:47], s66 offset:0 glc
    ds_read_b64_tr_b16 v[128:129], v163 offset:32768
    v_rcp_f32 v184, v184
    v_fma_f32 v188, v188, v193, v193
    v_mfma_f32_16x16x32_bf16 v[4:7], v[144:147], a[36:39], v[4:7]
    v_rcp_f32 v185, v185
    v_fma_f32 v189, v189, v193, v193
    v_mfma_f32_16x16x32_bf16 v[8:11], v[144:147], a[40:43], v[8:11]
    ds_read_b64_tr_b16 v[130:131], v163 offset:33024
    v_rcp_f32 v186, v186
    v_fma_f32 v190, v190, v193, v193
    v_mfma_f32_16x16x32_bf16 v[12:15], v[144:147], a[44:47], v[12:15]
    ds_read_b64_tr_b16 v[132:133], v163 offset:34816
    s_add_u32 m0, s59, 24576
    v_rcp_f32 v187, v187
    v_mfma_f32_16x16x32_bf16 v[12:15], v[148:151], a[60:63], v[12:15]
    buffer_load_dwordx4 v166, s[28:31], s57 offen offset:0 lds
    v_mfma_f32_16x16x32_bf16 v[8:11], v[148:151], a[56:59], v[8:11]
    ds_read_b64_tr_b16 v[134:135], v163 offset:35072
    v_fma_f32 v191, v191, v193, v193
    v_mfma_f32_16x16x32_bf16 v[4:7], v[148:151], a[52:55], v[4:7]
    ds_read_b64_tr_b16 v[136:137], v163 offset:36864
    v_rcp_f32 v188, v188
    v_mul_f32 v96, v96, v184
    v_mfma_f32_16x16x32_bf16 v[0:3], v[148:151], a[48:51], v[0:3]
    v_rcp_f32 v189, v189
    v_mul_f32 v97, v97, v185
    v_mfma_f32_16x16x32_bf16 v[16:19], v[152:155], a[32:35], v[16:19]
    ds_read_b64_tr_b16 v[138:139], v163 offset:37120
    v_rcp_f32 v190, v190
    v_mul_f32 v98, v98, v186
    v_mfma_f32_16x16x32_bf16 v[20:23], v[152:155], a[36:39], v[20:23]
    ds_read_b64_tr_b16 v[140:141], v163 offset:38912
    v_rcp_f32 v191, v191
    v_mul_f32 v99, v99, v187
    v_cvt_pk_bf16_f32 v64, v96, v97
    v_mfma_f32_16x16x32_bf16 v[24:27], v[152:155], a[40:43], v[24:27]
    v_cvt_pk_bf16_f32 v65, v98, v99
    v_mul_f32 v112, v112, v188
    v_mul_f32 v113, v113, v189
    v_mfma_f32_16x16x32_bf16 v[28:31], v[152:155], a[44:47], v[28:31]
    ds_read_b64_tr_b16 v[142:143], v163 offset:39168
    ds_read_b32 v170, v160
    v_mul_f32 v114, v114, v190
    v_mul_f32 v115, v115, v191
    v_cvt_pk_bf16_f32 v66, v112, v113
    v_mfma_f32_16x16x32_bf16 v[28:31], v[156:159], a[60:63], v[28:31]
    ds_read_b32 v170, v160
    v_cvt_pk_bf16_f32 v67, v114, v115
    v_mfma_f32_16x16x32_bf16 v[24:27], v[156:159], a[56:59], v[24:27]
    buffer_load_dwordx4 v167, s[28:31], s57 offen offset:1024 lds
    v_mfma_f32_16x16x32_bf16 v[20:23], v[156:159], a[52:55], v[20:23]
    buffer_store_dwordx4 v[64:67], v160, s[44:47], s11 offen offset:0 sc1
    v_mul_f32 v184, v194, v68
    s_waitcnt vmcnt(9) lgkmcnt(2)
    v_mfma_f32_16x16x32_bf16 v[16:19], v[156:159], a[48:51], v[16:19]
    s_barrier
    v_mfma_f32_16x16x32_bf16 v[0:3], v[128:131], a[64:67], v[0:3]
    ds_read_b64_tr_b16 v[144:145], v163 offset:40960
    v_mul_f32 v185, v194, v69
    v_mul_f32 v186, v194, v70
    v_mul_f32 v187, v194, v71
    v_mfma_f32_16x16x32_bf16 v[4:7], v[128:131], a[68:71], v[4:7]
    v_exp_f32 v184, v184
    v_mul_f32 v188, v194, v84
    v_mfma_f32_16x16x32_bf16 v[8:11], v[128:131], a[72:75], v[8:11]
    ds_read_b64_tr_b16 v[146:147], v163 offset:41216
    v_mul_f32 v100, v68, v100
    v_exp_f32 v185, v185
    v_mfma_f32_16x16x32_bf16 v[12:15], v[128:131], a[76:79], v[12:15]
    ds_read_b64_tr_b16 v[148:149], v163 offset:43008
    v_mul_f32 v189, v194, v85
    v_mul_f32 v101, v69, v101
    v_mfma_f32_16x16x32_bf16 v[12:15], v[132:135], a[92:95], v[12:15]
    buffer_load_dword v172, v179, s[36:39], s73 offen offset:384
    v_mfma_f32_16x16x32_bf16 v[8:11], v[132:135], a[88:91], v[8:11]
    ds_read_b64_tr_b16 v[150:151], v163 offset:43264
    v_exp_f32 v186, v186
    v_mul_f32 v190, v194, v86
    v_mfma_f32_16x16x32_bf16 v[4:7], v[132:135], a[84:87], v[4:7]
    ds_read_b64_tr_b16 v[152:153], v163 offset:45056
    v_mul_f32 v102, v70, v102
    v_mfma_f32_16x16x32_bf16 v[0:3], v[132:135], a[80:83], v[0:3]
    v_exp_f32 v187, v187
    v_mul_f32 v191, v194, v87
    v_mul_f32 v103, v71, v103
    v_mfma_f32_16x16x32_bf16 v[16:19], v[136:139], a[64:67], v[16:19]
    ds_read_b64_tr_b16 v[154:155], v163 offset:45312
    v_exp_f32 v188, v188
    v_fma_f32 v184, v184, v195, v195
    v_mfma_f32_16x16x32_bf16 v[20:23], v[136:139], a[68:71], v[20:23]
    ds_read_b64_tr_b16 v[156:157], v163 offset:47104
    v_mul_f32 v116, v84, v116
    v_exp_f32 v189, v189
    v_mfma_f32_16x16x32_bf16 v[24:27], v[136:139], a[72:75], v[24:27]
    v_fma_f32 v185, v185, v195, v195
    v_mul_f32 v117, v85, v117
    v_exp_f32 v190, v190
    v_mfma_f32_16x16x32_bf16 v[28:31], v[136:139], a[76:79], v[28:31]
    ds_read_b64_tr_b16 v[158:159], v163 offset:47360
    ds_read_b32 v170, v160
    v_fma_f32 v186, v186, v195, v195
    v_mul_f32 v118, v86, v118
    v_mfma_f32_16x16x32_bf16 v[28:31], v[140:143], a[92:95], v[28:31]
    ds_read_b32 v170, v160
    v_exp_f32 v191, v191
    v_fma_f32 v187, v187, v195, v195
    v_mul_f32 v119, v87, v119
    v_mfma_f32_16x16x32_bf16 v[24:27], v[140:143], a[88:91], v[24:27]
    buffer_load_dword v173, v179, s[40:43], s86 offen offset:384
    v_mfma_f32_16x16x32_bf16 v[20:23], v[140:143], a[84:87], v[20:23]
    v_rcp_f32 v184, v184
    s_waitcnt vmcnt(9) lgkmcnt(2)
    v_mfma_f32_16x16x32_bf16 v[16:19], v[140:143], a[80:83], v[16:19]
    s_barrier
    v_mfma_f32_16x16x32_bf16 v[0:3], v[144:147], a[96:99], v[0:3]
    s_waitcnt lgkmcnt(0)
    s_and_b64 s[16:17], s[16:17], s[20:21]
    s_and_b64 s[18:19], s[18:19], s[22:23]
    s_and_b64 s[16:17], s[16:17], s[18:19]
    s_and_b32 s16, s16, s17
    s_cmp_eq_u32 s16, 64
    s_cbranch_scc0 L_try8
L_ok8:
    ds_read_b64_tr_b16 v[128:129], v163 offset:0
    s_add_u32 s10, s71, 0
    v_fma_f32 v188, v188, v195, v195
    v_mfma_f32_16x16x32_bf16 v[4:7], v[144:147], a[100:103], v[4:7]
    buffer_load_dwordx4 a[0:3], v160, s[44:47], s10 offen offset:0 sc1
    v_mfma_f32_16x16x32_bf16 v[8:11], v[144:147], a[104:107], v[8:11]
    ds_read_b64_tr_b16 v[130:131], v163 offset:256
    v_rcp_f32 v185, v185
    v_fma_f32 v189, v189, v195, v195
    v_rcp_f32 v186, v186
    v_mfma_f32_16x16x32_bf16 v[12:15], v[144:147], a[108:111], v[12:15]
    ds_read_b64_tr_b16 v[132:133], v163 offset:2048
    v_fma_f32 v190, v190, v195, v195
    v_rcp_f32 v187, v187
    v_mfma_f32_16x16x32_bf16 v[12:15], v[148:151], a[124:127], v[12:15]
    v_fma_f32 v191, v191, v195, v195
    v_rcp_f32 v188, v188
    v_mul_f32 v100, v100, v184
    v_mfma_f32_16x16x32_bf16 v[8:11], v[148:151], a[120:123], v[8:11]
    ds_read_b64_tr_b16 v[134:135], v163 offset:2304
    v_rcp_f32 v189, v189
    v_mul_f32 v101, v101, v185
    v_mfma_f32_16x16x32_bf16 v[4:7], v[148:151], a[116:119], v[4:7]
    ds_read_b64_tr_b16 v[136:137], v163 offset:4096
    v_rcp_f32 v190, v190
    v_mul_f32 v102, v102, v186
    v_mfma_f32_16x16x32_bf16 v[0:3], v[148:151], a[112:115], v[0:3]
    buffer_load_dwordx4 a[4:7], v160, s[44:47], s10 offen offset:1024 sc1
    v_mfma_f32_16x16x32_bf16 v[16:19], v[152:155], a[96:99], v[16:19]
    ds_read_b64_tr_b16 v[138:139], v163 offset:4352
    v_rcp_f32 v191, v191
    v_mul_f32 v103, v103, v187
    v_cvt_pk_bf16_f32 v68, v100, v101
    v_mfma_f32_16x16x32_bf16 v[20:23], v[152:155], a[100:103], v[20:23]
    ds_read_b64_tr_b16 v[140:141], v163 offset:6144
    v_cvt_pk_bf16_f32 v69, v102, v103
    v_mul_f32 v116, v116, v188
    v_mul_f32 v117, v117, v189
    v_mfma_f32_16x16x32_bf16 v[24:27], v[152:155], a[104:107], v[24:27]
    v_mul_f32 v118, v118, v190
    v_mul_f32 v119, v119, v191
    v_cvt_pk_bf16_f32 v70, v116, v117
    v_cvt_pk_bf16_f32 v71, v118, v119
    v_mfma_f32_16x16x32_bf16 v[28:31], v[152:155], a[108:111], v[28:31]
    ds_read_b64_tr_b16 v[142:143], v163 offset:6400
    v_mfma_f32_16x16x32_bf16 v[28:31], v[156:159], a[124:127], v[28:31]
    buffer_load_dwordx4 a[8:11], v160, s[44:47], s10 offen offset:2048 sc1
    buffer_store_dwordx4 v[68:71], v160, s[44:47], s11 offen offset:1024 sc1
    v_mfma_f32_16x16x32_bf16 v[24:27], v[156:159], a[120:123], v[24:27]
    v_mul_f32 v184, v196, v72
    v_mul_f32 v185, v196, v73
    v_mul_f32 v186, v196, v74
    v_mfma_f32_16x16x32_bf16 v[20:23], v[156:159], a[116:119], v[20:23]
    buffer_load_dwordx4 a[12:15], v160, s[44:47], s10 offen offset:3072 sc1
    s_waitcnt vmcnt(12) lgkmcnt(0)
    v_mfma_f32_16x16x32_bf16 v[16:19], v[156:159], a[112:115], v[16:19]
    s_barrier
    v_mfma_f32_16x16x32_bf16 v[0:3], v[128:131], a[128:131], v[0:3]
    ds_read_b64_tr_b16 v[144:145], v163 offset:8192
    s_add_u32 s10, s71, 4096
    v_mul_f32 v187, v196, v75
    v_mfma_f32_16x16x32_bf16 v[4:7], v[128:131], a[132:135], v[4:7]
    buffer_load_dwordx4 a[16:19], v160, s[44:47], s10 offen offset:0 sc1
    v_mfma_f32_16x16x32_bf16 v[8:11], v[128:131], a[136:139], v[8:11]
    ds_read_b64_tr_b16 v[146:147], v163 offset:8448
    v_exp_f32 v184, v184
    v_mul_f32 v188, v196, v88
    v_mul_f32 v104, v72, v104
    v_mfma_f32_16x16x32_bf16 v[12:15], v[128:131], a[140:143], v[12:15]
    ds_read_b64_tr_b16 v[148:149], v163 offset:10240
    v_exp_f32 v185, v185
    v_mul_f32 v189, v196, v89
    v_mul_f32 v105, v73, v105
    v_mfma_f32_16x16x32_bf16 v[12:15], v[132:135], a[156:159], v[12:15]
    v_exp_f32 v186, v186
    v_mul_f32 v190, v196, v90
    v_mul_f32 v106, v74, v106
    v_mfma_f32_16x16x32_bf16 v[8:11], v[132:135], a[152:155], v[8:11]
    ds_read_b64_tr_b16 v[150:151], v163 offset:10496
    v_exp_f32 v187, v187
    v_mul_f32 v191, v196, v91
    v_mfma_f32_16x16x32_bf16 v[4:7], v[132:135], a[148:151], v[4:7]
    ds_read_b64_tr_b16 v[152:153], v163 offset:12288
    v_mul_f32 v107, v75, v107
    v_exp_f32 v188, v188
    v_mfma_f32_16x16x32_bf16 v[0:3], v[132:135], a[144:147], v[0:3]
    buffer_load_dwordx4 a[20:23], v160, s[44:47], s10 offen offset:1024 sc1
    v_mfma_f32_16x16x32_bf16 v[16:19], v[136:139], a[128:131], v[16:19]
    ds_read_b64_tr_b16 v[154:155], v163 offset:12544
    v_fma_f32 v184, v184, v197, v197
    v_mul_f32 v120, v88, v120
    v_mfma_f32_16x16x32_bf16 v[20:23], v[136:139], a[132:135], v[20:23]
    ds_read_b64_tr_b16 v[156:157], v163 offset:14336
    v_exp_f32 v189, v189
    v_fma_f32 v185, v185, v197, v197
    v_mul_f32 v121, v89, v121
    v_mfma_f32_16x16x32_bf16 v[24:27], v[136:139], a[136:139], v[24:27]
    v_exp_f32 v190, v190
    v_fma_f32 v186, v186, v197, v197
    v_mul_f32 v122, v90, v122
    v_mfma_f32_16x16x32_bf16 v[28:31], v[136:139], a[140:143], v[28:31]
    ds_read_b64_tr_b16 v[158:159], v163 offset:14592
    v_exp_f32 v191, v191
    v_fma_f32 v187, v187, v197, v197
    v_mul_f32 v123, v91, v123
    v_mfma_f32_16x16x32_bf16 v[28:31], v[140:143], a[156:159], v[28:31]
    buffer_load_dwordx4 a[24:27], v160, s[44:47], s10 offen offset:2048 sc1
    v_mfma_f32_16x16x32_bf16 v[24:27], v[140:143], a[152:155], v[24:27]
    v_rcp_f32 v184, v184
    v_fma_f32 v188, v188, v197, v197
    v_mfma_f32_16x16x32_bf16 v[20:23], v[140:143], a[148:151], v[20:23]
    buffer_load_dwordx4 a[28:31], v160, s[44:47], s10 offen offset:3072 sc1
    s_waitcnt vmcnt(14) lgkmcnt(0)
    v_mfma_f32_16x16x32_bf16 v[16:19], v[140:143], a[144:147], v[16:19]
    s_barrier
    v_mfma_f32_16x16x32_bf16 v[0:3], v[144:147], a[160:163], v[0:3]
    ds_read_b64_tr_b16 v[128:129], v163 offset:16384
    s_add_u32 s10, s71, 8192
    v_rcp_f32 v185, v185
    v_mfma_f32_16x16x32_bf16 v[4:7], v[144:147], a[164:167], v[4:7]
    buffer_load_dwordx4 a[32:35], v160, s[44:47], s10 offen offset:0 sc1
    v_mfma_f32_16x16x32_bf16 v[8:11], v[144:147], a[168:171], v[8:11]
    ds_read_b64_tr_b16 v[130:131], v163 offset:16640
    v_fma_f32 v189, v189, v197, v197
    v_rcp_f32 v186, v186
    v_fma_f32 v190, v190, v197, v197
    v_mfma_f32_16x16x32_bf16 v[12:15], v[144:147], a[172:175], v[12:15]
    ds_read_b64_tr_b16 v[132:133], v163 offset:18432
    v_rcp_f32 v187, v187
    v_fma_f32 v191, v191, v197, v197
    v_mfma_f32_16x16x32_bf16 v[12:15], v[148:151], a[188:191], v[12:15]
    v_rcp_f32 v188, v188
    v_mul_f32 v104, v104, v184
    v_mfma_f32_16x16x32_bf16 v[8:11], v[148:151], a[184:187], v[8:11]
    ds_read_b64_tr_b16 v[134:135], v163 offset:18688
    v_rcp_f32 v189, v189
    v_mul_f32 v105, v105, v185
    v_mfma_f32_16x16x32_bf16 v[4:7], v[148:151], a[180:183], v[4:7]
    ds_read_b64_tr_b16 v[136:137], v163 offset:20480
    v_rcp_f32 v190, v190
    v_mul_f32 v106, v106, v186
    v_mfma_f32_16x16x32_bf16 v[0:3], v[148:151], a[176:179], v[0:3]
    buffer_load_dwordx4 a[36:39], v160, s[44:47], s10 offen offset:1024 sc1
    v_rcp_f32 v191, v191
    v_mfma_f32_16x16x32_bf16 v[16:19], v[152:155], a[160:163], v[16:19]
    ds_read_b64_tr_b16 v[138:139], v163 offset:20736
    v_mul_f32 v107, v107, v187
    v_cvt_pk_bf16_f32 v72, v104, v105
    v_cvt_pk_bf16_f32 v73, v106, v107
    v_mfma_f32_16x16x32_bf16 v[20:23], v[152:155], a[164:167], v[20:23]
    ds_read_b64_tr_b16 v[140:141], v163 offset:22528
    v_mul_f32 v120, v120, v188
    v_mul_f32 v121, v121, v189
    v_mul_f32 v122, v122, v190
    v_mfma_f32_16x16x32_bf16 v[24:27], v[152:155], a[168:171], v[24:27]
    v_mul_f32 v123, v123, v191
    v_cvt_pk_bf16_f32 v74, v120, v121
    v_cvt_pk_bf16_f32 v75, v122, v123
    v_mfma_f32_16x16x32_bf16 v[28:31], v[152:155], a[172:175], v[28:31]
    ds_read_b64_tr_b16 v[142:143], v163 offset:22784
    buffer_store_dwordx4 v[72:75], v160, s[44:47], s11 offen offset:2048 sc1
    v_mfma_f32_16x16x32_bf16 v[28:31], v[156:159], a[188:191], v[28:31]
    buffer_load_dwordx4 a[40:43], v160, s[44:47], s10 offen offset:2048 sc1
    v_mul_f32 v184, v198, v76
    v_mfma_f32_16x16x32_bf16 v[24:27], v[156:159], a[184:187], v[24:27]
    v_mul_f32 v185, v198, v77
    v_mul_f32 v186, v198, v78
    v_mul_f32 v187, v198, v79
    v_mfma_f32_16x16x32_bf16 v[20:23], v[156:159], a[180:183], v[20:23]
    buffer_load_dwordx4 a[44:47], v160, s[44:47], s10 offen offset:3072 sc1
    s_waitcnt vmcnt(17) lgkmcnt(0)
    v_mfma_f32_16x16x32_bf16 v[16:19], v[156:159], a[176:179], v[16:19]
    s_barrier
    v_mfma_f32_16x16x32_bf16 v[0:3], v[128:131], a[192:195], v[0:3]
    ds_read_b64_tr_b16 v[144:145], v163 offset:24576
    s_add_u32 s10, s71, 12288
    v_exp_f32 v184, v184
    v_mfma_f32_16x16x32_bf16 v[4:7], v[128:131], a[196:199], v[4:7]
    buffer_load_dwordx4 a[48:51], v160, s[44:47], s10 offen offset:0 sc1
    v_mfma_f32_16x16x32_bf16 v[8:11], v[128:131], a[200:203], v[8:11]
    ds_read_b64_tr_b16 v[146:147], v163 offset:24832
    v_mul_f32 v188, v198, v92
    v_mul_f32 v108, v76, v108
    v_exp_f32 v185, v185
    v_mfma_f32_16x16x32_bf16 v[12:15], v[128:131], a[204:207], v[12:15]
    ds_read_b64_tr_b16 v[148:149], v163 offset:26624
    v_mul_f32 v189, v198, v93
    v_mul_f32 v109, v77, v109
    v_mfma_f32_16x16x32_bf16 v[12:15], v[132:135], a[220:223], v[12:15]
    v_exp_f32 v186, v186
    v_mul_f32 v190, v198, v94
    v_mul_f32 v110, v78, v110
    v_mfma_f32_16x16x32_bf16 v[8:11], v[132:135], a[216:219], v[8:11]
    ds_read_b64_tr_b16 v[150:151], v163 offset:26880
    v_exp_f32 v187, v187
    v_mul_f32 v191, v198, v95
    v_mul_f32 v111, v79, v111
    v_mfma_f32_16x16x32_bf16 v[4:7], v[132:135], a[212:215], v[4:7]
    ds_read_b64_tr_b16 v[152:153], v163 offset:28672
    v_exp_f32 v188, v188
    v_fma_f32 v184, v184, v199, v199
    v_mfma_f32_16x16x32_bf16 v[0:3], v[132:135], a[208:211], v[0:3]
    buffer_load_dwordx4 a[52:55], v160, s[44:47], s10 offen offset:1024 sc1
    v_mul_f32 v124, v92, v124
    v_mfma_f32_16x16x32_bf16 v[16:19], v[136:139], a[192:195], v[16:19]
    ds_read_b64_tr_b16 v[154:155], v163 offset:28928
    v_exp_f32 v189, v189
    v_fma_f32 v185, v185, v199, v199
    v_mfma_f32_16x16x32_bf16 v[20:23], v[136:139], a[196:199], v[20:23]
    ds_read_b64_tr_b16 v[156:157], v163 offset:30720
    v_mul_f32 v125, v93, v125
    v_exp_f32 v190, v190
    v_mfma_f32_16x16x32_bf16 v[24:27], v[136:139], a[200:203], v[24:27]
    v_fma_f32 v186, v186, v199, v199
    v_mul_f32 v126, v94, v126
    v_exp_f32 v191, v191
    v_mfma_f32_16x16x32_bf16 v[28:31], v[136:139], a[204:207], v[28:31]
    ds_read_b64_tr_b16 v[158:159], v163 offset:30976
    v_fma_f32 v187, v187, v199, v199
    v_mul_f32 v127, v95, v127
    v_mfma_f32_16x16x32_bf16 v[28:31], v[140:143], a[220:223], v[28:31]
    buffer_load_dwordx4 a[56:59], v160, s[44:47], s10 offen offset:2048 sc1
    v_rcp_f32 v184, v184
    v_mfma_f32_16x16x32_bf16 v[24:27], v[140:143], a[216:219], v[24:27]
    v_fma_f32 v188, v188, v199, v199
    v_rcp_f32 v185, v185
    v_mfma_f32_16x16x32_bf16 v[20:23], v[140:143], a[212:215], v[20:23]
    buffer_load_dwordx4 a[60:63], v160, s[44:47], s10 offen offset:3072 sc1
    s_waitcnt lgkmcnt(0)
    v_mfma_f32_16x16x32_bf16 v[16:19], v[140:143], a[208:211], v[16:19]
    s_barrier
    v_mfma_f32_16x16x32_bf16 v[0:3], v[144:147], a[224:227], v[0:3]
    v_fma_f32 v189, v189, v199, v199
    v_rcp_f32 v186, v186
    v_mfma_f32_16x16x32_bf16 v[4:7], v[144:147], a[228:231], v[4:7]
    s_add_u32 s10, s71, 16384
    v_fma_f32 v190, v190, v199, v199
    v_mfma_f32_16x16x32_bf16 v[8:11], v[144:147], a[232:235], v[8:11]
    buffer_load_dwordx4 a[64:67], v160, s[44:47], s10 offen offset:0 sc1
    v_mfma_f32_16x16x32_bf16 v[12:15], v[144:147], a[236:239], v[12:15]
    v_rcp_f32 v187, v187
    v_fma_f32 v191, v191, v199, v199
    v_mfma_f32_16x16x32_bf16 v[12:15], v[148:151], a[252:255], v[12:15]
    v_rcp_f32 v188, v188
    v_mul_f32 v108, v108, v184
    v_mfma_f32_16x16x32_bf16 v[8:11], v[148:151], a[248:251], v[8:11]
    v_rcp_f32 v189, v189
    v_mul_f32 v109, v109, v185
    v_mfma_f32_16x16x32_bf16 v[4:7], v[148:151], a[244:247], v[4:7]
    buffer_load_dwordx4 a[68:71], v160, s[44:47], s10 offen offset:1024 sc1
    v_mfma_f32_16x16x32_bf16 v[0:3], v[148:151], a[240:243], v[0:3]
    v_rcp_f32 v190, v190
    v_mul_f32 v110, v110, v186
    v_mfma_f32_16x16x32_bf16 v[16:19], v[152:155], a[224:227], v[16:19]
    v_rcp_f32 v191, v191
    v_mul_f32 v111, v111, v187
    v_mfma_f32_16x16x32_bf16 v[20:23], v[152:155], a[228:231], v[20:23]
    v_cvt_pk_bf16_f32 v76, v108, v109
    v_cvt_pk_bf16_f32 v77, v110, v111
    v_mul_f32 v124, v124, v188
    v_mfma_f32_16x16x32_bf16 v[24:27], v[152:155], a[232:235], v[24:27]
    buffer_load_dwordx4 a[72:75], v160, s[44:47], s10 offen offset:2048 sc1
    v_mfma_f32_16x16x32_bf16 v[28:31], v[152:155], a[236:239], v[28:31]
    v_mul_f32 v125, v125, v189
    v_mul_f32 v126, v126, v190
    v_mfma_f32_16x16x32_bf16 v[28:31], v[156:159], a[252:255], v[28:31]
    v_mul_f32 v127, v127, v191
    v_cvt_pk_bf16_f32 v78, v124, v125
    v_cvt_pk_bf16_f32 v79, v126, v127
    v_mfma_f32_16x16x32_bf16 v[24:27], v[156:159], a[248:251], v[24:27]
    v_mfma_f32_16x16x32_bf16 v[20:23], v[156:159], a[244:247], v[20:23]
    buffer_load_dwordx4 a[76:79], v160, s[44:47], s10 offen offset:3072 sc1
    s_waitcnt vmcnt(17)
    v_mfma_f32_16x16x32_bf16 v[16:19], v[156:159], a[240:243], v[16:19]
    buffer_store_dwordx4 v[76:79], v160, s[44:47], s11 offen offset:3072 sc1
    v_mfma_f32_16x16x32_bf16 a[192:195], v[208:211], a[0:3], 0
    s_add_u32 s10, s71, 20480
    v_mul_f32 v184, v192, v0
    v_mul_f32 v185, v192, v1
    v_mul_f32 v186, v192, v2
    v_mul_f32 v187, v192, v3
    v_exp_f32 v184, v184
    v_mul_f32 v188, v194, v4
    v_mul_f32 v16, v0, v16
    v_mfma_f32_16x16x32_bf16 a[196:199], v[208:211], a[4:7], 0
    buffer_load_dwordx4 a[80:83], v160, s[44:47], s10 offen offset:0 sc1
    v_exp_f32 v185, v185
    v_mul_f32 v189, v194, v5
    v_mul_f32 v17, v1, v17
    v_exp_f32 v186, v186
    v_mfma_f32_16x16x32_bf16 a[200:203], v[208:211], a[8:11], 0
    v_mul_f32 v190, v194, v6
    v_mul_f32 v18, v2, v18
    v_exp_f32 v187, v187
    v_mul_f32 v191, v194, v7
    v_mul_f32 v19, v3, v19
    v_exp_f32 v188, v188
    v_fma_f32 v184, v184, v193, v193
    v_mul_f32 v20, v4, v20
    v_mfma_f32_16x16x32_bf16 a[204:207], v[208:211], a[12:15], 0
    buffer_load_dwordx4 a[84:87], v160, s[44:47], s10 offen offset:1024 sc1
    v_exp_f32 v189, v189
    v_fma_f32 v185, v185, v193, v193
    v_mul_f32 v21, v5, v21
    v_exp_f32 v190, v190
    v_mfma_f32_16x16x32_bf16 a[220:223], v[212:215], a[12:15], 0
    v_fma_f32 v186, v186, v193, v193
    v_mul_f32 v22, v6, v22
    v_exp_f32 v191, v191
    v_fma_f32 v187, v187, v193, v193
    v_mul_f32 v23, v7, v23
    v_rcp_f32 v184, v184
    v_fma_f32 v188, v188, v195, v195
    v_mfma_f32_16x16x32_bf16 a[216:219], v[212:215], a[8:11], 0
    buffer_load_dwordx4 a[88:91], v160, s[44:47], s10 offen offset:2048 sc1
    v_rcp_f32 v185, v185
    v_fma_f32 v189, v189, v195, v195
    v_rcp_f32 v186, v186
    v_fma_f32 v190, v190, v195, v195
    v_mfma_f32_16x16x32_bf16 a[212:215], v[212:215], a[4:7], 0
    v_rcp_f32 v187, v187
    v_fma_f32 v191, v191, v195, v195
    v_rcp_f32 v188, v188
    v_mul_f32 v16, v16, v184
    v_rcp_f32 v189, v189
    v_mul_f32 v17, v17, v185
    v_mfma_f32_16x16x32_bf16 a[208:211], v[212:215], a[0:3], 0
    buffer_load_dwordx4 a[92:95], v160, s[44:47], s10 offen offset:3072 sc1
    v_rcp_f32 v190, v190
    v_mul_f32 v18, v18, v186
    v_rcp_f32 v191, v191
    v_mul_f32 v19, v19, v187
    v_cvt_pk_bf16_f32 v32, v16, v17
    v_mfma_f32_16x16x32_bf16 a[224:227], v[216:219], a[0:3], 0
    s_add_u32 s10, s71, 24576
    v_cvt_pk_bf16_f32 v33, v18, v19
    v_mul_f32 v20, v20, v188
    v_mul_f32 v21, v21, v189
    v_mul_f32 v22, v22, v190
    v_mul_f32 v23, v23, v191
    v_cvt_pk_bf16_f32 v34, v20, v21
    v_cvt_pk_bf16_f32 v35, v22, v23
    s_nop 0
    v_permlane32_swap_b32 v32, v34
    v_mfma_f32_16x16x32_bf16 a[228:231], v[216:219], a[4:7], 0
    buffer_load_dwordx4 a[96:99], v160, s[44:47], s10 offen offset:0 sc1
    v_permlane32_swap_b32 v33, v35
    buffer_store_dwordx4 v[32:35], v178, s[44:47], s64 offen offset:0 sc1
    v_mfma_f32_16x16x32_bf16 a[232:235], v[216:219], a[8:11], 0
    s_waitcnt vmcnt(6)
    buffer_store_dword v169, v169, s[44:47], s65 offen offset:128 sc1
    v_mul_f32 v184, v196, v8
    v_mul_f32 v185, v196, v9
    v_mul_f32 v186, v196, v10
    v_mul_f32 v187, v196, v11
    v_exp_f32 v184, v184
    v_mul_f32 v188, v198, v12
    v_mfma_f32_16x16x32_bf16 a[236:239], v[216:219], a[12:15], 0
    buffer_load_dwordx4 a[100:103], v160, s[44:47], s10 offen offset:1024 sc1
    v_mul_f32 v24, v8, v24
    v_exp_f32 v185, v185
    v_mul_f32 v189, v198, v13
    v_mul_f32 v25, v9, v25
    v_mfma_f32_16x16x32_bf16 a[252:255], v[220:223], a[12:15], 0
    v_exp_f32 v186, v186
    v_mul_f32 v190, v198, v14
    v_mul_f32 v26, v10, v26
    v_exp_f32 v187, v187
    v_mul_f32 v191, v198, v15
    v_mul_f32 v27, v11, v27
    v_exp_f32 v188, v188
    v_mfma_f32_16x16x32_bf16 a[248:251], v[220:223], a[8:11], 0
    buffer_load_dwordx4 a[104:107], v160, s[44:47], s10 offen offset:2048 sc1
    v_fma_f32 v184, v184, v197, v197
    v_mul_f32 v28, v12, v28
    v_exp_f32 v189, v189
    v_fma_f32 v185, v185, v197, v197
    v_mul_f32 v29, v13, v29
    v_mfma_f32_16x16x32_bf16 a[244:247], v[220:223], a[4:7], 0
    v_exp_f32 v190, v190
    v_fma_f32 v186, v186, v197, v197
    v_mul_f32 v30, v14, v30
    v_exp_f32 v191, v191
    v_fma_f32 v187, v187, v197, v197
    v_mul_f32 v31, v15, v31
    v_mfma_f32_16x16x32_bf16 a[240:243], v[220:223], a[0:3], 0
L_stub10:
    s_cbranch_execz L_tourret
    s_nop 0
    buffer_load_dwordx4 a[108:111], v160, s[44:47], s10 offen offset:3072 sc1
    v_rcp_f32 v184, v184
    v_fma_f32 v188, v188, v199, v199
    v_rcp_f32 v185, v185
    v_fma_f32 v189, v189, v199, v199
    v_mfma_f32_16x16x32_bf16 a[192:195], v[224:227], a[16:19], a[192:195]
    s_add_u32 s10, s71, 28672
    v_rcp_f32 v186, v186
    v_fma_f32 v190, v190, v199, v199
    v_mfma_f32_16x16x32_bf16 a[196:199], v[224:227], a[20:23], a[196:199]
    buffer_load_dwordx4 a[112:115], v160, s[44:47], s10 offen offset:0 sc1
    v_mfma_f32_16x16x32_bf16 a[200:203], v[224:227], a[24:27], a[200:203]
    v_rcp_f32 v187, v187
    v_fma_f32 v191, v191, v199, v199
    v_rcp_f32 v188, v188
    v_mul_f32 v24, v24, v184
    v_mfma_f32_16x16x32_bf16 a[204:207], v[224:227], a[28:31], a[204:207]
    buffer_load_dwordx4 a[116:119], v160, s[44:47], s10 offen offset:1024 sc1
    v_mfma_f32_16x16x32_bf16 a[220:223], v[228:231], a[28:31], a[220:223]
    v_rcp_f32 v189, v189
    v_mul_f32 v25, v25, v185
    v_rcp_f32 v190, v190
    v_mfma_f32_16x16x32_bf16 a[216:219], v[228:231], a[24:27], a[216:219]
    buffer_load_dwordx4 a[120:123], v160, s[44:47], s10 offen offset:2048 sc1
    v_mul_f32 v26, v26, v186
    v_mfma_f32_16x16x32_bf16 a[212:215], v[228:231], a[20:23], a[212:215]
    v_rcp_f32 v191, v191
    v_mul_f32 v27, v27, v187
    v_cvt_pk_bf16_f32 v36, v24, v25
    v_mfma_f32_16x16x32_bf16 a[208:211], v[228:231], a[16:19], a[208:211]
    buffer_load_dwordx4 a[124:127], v160, s[44:47], s10 offen offset:3072 sc1
    v_cvt_pk_bf16_f32 v37, v26, v27
    v_mfma_f32_16x16x32_bf16 a[224:227], v[232:235], a[16:19], a[224:227]
    s_add_u32 m0, s60, 32768
    s_add_u32 s9, s61, 327680
    v_mul_f32 v28, v28, v188
    v_mul_f32 v29, v29, v189
    v_mul_f32 v30, v30, v190
    v_mfma_f32_16x16x32_bf16 a[228:231], v[232:235], a[20:23], a[228:231]
    buffer_load_dwordx4 v168, s[36:39], s9 offen lds
    v_mfma_f32_16x16x32_bf16 a[232:235], v[232:235], a[24:27], a[232:235]
    s_add_u32 m0, s60, 33792
    s_add_u32 s9, s61, 335872
    v_mul_f32 v31, v31, v191
    v_cvt_pk_bf16_f32 v38, v28, v29
    v_cvt_pk_bf16_f32 v39, v30, v31
    v_mfma_f32_16x16x32_bf16 a[236:239], v[232:235], a[28:31], a[236:239]
    buffer_load_dwordx4 v168, s[36:39], s9 offen lds
    v_permlane32_swap_b32 v36, v38
    v_mfma_f32_16x16x32_bf16 a[252:255], v[236:239], a[28:31], a[252:255]
    s_add_u32 m0, s60, 34816
    s_add_u32 s9, s61, 344064
    v_permlane32_swap_b32 v37, v39
    v_mfma_f32_16x16x32_bf16 a[248:251], v[236:239], a[24:27], a[248:251]
    buffer_load_dwordx4 v168, s[36:39], s9 offen lds
    v_mfma_f32_16x16x32_bf16 a[244:247], v[236:239], a[20:23], a[244:247]
    s_add_u32 m0, s60, 35840
    s_add_u32 s9, s61, 352256
    buffer_store_dwordx4 v[36:39], v178, s[44:47], s64 offen offset:2048 sc1
    v_mfma_f32_16x16x32_bf16 a[240:243], v[236:239], a[16:19], a[240:243]
    buffer_load_dwordx4 v168, s[36:39], s9 offen lds
    v_mfma_f32_16x16x32_bf16 a[192:195], v[240:243], a[32:35], a[192:195]
    ds_read_b64_tr_b16 v[144:145], v180 offset:49152
    s_add_u32 m0, s60, 0
    s_add_u32 s9, s61, 360448
    v_mfma_f32_16x16x32_bf16 a[196:199], v[240:243], a[36:39], a[196:199]
    buffer_load_dwordx4 v168, s[36:39], s9 offen lds
    v_mfma_f32_16x16x32_bf16 a[200:203], v[240:243], a[40:43], a[200:203]
    ds_read_b64_tr_b16 v[146:147], v180 offset:51200
    v_mfma_f32_16x16x32_bf16 a[204:207], v[240:243], a[44:47], a[204:207]
    ds_read_b64_tr_b16 v[148:149], v181 offset:49152
    s_add_u32 m0, s60, 1024
    s_add_u32 s9, s61, 368640
    v_mfma_f32_16x16x32_bf16 a[220:223], v[244:247], a[44:47], a[220:223]
    buffer_load_dwordx4 v168, s[36:39], s9 offen lds
    v_mfma_f32_16x16x32_bf16 a[216:219], v[244:247], a[40:43], a[216:219]
    ds_read_b64_tr_b16 v[150:151], v181 offset:51200
    v_mfma_f32_16x16x32_bf16 a[212:215], v[244:247], a[36:39], a[212:215]
    ds_read_b64_tr_b16 v[152:153], v182 offset:49152
    s_add_u32 m0, s60, 2048
    s_add_u32 s9, s61, 376832
    v_mfma_f32_16x16x32_bf16 a[208:211], v[244:247], a[32:35], a[208:211]
    buffer_load_dwordx4 v168, s[36:39], s9 offen lds
    v_mfma_f32_16x16x32_bf16 a[224:227], v[248:251], a[32:35], a[224:227]
    ds_read_b64_tr_b16 v[154:155], v182 offset:51200
    v_mfma_f32_16x16x32_bf16 a[228:231], v[248:251], a[36:39], a[228:231]
    ds_read_b64_tr_b16 v[156:157], v183 offset:49152
    s_add_u32 m0, s60, 3072
    s_add_u32 s9, s61, 385024
    v_mfma_f32_16x16x32_bf16 a[232:235], v[248:251], a[40:43], a[232:235]
    buffer_load_dwordx4 v168, s[36:39], s9 offen lds
    v_mfma_f32_16x16x32_bf16 a[236:239], v[248:251], a[44:47], a[236:239]
    ds_read_b64_tr_b16 v[158:159], v183 offset:51200
    s_add_u32 m0, s60, 16384
    s_add_u32 s9, s61, 393216
    v_mfma_f32_16x16x32_bf16 a[252:255], v[252:255], a[44:47], a[252:255]
    buffer_load_dwordx4 v168, s[36:39], s9 offen lds
    s_add_u32 m0, s60, 17408
    s_add_u32 s9, s61, 409600
    v_mfma_f32_16x16x32_bf16 a[248:251], v[252:255], a[40:43], a[248:251]
    buffer_load_dwordx4 v168, s[36:39], s9 offen lds
    s_add_u32 m0, s60, 18432
    s_add_u32 s9, s61, 401408
    v_mfma_f32_16x16x32_bf16 a[244:247], v[252:255], a[36:39], a[244:247]
    buffer_load_dwordx4 v168, s[36:39], s9 offen lds
    s_add_u32 m0, s60, 19456
    s_add_u32 s9, s61, 417792
    s_waitcnt lgkmcnt(0)
    v_mfma_f32_16x16x32_bf16 a[240:243], v[252:255], a[32:35], a[240:243]
    buffer_load_dwordx4 v168, s[36:39], s9 offen lds
    v_mfma_f32_16x16x32_bf16 a[192:195], v[144:147], a[48:51], a[192:195]
    s_buffer_load_dwordx4 s[16:19], s[44:47], s66 offset:144 glc
    v_add_u32 v180, 0xc000, v180
    ds_read_b64_tr_b16 v[128:129], v180 offset:16384
    v_mfma_f32_16x16x32_bf16 a[196:199], v[144:147], a[52:55], a[196:199]
    v_mfma_f32_16x16x32_bf16 a[200:203], v[144:147], a[56:59], a[200:203]
    ds_read_b64_tr_b16 v[130:131], v180 offset:18432
    v_mfma_f32_16x16x32_bf16 a[204:207], v[144:147], a[60:63], a[204:207]
    v_add_u32 v181, 0xc000, v181
    ds_read_b64_tr_b16 v[132:133], v181 offset:16384
    s_add_u32 m0, s60, 98304
    s_add_u32 s9, s61, 425984
    v_mfma_f32_16x16x32_bf16 a[220:223], v[148:151], a[60:63], a[220:223]
    buffer_load_dwordx4 v168, s[36:39], s9 offen lds
    v_mfma_f32_16x16x32_bf16 a[216:219], v[148:151], a[56:59], a[216:219]
    ds_read_b64_tr_b16 v[134:135], v181 offset:18432
    v_mfma_f32_16x16x32_bf16 a[212:215], v[148:151], a[52:55], a[212:215]
    v_add_u32 v182, 0xc000, v182
    ds_read_b64_tr_b16 v[136:137], v182 offset:16384
    v_mfma_f32_16x16x32_bf16 a[208:211], v[148:151], a[48:51], a[208:211]
    v_mfma_f32_16x16x32_bf16 a[224:227], v[152:155], a[48:51], a[224:227]
    ds_read_b64_tr_b16 v[138:139], v182 offset:18432
    v_mfma_f32_16x16x32_bf16 a[228:231], v[152:155], a[52:55], a[228:231]
    v_add_u32 v183, 0xc000, v183
    ds_read_b64_tr_b16 v[140:141], v183 offset:16384
    s_add_u32 m0, s60, 99328
    s_add_u32 s9, s61, 442368
    v_mfma_f32_16x16x32_bf16 a[232:235], v[152:155], a[56:59], a[232:235]
    buffer_load_dwordx4 v168, s[36:39], s9 offen lds
    v_mfma_f32_16x16x32_bf16 a[236:239], v[152:155], a[60:63], a[236:239]
    ds_read_b64_tr_b16 v[142:143], v183 offset:18432
    ds_read_b32 v170, v160
    v_mfma_f32_16x16x32_bf16 a[252:255], v[156:159], a[60:63], a[252:255]
    ds_read_b32 v170, v160
    s_add_u32 m0, s60, 100352
    s_add_u32 s9, s61, 434176
    v_mfma_f32_16x16x32_bf16 a[248:251], v[156:159], a[56:59], a[248:251]
    buffer_load_dwordx4 v168, s[36:39], s9 offen lds
    v_mfma_f32_16x16x32_bf16 a[244:247], v[156:159], a[52:55], a[244:247]
    s_add_u32 m0, s60, 101376
    s_add_u32 s9, s61, 450560
    s_waitcnt lgkmcnt(2)
    v_mfma_f32_16x16x32_bf16 a[240:243], v[156:159], a[48:51], a[240:243]
    buffer_load_dwordx4 v168, s[36:39], s9 offen lds
    v_mfma_f32_16x16x32_bf16 a[192:195], v[128:131], a[64:67], a[192:195]
    ds_read_b64_tr_b16 v[144:145], v180 offset:32768
    v_mfma_f32_16x16x32_bf16 a[196:199], v[128:131], a[68:71], a[196:199]
    s_waitcnt vmcnt(13)
    buffer_store_dword v169, v169, s[44:47], s65 offen offset:512 sc1
    v_mfma_f32_16x16x32_bf16 a[200:203], v[128:131], a[72:75], a[200:203]
    ds_read_b64_tr_b16 v[146:147], v180 offset:34816
    v_mfma_f32_16x16x32_bf16 a[204:207], v[128:131], a[76:79], a[204:207]
    ds_read_b64_tr_b16 v[148:149], v181 offset:32768
    v_mfma_f32_16x16x32_bf16 a[220:223], v[132:135], a[76:79], a[220:223]
    v_mfma_f32_16x16x32_bf16 a[216:219], v[132:135], a[72:75], a[216:219]
    ds_read_b64_tr_b16 v[150:151], v181 offset:34816
    v_mfma_f32_16x16x32_bf16 a[212:215], v[132:135], a[68:71], a[212:215]
    ds_read_b64_tr_b16 v[152:153], v182 offset:32768
    s_add_u32 m0, s60, 114688
    s_add_u32 s9, s62, 0
    v_mfma_f32_16x16x32_bf16 a[208:211], v[132:135], a[64:67], a[208:211]
    buffer_load_dwordx4 v168, s[40:43], s9 offen lds
    v_mfma_f32_16x16x32_bf16 a[224:227], v[136:139], a[64:67], a[224:227]
    ds_read_b64_tr_b16 v[154:155], v182 offset:34816
    v_mfma_f32_16x16x32_bf16 a[228:231], v[136:139], a[68:71], a[228:231]
    ds_read_b64_tr_b16 v[156:157], v183 offset:32768
    v_mfma_f32_16x16x32_bf16 a[232:235], v[136:139], a[72:75], a[232:235]
    v_mfma_f32_16x16x32_bf16 a[236:239], v[136:139], a[76:79], a[236:239]
    ds_read_b64_tr_b16 v[158:159], v183 offset:34816
    ds_read_b32 v170, v160
    s_add_u32 m0, s60, 115712
    s_add_u32 s9, s62, 8192
    v_mfma_f32_16x16x32_bf16 a[252:255], v[140:143], a[76:79], a[252:255]
    ds_read_b32 v170, v160
    buffer_load_dwordx4 v168, s[40:43], s9 offen lds
    s_add_u32 m0, s60, 116736
    s_add_u32 s9, s62, 16384
    v_mfma_f32_16x16x32_bf16 a[248:251], v[140:143], a[72:75], a[248:251]
    buffer_load_dwordx4 v168, s[40:43], s9 offen lds
    v_mfma_f32_16x16x32_bf16 a[244:247], v[140:143], a[68:71], a[244:247]
    s_add_u32 m0, s60, 117760
    s_add_u32 s9, s62, 24576
    s_waitcnt lgkmcnt(2)
    v_mfma_f32_16x16x32_bf16 a[240:243], v[140:143], a[64:67], a[240:243]
    buffer_load_dwordx4 v168, s[40:43], s9 offen lds
    v_mfma_f32_16x16x32_bf16 a[192:195], v[144:147], a[80:83], a[192:195]
    s_waitcnt lgkmcnt(0)
    s_and_b64 s[16:17], s[16:17], s[18:19]
    s_and_b32 s16, s16, s17
    s_cmp_eq_u32 s16, 64
    s_cbranch_scc0 L_try9
L_ok9:
    ds_read_b64_tr_b16 v[128:129], v180 offset:49152
    s_add_u32 s10, s71, 32768
    v_mfma_f32_16x16x32_bf16 a[196:199], v[144:147], a[84:87], a[196:199]
    buffer_load_dwordx4 a[128:131], v160, s[44:47], s10 offen offset:0 sc1
    v_mfma_f32_16x16x32_bf16 a[200:203], v[144:147], a[88:91], a[200:203]
    ds_read_b64_tr_b16 v[130:131], v180 offset:51200
    v_mfma_f32_16x16x32_bf16 a[204:207], v[144:147], a[92:95], a[204:207]
    ds_read_b64_tr_b16 v[132:133], v181 offset:49152
    v_mfma_f32_16x16x32_bf16 a[220:223], v[148:151], a[92:95], a[220:223]
    v_mfma_f32_16x16x32_bf16 a[216:219], v[148:151], a[88:91], a[216:219]
    ds_read_b64_tr_b16 v[134:135], v181 offset:51200
    v_mfma_f32_16x16x32_bf16 a[212:215], v[148:151], a[84:87], a[212:215]
    ds_read_b64_tr_b16 v[136:137], v182 offset:49152
    v_mfma_f32_16x16x32_bf16 a[208:211], v[148:151], a[80:83], a[208:211]
    buffer_load_dwordx4 a[132:135], v160, s[44:47], s10 offen offset:1024 sc1
    v_mfma_f32_16x16x32_bf16 a[224:227], v[152:155], a[80:83], a[224:227]
    ds_read_b64_tr_b16 v[138:139], v182 offset:51200
    v_mfma_f32_16x16x32_bf16 a[228:231], v[152:155], a[84:87], a[228:231]
    ds_read_b64_tr_b16 v[140:141], v183 offset:49152
    v_mfma_f32_16x16x32_bf16 a[232:235], v[152:155], a[88:91], a[232:235]
    v_mfma_f32_16x16x32_bf16 a[236:239], v[152:155], a[92:95], a[236:239]
    ds_read_b64_tr_b16 v[142:143], v183 offset:51200
    v_mfma_f32_16x16x32_bf16 a[252:255], v[156:159], a[92:95], a[252:255]
    buffer_load_dwordx4 a[136:139], v160, s[44:47], s10 offen offset:2048 sc1
    v_mfma_f32_16x16x32_bf16 a[248:251], v[156:159], a[88:91], a[248:251]
    buffer_load_dwordx4 a[140:143], v160, s[44:47], s10 offen offset:3072 sc1
    v_mfma_f32_16x16x32_bf16 a[244:247], v[156:159], a[84:87], a[244:247]
    s_add_u32 s10, s71, 36864
    s_waitcnt lgkmcnt(0)
    v_mfma_f32_16x16x32_bf16 a[240:243], v[156:159], a[80:83], a[240:243]
    buffer_load_dwordx4 a[144:147], v160, s[44:47], s10 offen offset:0 sc1
    v_mfma_f32_16x16x32_bf16 a[192:195], v[128:131], a[96:99], a[192:195]
    s_buffer_load_dwordx4 s[16:19], s[44:47], s66 offset:528 glc
    v_add_u32 v180, 0xffff4000, v180
    ds_read_b64_tr_b16 v[144:145], v180 offset:0
    v_mfma_f32_16x16x32_bf16 a[196:199], v[128:131], a[100:103], a[196:199]
    buffer_load_dwordx4 a[148:151], v160, s[44:47], s10 offen offset:1024 sc1
    v_mfma_f32_16x16x32_bf16 a[200:203], v[128:131], a[104:107], a[200:203]
    ds_read_b64_tr_b16 v[146:147], v180 offset:2048
    v_mfma_f32_16x16x32_bf16 a[204:207], v[128:131], a[108:111], a[204:207]
    v_add_u32 v181, 0xffff4000, v181
    ds_read_b64_tr_b16 v[148:149], v181 offset:0
    v_mfma_f32_16x16x32_bf16 a[220:223], v[132:135], a[108:111], a[220:223]
    v_mfma_f32_16x16x32_bf16 a[216:219], v[132:135], a[104:107], a[216:219]
    ds_read_b64_tr_b16 v[150:151], v181 offset:2048
    v_mfma_f32_16x16x32_bf16 a[212:215], v[132:135], a[100:103], a[212:215]
    v_add_u32 v182, 0xffff4000, v182
    ds_read_b64_tr_b16 v[152:153], v182 offset:0
    v_mfma_f32_16x16x32_bf16 a[208:211], v[132:135], a[96:99], a[208:211]
    buffer_load_dwordx4 a[152:155], v160, s[44:47], s10 offen offset:2048 sc1
    v_mfma_f32_16x16x32_bf16 a[224:227], v[136:139], a[96:99], a[224:227]
    ds_read_b64_tr_b16 v[154:155], v182 offset:2048
    v_mfma_f32_16x16x32_bf16 a[228:231], v[136:139], a[100:103], a[228:231]
    v_add_u32 v183, 0xffff4000, v183
    ds_read_b64_tr_b16 v[156:157], v183 offset:0
    v_mfma_f32_16x16x32_bf16 a[232:235], v[136:139], a[104:107], a[232:235]
    v_mfma_f32_16x16x32_bf16 a[236:239], v[136:139], a[108:111], a[236:239]
    ds_read_b64_tr_b16 v[158:159], v183 offset:2048
    ds_read_b32 v170, v160
    v_mfma_f32_16x16x32_bf16 a[252:255], v[140:143], a[108:111], a[252:255]
    ds_read_b32 v170, v160
    buffer_load_dwordx4 a[156:159], v160, s[44:47], s10 offen offset:3072 sc1
    s_add_u32 s10, s71, 40960
    v_mfma_f32_16x16x32_bf16 a[248:251], v[140:143], a[104:107], a[248:251]
    buffer_load_dwordx4 a[160:163], v160, s[44:47], s10 offen offset:0 sc1
    v_mfma_f32_16x16x32_bf16 a[244:247], v[140:143], a[100:103], a[244:247]
    s_waitcnt lgkmcnt(2)
    v_mfma_f32_16x16x32_bf16 a[240:243], v[140:143], a[96:99], a[240:243]
    buffer_load_dwordx4 a[164:167], v160, s[44:47], s10 offen offset:1024 sc1
    v_mfma_f32_16x16x32_bf16 a[192:195], v[144:147], a[112:115], a[192:195]
    ds_read_b64_tr_b16 v[128:129], v180 offset:16384
    v_mfma_f32_16x16x32_bf16 a[196:199], v[144:147], a[116:119], a[196:199]
    buffer_load_dwordx4 a[168:171], v160, s[44:47], s10 offen offset:2048 sc1
    v_mfma_f32_16x16x32_bf16 a[200:203], v[144:147], a[120:123], a[200:203]
    ds_read_b64_tr_b16 v[130:131], v180 offset:18432
    v_mfma_f32_16x16x32_bf16 a[204:207], v[144:147], a[124:127], a[204:207]
    ds_read_b64_tr_b16 v[132:133], v181 offset:16384
    v_mfma_f32_16x16x32_bf16 a[220:223], v[148:151], a[124:127], a[220:223]
    v_mfma_f32_16x16x32_bf16 a[216:219], v[148:151], a[120:123], a[216:219]
    ds_read_b64_tr_b16 v[134:135], v181 offset:18432
    v_mfma_f32_16x16x32_bf16 a[212:215], v[148:151], a[116:119], a[212:215]
    ds_read_b64_tr_b16 v[136:137], v182 offset:16384
    v_mfma_f32_16x16x32_bf16 a[208:211], v[148:151], a[112:115], a[208:211]
    buffer_load_dwordx4 a[172:175], v160, s[44:47], s10 offen offset:3072 sc1
    v_mfma_f32_16x16x32_bf16 a[224:227], v[152:155], a[112:115], a[224:227]
    ds_read_b64_tr_b16 v[138:139], v182 offset:18432
    v_mfma_f32_16x16x32_bf16 a[228:231], v[152:155], a[116:119], a[228:231]
    ds_read_b64_tr_b16 v[140:141], v183 offset:16384
    v_mfma_f32_16x16x32_bf16 a[232:235], v[152:155], a[120:123], a[232:235]
    v_mfma_f32_16x16x32_bf16 a[236:239], v[152:155], a[124:127], a[236:239]
    ds_read_b64_tr_b16 v[142:143], v183 offset:18432
    ds_read_b32 v170, v160
    s_add_u32 s10, s71, 45056
    v_mfma_f32_16x16x32_bf16 a[252:255], v[156:159], a[124:127], a[252:255]
    ds_read_b32 v170, v160
    buffer_load_dwordx4 a[176:179], v160, s[44:47], s10 offen offset:0 sc1
    v_mfma_f32_16x16x32_bf16 a[248:251], v[156:159], a[120:123], a[248:251]
    buffer_load_dwordx4 a[180:183], v160, s[44:47], s10 offen offset:1024 sc1
    v_mfma_f32_16x16x32_bf16 a[244:247], v[156:159], a[116:119], a[244:247]
    s_waitcnt vmcnt(10) lgkmcnt(2)
    v_mfma_f32_16x16x32_bf16 a[240:243], v[156:159], a[112:115], a[240:243]
    buffer_load_dwordx4 a[184:187], v160, s[44:47], s10 offen offset:2048 sc1
    v_mfma_f32_16x16x32_bf16 a[192:195], v[128:131], a[128:131], a[192:195]
    s_waitcnt lgkmcnt(0)
    s_and_b64 s[16:17], s[16:17], s[18:19]
    s_and_b32 s16, s16, s17
    s_cmp_eq_u32 s16, 64
    s_cbranch_scc0 L_try10
L_ok10:
    ds_read_b64_tr_b16 v[144:145], v180 offset:32768
    v_mfma_f32_16x16x32_bf16 a[196:199], v[128:131], a[132:135], a[196:199]
    buffer_load_dwordx4 a[188:191], v160, s[44:47], s10 offen offset:3072 sc1
    v_mfma_f32_16x16x32_bf16 a[200:203], v[128:131], a[136:139], a[200:203]
    ds_read_b64_tr_b16 v[146:147], v180 offset:34816
    v_mfma_f32_16x16x32_bf16 a[204:207], v[128:131], a[140:143], a[204:207]
    ds_read_b64_tr_b16 v[148:149], v181 offset:32768
    v_mfma_f32_16x16x32_bf16 a[220:223], v[132:135], a[140:143], a[220:223]
    v_mfma_f32_16x16x32_bf16 a[216:219], v[132:135], a[136:139], a[216:219]
    ds_read_b64_tr_b16 v[150:151], v181 offset:34816
    v_mfma_f32_16x16x32_bf16 a[212:215], v[132:135], a[132:135], a[212:215]
    ds_read_b64_tr_b16 v[152:153], v182 offset:32768
    s_add_u32 s10, s71, 49152
    v_mfma_f32_16x16x32_bf16 a[208:211], v[132:135], a[128:131], a[208:211]
    buffer_load_dwordx4 a[0:3], v160, s[44:47], s10 offen offset:0 sc1
    v_mfma_f32_16x16x32_bf16 a[224:227], v[136:139], a[128:131], a[224:227]
    ds_read_b64_tr_b16 v[154:155], v182 offset:34816
    v_mfma_f32_16x16x32_bf16 a[228:231], v[136:139], a[132:135], a[228:231]
    ds_read_b64_tr_b16 v[156:157], v183 offset:32768
    v_mfma_f32_16x16x32_bf16 a[232:235], v[136:139], a[136:139], a[232:235]
    v_mfma_f32_16x16x32_bf16 a[236:239], v[136:139], a[140:143], a[236:239]
    ds_read_b64_tr_b16 v[158:159], v183 offset:34816
    v_mfma_f32_16x16x32_bf16 a[252:255], v[140:143], a[140:143], a[252:255]
    buffer_load_dwordx4 a[4:7], v160, s[44:47], s10 offen offset:1024 sc1
    v_mfma_f32_16x16x32_bf16 a[248:251], v[140:143], a[136:139], a[248:251]
    buffer_load_dwordx4 a[8:11], v160, s[44:47], s10 offen offset:2048 sc1
    v_mfma_f32_16x16x32_bf16 a[244:247], v[140:143], a[132:135], a[244:247]
    s_waitcnt vmcnt(11) lgkmcnt(0)
    v_mfma_f32_16x16x32_bf16 a[240:243], v[140:143], a[128:131], a[240:243]
    buffer_load_dwordx4 a[12:15], v160, s[44:47], s10 offen offset:3072 sc1
    v_mfma_f32_16x16x32_bf16 a[192:195], v[144:147], a[144:147], a[192:195]
    s_buffer_load_dwordx4 s[20:23], s[44:47], s66 offset:256 glc
    v_add_u32 v180, 0xffff4000, v180
    ds_read_b64_tr_b16 v[128:129], v180 offset:32768
    s_add_u32 s10, s71, 53248
    v_mfma_f32_16x16x32_bf16 a[196:199], v[144:147], a[148:151], a[196:199]
    buffer_load_dwordx4 a[16:19], v160, s[44:47], s10 offen offset:0 sc1
    v_mfma_f32_16x16x32_bf16 a[200:203], v[144:147], a[152:155], a[200:203]
    ds_read_b64_tr_b16 v[130:131], v180 offset:34816
    v_mfma_f32_16x16x32_bf16 a[204:207], v[144:147], a[156:159], a[204:207]
    v_add_u32 v181, 0xffff4000, v181
    ds_read_b64_tr_b16 v[132:133], v181 offset:32768
    v_mfma_f32_16x16x32_bf16 a[220:223], v[148:151], a[156:159], a[220:223]
    v_mfma_f32_16x16x32_bf16 a[216:219], v[148:151], a[152:155], a[216:219]
    ds_read_b64_tr_b16 v[134:135], v181 offset:34816
    v_mfma_f32_16x16x32_bf16 a[212:215], v[148:151], a[148:151], a[212:215]
    v_add_u32 v182, 0xffff4000, v182
    ds_read_b64_tr_b16 v[136:137], v182 offset:32768
    v_mfma_f32_16x16x32_bf16 a[208:211], v[148:151], a[144:147], a[208:211]
    buffer_load_dwordx4 a[20:23], v160, s[44:47], s10 offen offset:1024 sc1
    v_mfma_f32_16x16x32_bf16 a[224:227], v[152:155], a[144:147], a[224:227]
    ds_read_b64_tr_b16 v[138:139], v182 offset:34816
    v_mfma_f32_16x16x32_bf16 a[228:231], v[152:155], a[148:151], a[228:231]
    v_add_u32 v183, 0xffff4000, v183
    ds_read_b64_tr_b16 v[140:141], v183 offset:32768
    v_mfma_f32_16x16x32_bf16 a[232:235], v[152:155], a[152:155], a[232:235]
    v_mfma_f32_16x16x32_bf16 a[236:239], v[152:155], a[156:159], a[236:239]
    ds_read_b64_tr_b16 v[142:143], v183 offset:34816
    ds_read_b32 v170, v160
    v_mfma_f32_16x16x32_bf16 a[252:255], v[156:159], a[156:159], a[252:255]
    ds_read_b32 v170, v160
    buffer_load_dwordx4 a[24:27], v160, s[44:47], s10 offen offset:2048 sc1
    v_mfma_f32_16x16x32_bf16 a[248:251], v[156:159], a[152:155], a[248:251]
    buffer_load_dwordx4 a[28:31], v160, s[44:47], s10 offen offset:3072 sc1
    v_mfma_f32_16x16x32_bf16 a[244:247], v[156:159], a[148:151], a[244:247]
    s_add_u32 m0, s60, 131072
    s_add_u32 s9, s62, 32768
    s_waitcnt vmcnt(12) lgkmcnt(2)
    v_mfma_f32_16x16x32_bf16 a[240:243], v[156:159], a[144:147], a[240:243]
    buffer_load_dwordx4 v168, s[40:43], s9 offen lds
    v_mfma_f32_16x16x32_bf16 a[192:195], v[128:131], a[160:163], a[192:195]
    ds_read_b64_tr_b16 v[144:145], v180 offset:0
    v_mfma_f32_16x16x32_bf16 a[196:199], v[128:131], a[164:167], a[196:199]
    buffer_load_dwordx4 v[0:3], v174, s[24:27], s72 offen offset:1024
    v_mfma_f32_16x16x32_bf16 a[200:203], v[128:131], a[168:171], a[200:203]
    ds_read_b64_tr_b16 v[146:147], v180 offset:2048
    v_mfma_f32_16x16x32_bf16 a[204:207], v[128:131], a[172:175], a[204:207]
    ds_read_b64_tr_b16 v[148:149], v181 offset:0
    s_add_u32 s11, s72, 8192
    v_mfma_f32_16x16x32_bf16 a[220:223], v[132:135], a[172:175], a[220:223]
    buffer_load_dwordx4 v[4:7], v174, s[24:27], s11 offen offset:1024
    v_mfma_f32_16x16x32_bf16 a[216:219], v[132:135], a[168:171], a[216:219]
    ds_read_b64_tr_b16 v[150:151], v181 offset:2048
    v_mfma_f32_16x16x32_bf16 a[212:215], v[132:135], a[164:167], a[212:215]
    ds_read_b64_tr_b16 v[152:153], v182 offset:0
    s_add_u32 m0, s60, 132096
    s_add_u32 s9, s62, 40960
    v_mfma_f32_16x16x32_bf16 a[208:211], v[132:135], a[160:163], a[208:211]
    buffer_load_dwordx4 v168, s[40:43], s9 offen lds
    v_mfma_f32_16x16x32_bf16 a[224:227], v[136:139], a[160:163], a[224:227]
    ds_read_b64_tr_b16 v[154:155], v182 offset:2048
    v_mfma_f32_16x16x32_bf16 a[228:231], v[136:139], a[164:167], a[228:231]
    ds_read_b64_tr_b16 v[156:157], v183 offset:0
    v_mfma_f32_16x16x32_bf16 a[232:235], v[136:139], a[168:171], a[232:235]
    v_mfma_f32_16x16x32_bf16 a[236:239], v[136:139], a[172:175], a[236:239]
    ds_read_b64_tr_b16 v[158:159], v183 offset:2048
    ds_read_b32 v170, v160
    s_add_u32 m0, s60, 133120
    s_add_u32 s9, s62, 49152
    v_mfma_f32_16x16x32_bf16 a[252:255], v[140:143], a[172:175], a[252:255]
    ds_read_b32 v170, v160
    buffer_load_dwordx4 v168, s[40:43], s9 offen lds
    s_add_u32 m0, s60, 134144
    s_add_u32 s9, s62, 57344
    v_mfma_f32_16x16x32_bf16 a[248:251], v[140:143], a[168:171], a[248:251]
    buffer_load_dwordx4 v168, s[40:43], s9 offen lds
    s_add_u32 m0, s60, 147456
    s_add_u32 s9, s62, 65536
    v_mfma_f32_16x16x32_bf16 a[244:247], v[140:143], a[164:167], a[244:247]
    buffer_load_dwordx4 v168, s[40:43], s9 offen lds
    s_add_u32 m0, s60, 148480
    s_add_u32 s9, s62, 73728
    s_waitcnt vmcnt(15) lgkmcnt(2)
    v_mfma_f32_16x16x32_bf16 a[240:243], v[140:143], a[160:163], a[240:243]
    buffer_load_dwordx4 v168, s[40:43], s9 offen lds
    v_mfma_f32_16x16x32_bf16 a[192:195], v[144:147], a[176:179], a[192:195]
    s_waitcnt lgkmcnt(0)
    s_and_b64 s[20:21], s[20:21], s[22:23]
    s_and_b32 s20, s20, s21
    s_cmp_eq_u32 s20, 64
    s_cbranch_scc0 L_try11
L_ok11:
    ds_read_b64_tr_b16 v[128:129], v180 offset:16384
    s_add_u32 s10, s71, 57344
    v_mfma_f32_16x16x32_bf16 a[196:199], v[144:147], a[180:183], a[196:199]
    buffer_load_dwordx4 a[32:35], v160, s[44:47], s10 offen offset:0 sc1
    v_mfma_f32_16x16x32_bf16 a[200:203], v[144:147], a[184:187], a[200:203]
    ds_read_b64_tr_b16 v[130:131], v180 offset:18432
    v_mfma_f32_16x16x32_bf16 a[204:207], v[144:147], a[188:191], a[204:207]
    ds_read_b64_tr_b16 v[132:133], v181 offset:16384
    v_mfma_f32_16x16x32_bf16 a[220:223], v[148:151], a[188:191], a[220:223]
    v_mfma_f32_16x16x32_bf16 a[216:219], v[148:151], a[184:187], a[216:219]
    ds_read_b64_tr_b16 v[134:135], v181 offset:18432
    v_mfma_f32_16x16x32_bf16 a[212:215], v[148:151], a[180:183], a[212:215]
    ds_read_b64_tr_b16 v[136:137], v182 offset:16384
    v_mfma_f32_16x16x32_bf16 a[208:211], v[148:151], a[176:179], a[208:211]
    buffer_load_dwordx4 a[36:39], v160, s[44:47], s10 offen offset:1024 sc1
    v_mfma_f32_16x16x32_bf16 a[224:227], v[152:155], a[176:179], a[224:227]
    ds_read_b64_tr_b16 v[138:139], v182 offset:18432
    v_mfma_f32_16x16x32_bf16 a[228:231], v[152:155], a[180:183], a[228:231]
    ds_read_b64_tr_b16 v[140:141], v183 offset:16384
    v_mfma_f32_16x16x32_bf16 a[232:235], v[152:155], a[184:187], a[232:235]
    v_mfma_f32_16x16x32_bf16 a[236:239], v[152:155], a[188:191], a[236:239]
    ds_read_b64_tr_b16 v[142:143], v183 offset:18432
    v_mfma_f32_16x16x32_bf16 a[252:255], v[156:159], a[188:191], a[252:255]
    buffer_load_dwordx4 a[40:43], v160, s[44:47], s10 offen offset:2048 sc1
    v_mfma_f32_16x16x32_bf16 a[248:251], v[156:159], a[184:187], a[248:251]
    buffer_load_dwordx4 a[44:47], v160, s[44:47], s10 offen offset:3072 sc1
    v_mfma_f32_16x16x32_bf16 a[244:247], v[156:159], a[180:183], a[244:247]
    s_add_u32 s10, s71, 61440
    s_waitcnt vmcnt(16) lgkmcnt(0)
    v_mfma_f32_16x16x32_bf16 a[240:243], v[156:159], a[176:179], a[240:243]
    buffer_load_dwordx4 a[48:51], v160, s[44:47], s10 offen offset:0 sc1
    v_mfma_f32_16x16x32_bf16 a[192:195], v[128:131], a[0:3], a[192:195]
    v_add_u32 v180, 0x18000, v180
    ds_read_b64_tr_b16 v[144:145], v180 offset:0
    v_mfma_f32_16x16x32_bf16 a[196:199], v[128:131], a[4:7], a[196:199]
    buffer_load_dwordx4 a[52:55], v160, s[44:47], s10 offen offset:1024 sc1
    v_mfma_f32_16x16x32_bf16 a[200:203], v[128:131], a[8:11], a[200:203]
    ds_read_b64_tr_b16 v[146:147], v180 offset:2048
    v_mfma_f32_16x16x32_bf16 a[204:207], v[128:131], a[12:15], a[204:207]
    v_add_u32 v181, 0x18000, v181
    ds_read_b64_tr_b16 v[148:149], v181 offset:0
    v_mfma_f32_16x16x32_bf16 a[220:223], v[132:135], a[12:15], a[220:223]
    v_mfma_f32_16x16x32_bf16 a[216:219], v[132:135], a[8:11], a[216:219]
    ds_read_b64_tr_b16 v[150:151], v181 offset:2048
    v_mfma_f32_16x16x32_bf16 a[212:215], v[132:135], a[4:7], a[212:215]
    v_add_u32 v182, 0x18000, v182
    ds_read_b64_tr_b16 v[152:153], v182 offset:0
    v_mfma_f32_16x16x32_bf16 a[208:211], v[132:135], a[0:3], a[208:211]
    buffer_load_dwordx4 a[56:59], v160, s[44:47], s10 offen offset:2048 sc1
    v_mfma_f32_16x16x32_bf16 a[224:227], v[136:139], a[0:3], a[224:227]
    ds_read_b64_tr_b16 v[154:155], v182 offset:2048
    v_mfma_f32_16x16x32_bf16 a[228:231], v[136:139], a[4:7], a[228:231]
    v_add_u32 v183, 0x18000, v183
    ds_read_b64_tr_b16 v[156:157], v183 offset:0
    v_mfma_f32_16x16x32_bf16 a[232:235], v[136:139], a[8:11], a[232:235]
    v_mfma_f32_16x16x32_bf16 a[236:239], v[136:139], a[12:15], a[236:239]
    ds_read_b64_tr_b16 v[158:159], v183 offset:2048
    v_mfma_f32_16x16x32_bf16 a[252:255], v[140:143], a[12:15], a[252:255]
    buffer_load_dwordx4 a[60:63], v160, s[44:47], s10 offen offset:3072 sc1
    s_add_u32 m0, s60, 149504
    s_add_u32 s9, s62, 81920
    v_mfma_f32_16x16x32_bf16 a[248:251], v[140:143], a[8:11], a[248:251]
    buffer_load_dwordx4 v168, s[40:43], s9 offen lds
    v_mfma_f32_16x16x32_bf16 a[244:247], v[140:143], a[4:7], a[244:247]
    s_add_u32 m0, s60, 150528
    s_add_u32 s9, s62, 90112
    s_waitcnt vmcnt(17) lgkmcnt(0)
    v_mfma_f32_16x16x32_bf16 a[240:243], v[140:143], a[0:3], a[240:243]
    buffer_load_dwordx4 v168, s[40:43], s9 offen lds
    v_mfma_f32_16x16x32_bf16 a[192:195], v[144:147], a[16:19], a[192:195]
    ds_read_b64_tr_b16 v[128:129], v180 offset:16384
    s_add_u32 s10, s71, 65536
    v_mfma_f32_16x16x32_bf16 a[196:199], v[144:147], a[20:23], a[196:199]
    buffer_load_dwordx4 a[64:67], v160, s[44:47], s10 offen offset:0 sc1
    v_mfma_f32_16x16x32_bf16 a[200:203], v[144:147], a[24:27], a[200:203]
    ds_read_b64_tr_b16 v[130:131], v180 offset:18432
    v_mfma_f32_16x16x32_bf16 a[204:207], v[144:147], a[28:31], a[204:207]
    ds_read_b64_tr_b16 v[132:133], v181 offset:16384
    v_mfma_f32_16x16x32_bf16 a[220:223], v[148:151], a[28:31], a[220:223]
    v_mfma_f32_16x16x32_bf16 a[216:219], v[148:151], a[24:27], a[216:219]
    ds_read_b64_tr_b16 v[134:135], v181 offset:18432
    v_mfma_f32_16x16x32_bf16 a[212:215], v[148:151], a[20:23], a[212:215]
    ds_read_b64_tr_b16 v[136:137], v182 offset:16384
    v_mfma_f32_16x16x32_bf16 a[208:211], v[148:151], a[16:19], a[208:211]
    buffer_load_dwordx4 a[68:71], v160, s[44:47], s10 offen offset:1024 sc1
    v_mfma_f32_16x16x32_bf16 a[224:227], v[152:155], a[16:19], a[224:227]
    ds_read_b64_tr_b16 v[138:139], v182 offset:18432
    v_mfma_f32_16x16x32_bf16 a[228:231], v[152:155], a[20:23], a[228:231]
    ds_read_b64_tr_b16 v[140:141], v183 offset:16384
    v_mfma_f32_16x16x32_bf16 a[232:235], v[152:155], a[24:27], a[232:235]
    v_mfma_f32_16x16x32_bf16 a[236:239], v[152:155], a[28:31], a[236:239]
    ds_read_b64_tr_b16 v[142:143], v183 offset:18432
    v_mfma_f32_16x16x32_bf16 a[252:255], v[156:159], a[28:31], a[252:255]
    buffer_load_dwordx4 a[72:75], v160, s[44:47], s10 offen offset:2048 sc1
    v_mfma_f32_16x16x32_bf16 a[248:251], v[156:159], a[24:27], a[248:251]
    buffer_load_dwordx4 a[76:79], v160, s[44:47], s10 offen offset:3072 sc1
    v_mfma_f32_16x16x32_bf16 a[244:247], v[156:159], a[20:23], a[244:247]
    s_add_u32 m0, s60, 65536
    s_add_u32 s9, s62, 98304
    s_waitcnt vmcnt(10) lgkmcnt(0)
    v_mfma_f32_16x16x32_bf16 a[240:243], v[156:159], a[16:19], a[240:243]
    buffer_load_dwordx4 v168, s[40:43], s9 offen lds
    v_mfma_f32_16x16x32_bf16 a[192:195], v[128:131], a[32:35], a[192:195]
    ds_read_b64_tr_b16 v[144:145], v180 offset:32768
    s_add_u32 m0, s60, 66560
L_stub11:
    s_cbranch_execz L_tourret
    s_nop 0
    s_add_u32 s9, s62, 106496
    v_mfma_f32_16x16x32_bf16 a[196:199], v[128:131], a[36:39], a[196:199]
    buffer_load_dwordx4 v168, s[40:43], s9 offen lds
    v_mfma_f32_16x16x32_bf16 a[200:203], v[128:131], a[40:43], a[200:203]
    ds_read_b64_tr_b16 v[146:147], v180 offset:34816
    v_mfma_f32_16x16x32_bf16 a[204:207], v[128:131], a[44:47], a[204:207]
    ds_read_b64_tr_b16 v[148:149], v181 offset:32768
    v_mfma_f32_16x16x32_bf16 a[220:223], v[132:135], a[44:47], a[220:223]
    v_mfma_f32_16x16x32_bf16 a[216:219], v[132:135], a[40:43], a[216:219]
    ds_read_b64_tr_b16 v[150:151], v181 offset:34816
    v_mfma_f32_16x16x32_bf16 a[212:215], v[132:135], a[36:39], a[212:215]
    ds_read_b64_tr_b16 v[152:153], v182 offset:32768
    s_add_u32 m0, s60, 67584
    s_add_u32 s9, s62, 114688
    v_mfma_f32_16x16x32_bf16 a[208:211], v[132:135], a[32:35], a[208:211]
    buffer_load_dwordx4 v168, s[40:43], s9 offen lds
    v_mfma_f32_16x16x32_bf16 a[224:227], v[136:139], a[32:35], a[224:227]
    ds_read_b64_tr_b16 v[154:155], v182 offset:34816
    v_mfma_f32_16x16x32_bf16 a[228:231], v[136:139], a[36:39], a[228:231]
    ds_read_b64_tr_b16 v[156:157], v183 offset:32768
    v_mfma_f32_16x16x32_bf16 a[232:235], v[136:139], a[40:43], a[232:235]
    v_mfma_f32_16x16x32_bf16 a[236:239], v[136:139], a[44:47], a[236:239]
    ds_read_b64_tr_b16 v[158:159], v183 offset:34816
    s_add_u32 m0, s60, 68608
    s_add_u32 s9, s62, 122880
    v_mfma_f32_16x16x32_bf16 a[252:255], v[140:143], a[44:47], a[252:255]
    buffer_load_dwordx4 v168, s[40:43], s9 offen lds
    s_add_u32 s10, s71, 69632
    v_mfma_f32_16x16x32_bf16 a[248:251], v[140:143], a[40:43], a[248:251]
    buffer_load_dwordx4 a[80:83], v160, s[44:47], s10 offen offset:0 sc1
    v_mfma_f32_16x16x32_bf16 a[244:247], v[140:143], a[36:39], a[244:247]
    s_waitcnt vmcnt(9) lgkmcnt(0)
    v_mfma_f32_16x16x32_bf16 a[240:243], v[140:143], a[32:35], a[240:243]
    buffer_load_dwordx4 a[84:87], v160, s[44:47], s10 offen offset:1024 sc1
    v_mfma_f32_16x16x32_bf16 a[192:195], v[144:147], a[48:51], a[192:195]
    ds_read_b64_tr_b16 v[128:129], v180 offset:49152
    v_mfma_f32_16x16x32_bf16 a[196:199], v[144:147], a[52:55], a[196:199]
    v_mfma_f32_16x16x32_bf16 a[200:203], v[144:147], a[56:59], a[200:203]
    ds_read_b64_tr_b16 v[130:131], v180 offset:51200
    v_mfma_f32_16x16x32_bf16 a[204:207], v[144:147], a[60:63], a[204:207]
    ds_read_b64_tr_b16 v[132:133], v181 offset:49152
    v_mfma_f32_16x16x32_bf16 a[220:223], v[148:151], a[60:63], a[220:223]
    v_mfma_f32_16x16x32_bf16 a[216:219], v[148:151], a[56:59], a[216:219]
    ds_read_b64_tr_b16 v[134:135], v181 offset:51200
    v_mfma_f32_16x16x32_bf16 a[212:215], v[148:151], a[52:55], a[212:215]
    ds_read_b64_tr_b16 v[136:137], v182 offset:49152
    v_mfma_f32_16x16x32_bf16 a[208:211], v[148:151], a[48:51], a[208:211]
    buffer_load_dwordx4 a[88:91], v160, s[44:47], s10 offen offset:2048 sc1
    v_mfma_f32_16x16x32_bf16 a[224:227], v[152:155], a[48:51], a[224:227]
    ds_read_b64_tr_b16 v[138:139], v182 offset:51200
    v_mfma_f32_16x16x32_bf16 a[228:231], v[152:155], a[52:55], a[228:231]
    ds_read_b64_tr_b16 v[140:141], v183 offset:49152
    v_mfma_f32_16x16x32_bf16 a[232:235], v[152:155], a[56:59], a[232:235]
    v_mfma_f32_16x16x32_bf16 a[236:239], v[152:155], a[60:63], a[236:239]
    ds_read_b64_tr_b16 v[142:143], v183 offset:51200
    v_mfma_f32_16x16x32_bf16 a[252:255], v[156:159], a[60:63], a[252:255]
    v_mfma_f32_16x16x32_bf16 a[248:251], v[156:159], a[56:59], a[248:251]
    v_mfma_f32_16x16x32_bf16 a[244:247], v[156:159], a[52:55], a[244:247]
    buffer_load_dwordx4 a[92:95], v160, s[44:47], s10 offen offset:3072 sc1
    s_waitcnt vmcnt(4) lgkmcnt(0)
    v_mfma_f32_16x16x32_bf16 a[240:243], v[156:159], a[48:51], a[240:243]
    v_mfma_f32_16x16x32_bf16 a[192:195], v[128:131], a[64:67], a[192:195]
    v_add_u32 v180, 0xffff8000, v180
    ds_read_b64_tr_b16 v[144:145], v180 offset:0
    v_mfma_f32_16x16x32_bf16 a[196:199], v[128:131], a[68:71], a[196:199]
    v_xor_b32 v185, 64, v175
    v_xor_b32 v186, 128, v175
    v_mfma_f32_16x16x32_bf16 a[200:203], v[128:131], a[72:75], a[200:203]
    ds_read_b64_tr_b16 v[146:147], v180 offset:2048
    v_xor_b32 v187, 192, v175
    v_mfma_f32_16x16x32_bf16 a[204:207], v[128:131], a[76:79], a[204:207]
    v_add_u32 v181, 0xffff8000, v181
    ds_read_b64_tr_b16 v[148:149], v181 offset:0
    v_mfma_f32_16x16x32_bf16 a[220:223], v[132:135], a[76:79], a[220:223]
    v_xor_b32 v184, 16, v176
    v_lshlrev_b32 v8, 16, v0
    v_mfma_f32_16x16x32_bf16 a[216:219], v[132:135], a[72:75], a[216:219]
    ds_read_b64_tr_b16 v[150:151], v181 offset:2048
    v_and_b32 v9, 0xffff0000, v0
    v_mfma_f32_16x16x32_bf16 a[212:215], v[132:135], a[68:71], a[212:215]
    v_add_u32 v182, 0xffff8000, v182
    ds_read_b64_tr_b16 v[152:153], v182 offset:0
    v_mfma_f32_16x16x32_bf16 a[208:211], v[132:135], a[64:67], a[208:211]
    v_lshlrev_b32 v10, 16, v1
    v_and_b32 v11, 0xffff0000, v1
    v_lshlrev_b32 v12, 16, v2
    v_mfma_f32_16x16x32_bf16 a[224:227], v[136:139], a[64:67], a[224:227]
    ds_read_b64_tr_b16 v[154:155], v182 offset:2048
    v_and_b32 v13, 0xffff0000, v2
    v_mfma_f32_16x16x32_bf16 a[228:231], v[136:139], a[68:71], a[228:231]
    v_add_u32 v183, 0xffff8000, v183
    ds_read_b64_tr_b16 v[156:157], v183 offset:0
    v_mfma_f32_16x16x32_bf16 a[232:235], v[136:139], a[72:75], a[232:235]
    v_lshlrev_b32 v14, 16, v3
    v_and_b32 v15, 0xffff0000, v3
    v_mfma_f32_16x16x32_bf16 a[236:239], v[136:139], a[76:79], a[236:239]
    ds_read_b64_tr_b16 v[158:159], v183 offset:2048
    v_lshlrev_b32 v16, 16, v4
    v_mfma_f32_16x16x32_bf16 a[252:255], v[140:143], a[76:79], a[252:255]
    v_and_b32 v17, 0xffff0000, v4
    v_lshlrev_b32 v18, 16, v5
    v_mfma_f32_16x16x32_bf16 a[248:251], v[140:143], a[72:75], a[248:251]
    v_and_b32 v19, 0xffff0000, v5
    v_lshlrev_b32 v20, 16, v6
    v_mfma_f32_16x16x32_bf16 a[244:247], v[140:143], a[68:71], a[244:247]
    v_and_b32 v21, 0xffff0000, v6
    v_lshlrev_b32 v22, 16, v7
    s_waitcnt vmcnt(0) lgkmcnt(0)
    v_mfma_f32_16x16x32_bf16 a[240:243], v[140:143], a[64:67], a[240:243]
    v_and_b32 v23, 0xffff0000, v7
    v_mfma_f32_16x16x32_bf16 a[192:195], v[144:147], a[80:83], a[192:195]
    v_mfma_f32_16x16x32_bf16 a[196:199], v[144:147], a[84:87], a[196:199]
    v_mfma_f32_16x16x32_bf16 a[200:203], v[144:147], a[88:91], a[200:203]
    v_mfma_f32_16x16x32_bf16 a[204:207], v[144:147], a[92:95], a[204:207]
    v_mfma_f32_16x16x32_bf16 a[220:223], v[148:151], a[92:95], a[220:223]
    v_mfma_f32_16x16x32_bf16 a[216:219], v[148:151], a[88:91], a[216:219]
    v_mfma_f32_16x16x32_bf16 a[212:215], v[148:151], a[84:87], a[212:215]
    v_mfma_f32_16x16x32_bf16 a[208:211], v[148:151], a[80:83], a[208:211]
    s_nop 0
    ds_write_b128 v175, a[192:195] offset:0
    v_mfma_f32_16x16x32_bf16 a[224:227], v[152:155], a[80:83], a[224:227]
    ds_write_b128 v175, a[196:199] offset:16384
    v_mfma_f32_16x16x32_bf16 a[228:231], v[152:155], a[84:87], a[228:231]
    ds_write_b128 v175, a[200:203] offset:32768
    v_mfma_f32_16x16x32_bf16 a[232:235], v[152:155], a[88:91], a[232:235]
    ds_write_b128 v175, a[204:207] offset:49152
    v_mfma_f32_16x16x32_bf16 a[236:239], v[152:155], a[92:95], a[236:239]
    ds_write_b128 v185, a[220:223] offset:49152
    v_mfma_f32_16x16x32_bf16 a[252:255], v[156:159], a[92:95], a[252:255]
    ds_write_b128 v185, a[216:219] offset:32768
    v_mfma_f32_16x16x32_bf16 a[248:251], v[156:159], a[88:91], a[248:251]
    ds_write_b128 v185, a[212:215] offset:16384
    v_mfma_f32_16x16x32_bf16 a[244:247], v[156:159], a[84:87], a[244:247]
    ds_write_b128 v185, a[208:211] offset:0
    v_mfma_f32_16x16x32_bf16 a[240:243], v[156:159], a[80:83], a[240:243]
    ds_write_b128 v186, a[224:227] offset:0
    ds_write_b128 v186, a[228:231] offset:16384
    ds_write_b128 v186, a[232:235] offset:32768
    ds_write_b128 v186, a[236:239] offset:49152
    ds_write_b128 v187, a[252:255] offset:49152
    ds_write_b128 v187, a[248:251] offset:32768
    ds_write_b128 v187, a[244:247] offset:16384
    s_nop 0
    ds_write_b128 v187, a[240:243] offset:0
    s_waitcnt lgkmcnt(0)
    s_barrier
    ds_read_b128 v[64:67], v176 offset:0
    ds_read_b128 v[68:71], v184 offset:0
    ds_read_b128 v[72:75], v176 offset:4096
    ds_read_b128 v[76:79], v184 offset:4096
    ds_read_b128 v[80:83], v176 offset:8192
    ds_read_b128 v[84:87], v184 offset:8192
    ds_read_b128 v[88:91], v176 offset:12288
    ds_read_b128 v[92:95], v184 offset:12288
    ds_read_b128 v[96:99], v176 offset:2048
    ds_read_b128 v[100:103], v184 offset:2048
    ds_read_b128 v[104:107], v176 offset:6144
    ds_read_b128 v[108:111], v184 offset:6144
    ds_read_b128 v[112:115], v176 offset:10240
    ds_read_b128 v[116:119], v184 offset:10240
    ds_read_b128 v[120:123], v176 offset:14336
    ds_read_b128 v[124:127], v184 offset:14336
    s_waitcnt lgkmcnt(15)
    v_add_f32 v8, v8, v64
    v_add_f32 v9, v9, v65
    v_add_f32 v10, v10, v66
    v_add_f32 v11, v11, v67
    s_waitcnt lgkmcnt(14)
    v_add_f32 v12, v12, v68
    v_add_f32 v13, v13, v69
    v_add_f32 v14, v14, v70
    v_add_f32 v15, v15, v71
    s_waitcnt lgkmcnt(13)
    v_add_f32 v8, v8, v72
    v_add_f32 v9, v9, v73
    v_add_f32 v10, v10, v74
    v_add_f32 v11, v11, v75
    s_waitcnt lgkmcnt(12)
    v_add_f32 v12, v12, v76
    v_add_f32 v13, v13, v77
    v_add_f32 v14, v14, v78
    v_add_f32 v15, v15, v79
    s_waitcnt lgkmcnt(11)
    v_add_f32 v8, v8, v80
    v_add_f32 v9, v9, v81
    v_add_f32 v10, v10, v82
    v_add_f32 v11, v11, v83
    s_waitcnt lgkmcnt(10)
    v_add_f32 v12, v12, v84
    v_add_f32 v13, v13, v85
    v_add_f32 v14, v14, v86
    v_add_f32 v15, v15, v87
    s_waitcnt lgkmcnt(9)
    v_add_f32 v8, v8, v88
    v_add_f32 v9, v9, v89
    v_add_f32 v10, v10, v90
    v_add_f32 v11, v11, v91
    s_waitcnt lgkmcnt(8)
    v_add_f32 v12, v12, v92
    v_add_f32 v13, v13, v93
    v_add_f32 v14, v14, v94
    v_add_f32 v15, v15, v95
    v_cvt_pk_bf16_f32 v0, v8, v9
    v_cvt_pk_bf16_f32 v1, v10, v11
    v_cvt_pk_bf16_f32 v2, v12, v13
    v_cvt_pk_bf16_f32 v3, v14, v15
    buffer_store_dwordx4 v[0:3], v174, s[52:55], s72 offen sc0 sc1
    s_waitcnt lgkmcnt(7)
    v_add_f32 v16, v16, v96
    v_add_f32 v17, v17, v97
    v_add_f32 v18, v18, v98
    v_add_f32 v19, v19, v99
    s_waitcnt lgkmcnt(6)
    v_add_f32 v20, v20, v100
    v_add_f32 v21, v21, v101
    v_add_f32 v22, v22, v102
    v_add_f32 v23, v23, v103
    s_waitcnt lgkmcnt(5)
    v_add_f32 v16, v16, v104
    v_add_f32 v17, v17, v105
    v_add_f32 v18, v18, v106
    v_add_f32 v19, v19, v107
    s_waitcnt lgkmcnt(4)
    v_add_f32 v20, v20, v108
    v_add_f32 v21, v21, v109
    v_add_f32 v22, v22, v110
    v_add_f32 v23, v23, v111
    s_waitcnt lgkmcnt(3)
    v_add_f32 v16, v16, v112
    v_add_f32 v17, v17, v113
    v_add_f32 v18, v18, v114
    v_add_f32 v19, v19, v115
    s_waitcnt lgkmcnt(2)
    v_add_f32 v20, v20, v116
    v_add_f32 v21, v21, v117
    v_add_f32 v22, v22, v118
    v_add_f32 v23, v23, v119
    s_waitcnt lgkmcnt(1)
    v_add_f32 v16, v16, v120
    v_add_f32 v17, v17, v121
    v_add_f32 v18, v18, v122
    v_add_f32 v19, v19, v123
    s_waitcnt lgkmcnt(0)
    v_add_f32 v20, v20, v124
    v_add_f32 v21, v21, v125
    v_add_f32 v22, v22, v126
    v_add_f32 v23, v23, v127
    v_cvt_pk_bf16_f32 v4, v16, v17
    v_cvt_pk_bf16_f32 v5, v18, v19
    v_cvt_pk_bf16_f32 v6, v20, v21
    v_cvt_pk_bf16_f32 v7, v22, v23
    buffer_store_dwordx4 v[4:7], v174, s[52:55], s11 offen sc0 sc1
    s_endpgm
L_end:
    s_endpgm
L_slow1:
    s_mov_b32 s7, 0
L_spin1:
    v_bfe_u32 v170, v160, 2, 6
    buffer_load_dword v170, v170, s[48:51], 0 offen offset:64 sc1
    s_waitcnt vmcnt(0)
    v_cmp_eq_u32 vcc, 64, v170
    s_nop 3
    s_and_b32 s8, vcc_lo, 65535
    s_cmp_eq_u32 s8, 65535
    s_cbranch_scc1 L_ok1
    s_add_u32 s7, s7, 1
    s_cmp_lt_u32 s7, 0x8000
    s_cbranch_scc1 L_spin1
    s_branch L_ok1
L_try2:
    s_mov_b32 s7, 0
L_sspin2:
    s_buffer_load_dwordx8 s[16:23], s[44:47], s66 offset:0 glc
    s_waitcnt lgkmcnt(0)
    s_and_b64 s[16:17], s[16:17], s[20:21]
    s_and_b64 s[18:19], s[18:19], s[22:23]
    s_and_b64 s[16:17], s[16:17], s[18:19]
    s_and_b32 s16, s16, s17
    s_cmp_eq_u32 s16, 64
    s_cbranch_scc1 L_ok2
    s_add_u32 s7, s7, 1
    s_cmp_lt_u32 s7, 16
    s_cbranch_scc1 L_sspin2
L_slow2:
    s_mov_b32 s7, 0
L_spin2:
    v_bfe_u32 v170, v160, 2, 6
    buffer_load_dword v170, v170, s[44:47], s66 offen offset:0 sc1
    s_waitcnt vmcnt(0)
    v_cmp_eq_u32 vcc, 64, v170
    s_nop 3
    s_and_b32 s8, vcc_lo, 255
    s_cmp_eq_u32 s8, 255
    s_cbranch_scc1 L_ok2
    s_add_u32 s7, s7, 1
    s_cmp_lt_u32 s7, 0x8000
    s_cbranch_scc1 L_spin2
    s_branch L_ok2
L_try3:
    s_mov_b32 s7, 0
L_sspin3:
    s_buffer_load_dword s12, s[44:47], s67 offset:0 glc
    s_waitcnt lgkmcnt(0)
    s_cmp_eq_u32 s12, 64
    s_cbranch_scc1 L_ok3
    s_add_u32 s7, s7, 1
    s_cmp_lt_u32 s7, 16
    s_cbranch_scc1 L_sspin3
L_slow3:
    s_mov_b32 s7, 0
L_spin3:
    v_bfe_u32 v170, v160, 2, 6
    buffer_load_dword v170, v170, s[44:47], s67 offen offset:0 sc1
    s_waitcnt vmcnt(0)
    v_cmp_eq_u32 vcc, 64, v170
    s_nop 3
    s_and_b32 s8, vcc_lo, s68
    s_cmp_eq_u32 s8, s68
    s_cbranch_scc1 L_ok3
    s_add_u32 s7, s7, 1
    s_cmp_lt_u32 s7, 0x8000
    s_cbranch_scc1 L_spin3
    s_branch L_ok3
L_try4:
    s_mov_b32 s7, 0
L_sspin4:
    s_buffer_load_dwordx4 s[16:19], s[44:47], s66 offset:144 glc
    s_waitcnt lgkmcnt(0)
    s_and_b64 s[16:17], s[16:17], s[18:19]
    s_and_b32 s16, s16, s17
    s_cmp_eq_u32 s16, 64
    s_cbranch_scc1 L_ok4
    s_add_u32 s7, s7, 1
    s_cmp_lt_u32 s7, 16
    s_cbranch_scc1 L_sspin4
L_slow4:
    s_mov_b32 s7, 0
L_spin4:
    v_bfe_u32 v170, v160, 2, 6
    buffer_load_dword v170, v170, s[44:47], s66 offen offset:128 sc1
    s_waitcnt vmcnt(0)
    v_cmp_eq_u32 vcc, 64, v170
    s_nop 3
    s_and_b32 s8, vcc_lo, 240
    s_cmp_eq_u32 s8, 240
    s_cbranch_scc1 L_ok4
    s_add_u32 s7, s7, 1
    s_cmp_lt_u32 s7, 0x8000
    s_cbranch_scc1 L_spin4
    s_branch L_ok4
L_try5:
    s_mov_b32 s7, 0
L_sspin5:
    s_buffer_load_dwordx4 s[16:19], s[44:47], s66 offset:528 glc
    s_waitcnt lgkmcnt(0)
    s_and_b64 s[16:17], s[16:17], s[18:19]
    s_and_b32 s16, s16, s17
    s_cmp_eq_u32 s16, 64
    s_cbranch_scc1 L_ok5
    s_add_u32 s7, s7, 1
    s_cmp_lt_u32 s7, 16
    s_cbranch_scc1 L_sspin5
L_slow5:
    s_mov_b32 s7, 0
L_spin5:
    v_bfe_u32 v170, v160, 2, 6
    buffer_load_dword v170, v170, s[44:47], s66 offen offset:512 sc1
    s_waitcnt vmcnt(0)
    v_cmp_eq_u32 vcc, 64, v170
    s_nop 3
    s_and_b32 s8, vcc_lo, 240
    s_cmp_eq_u32 s8, 240
    s_cbranch_scc1 L_ok5
    s_add_u32 s7, s7, 1
    s_cmp_lt_u32 s7, 0x8000
    s_cbranch_scc1 L_spin5
    s_branch L_ok5
L_try6:
    s_mov_b32 s7, 0
L_sspin6:
    s_buffer_load_dwordx4 s[20:23], s[44:47], s66 offset:256 glc
    s_waitcnt lgkmcnt(0)
    s_and_b64 s[20:21], s[20:21], s[22:23]
    s_and_b32 s20, s20, s21
    s_cmp_eq_u32 s20, 64
    s_cbranch_scc1 L_ok6
    s_add_u32 s7, s7, 1
    s_cmp_lt_u32 s7, 16
    s_cbranch_scc1 L_sspin6
L_slow6:
    s_mov_b32 s7, 0
L_spin6:
    v_bfe_u32 v170, v160, 2, 6
    buffer_load_dword v170, v170, s[44:47], s66 offen offset:256 sc1
    s_waitcnt vmcnt(0)
    v_cmp_eq_u32 vcc, 64, v170
    s_nop 3
    s_and_b32 s8, vcc_lo, 15
    s_cmp_eq_u32 s8, 15
    s_cbranch_scc1 L_ok6
    s_add_u32 s7, s7, 1
    s_cmp_lt_u32 s7, 0x8000
    s_cbranch_scc1 L_spin6
    s_branch L_ok6
L_slow7:
    s_mov_b32 s7, 0
L_spin7:
    v_bfe_u32 v170, v160, 2, 6
    buffer_load_dword v170, v170, s[48:51], 0 offen offset:64 sc1
    s_waitcnt vmcnt(0)
    v_cmp_eq_u32 vcc, 64, v170
    s_nop 3
    s_and_b32 s8, vcc_lo, 65535
    s_cmp_eq_u32 s8, 65535
    s_cbranch_scc1 L_ok7
    s_add_u32 s7, s7, 1
    s_cmp_lt_u32 s7, 0x8000
    s_cbranch_scc1 L_spin7
    s_branch L_ok7
L_try8:
    s_mov_b32 s7, 0
L_sspin8:
    s_buffer_load_dwordx8 s[16:23], s[44:47], s66 offset:0 glc
    s_waitcnt lgkmcnt(0)
    s_and_b64 s[16:17], s[16:17], s[20:21]
    s_and_b64 s[18:19], s[18:19], s[22:23]
    s_and_b64 s[16:17], s[16:17], s[18:19]
    s_and_b32 s16, s16, s17
    s_cmp_eq_u32 s16, 64
    s_cbranch_scc1 L_ok8
    s_add_u32 s7, s7, 1
    s_cmp_lt_u32 s7, 16
    s_cbranch_scc1 L_sspin8
L_slow8:
    s_mov_b32 s7, 0
L_spin8:
    v_bfe_u32 v170, v160, 2, 6
    buffer_load_dword v170, v170, s[44:47], s66 offen offset:0 sc1
    s_waitcnt vmcnt(0)
    v_cmp_eq_u32 vcc, 64, v170
    s_nop 3
    s_and_b32 s8, vcc_lo, 255
    s_cmp_eq_u32 s8, 255
    s_cbranch_scc1 L_ok8
    s_add_u32 s7, s7, 1
    s_cmp_lt_u32 s7, 0x8000
    s_cbranch_scc1 L_spin8
    s_branch L_ok8
L_try9:
    s_mov_b32 s7, 0
L_sspin9:
    s_buffer_load_dwordx4 s[16:19], s[44:47], s66 offset:144 glc
    s_waitcnt lgkmcnt(0)
    s_and_b64 s[16:17], s[16:17], s[18:19]
    s_and_b32 s16, s16, s17
    s_cmp_eq_u32 s16, 64
    s_cbranch_scc1 L_ok9
    s_add_u32 s7, s7, 1
    s_cmp_lt_u32 s7, 16
    s_cbranch_scc1 L_sspin9
L_slow9:
    s_mov_b32 s7, 0
L_spin9:
    v_bfe_u32 v170, v160, 2, 6
    buffer_load_dword v170, v170, s[44:47], s66 offen offset:128 sc1
    s_waitcnt vmcnt(0)
    v_cmp_eq_u32 vcc, 64, v170
    s_nop 3
    s_and_b32 s8, vcc_lo, 240
    s_cmp_eq_u32 s8, 240
    s_cbranch_scc1 L_ok9
    s_add_u32 s7, s7, 1
    s_cmp_lt_u32 s7, 0x8000
    s_cbranch_scc1 L_spin9
    s_branch L_ok9
L_try10:
    s_mov_b32 s7, 0
L_sspin10:
    s_buffer_load_dwordx4 s[16:19], s[44:47], s66 offset:528 glc
    s_waitcnt lgkmcnt(0)
    s_and_b64 s[16:17], s[16:17], s[18:19]
    s_and_b32 s16, s16, s17
    s_cmp_eq_u32 s16, 64
    s_cbranch_scc1 L_ok10
    s_add_u32 s7, s7, 1
    s_cmp_lt_u32 s7, 16
    s_cbranch_scc1 L_sspin10
L_slow10:
    s_mov_b32 s7, 0
L_spin10:
    v_bfe_u32 v170, v160, 2, 6
    buffer_load_dword v170, v170, s[44:47], s66 offen offset:512 sc1
    s_waitcnt vmcnt(0)
    v_cmp_eq_u32 vcc, 64, v170
    s_nop 3
    s_and_b32 s8, vcc_lo, 240
    s_cmp_eq_u32 s8, 240
    s_cbranch_scc1 L_ok10
    s_add_u32 s7, s7, 1
    s_cmp_lt_u32 s7, 0x8000
    s_cbranch_scc1 L_spin10
    s_branch L_ok10
L_try11:
    s_mov_b32 s7, 0
L_sspin11:
    s_buffer_load_dwordx4 s[20:23], s[44:47], s66 offset:256 glc
    s_waitcnt lgkmcnt(0)
    s_and_b64 s[20:21], s[20:21], s[22:23]
    s_and_b32 s20, s20, s21
    s_cmp_eq_u32 s20, 64
    s_cbranch_scc1 L_ok11
    s_add_u32 s7, s7, 1
    s_cmp_lt_u32 s7, 16
    s_cbranch_scc1 L_sspin11
L_slow11:
    s_mov_b32 s7, 0
L_spin11:
    v_bfe_u32 v170, v160, 2, 6
    buffer_load_dword v170, v170, s[44:47], s66 offen offset:256 sc1
    s_waitcnt vmcnt(0)
    v_cmp_eq_u32 vcc, 64, v170
    s_nop 3
    s_and_b32 s8, vcc_lo, 15
    s_cmp_eq_u32 s8, 15
    s_cbranch_scc1 L_ok11
    s_add_u32 s7, s7, 1
    s_cmp_lt_u32 s7, 0x8000
    s_cbranch_scc1 L_spin11
    s_branch L_ok11
L_codeend:
.macro recA p0, p1, p2, p3, p4, p5, p6, p7, p8, p9, p10, p11, p12, p13, p14, p15, p16, p17, p18, p19, p20, p21, p22, p23, p24, p25, p26, p27, p28, p29, p30, p31
.long \p0+0, \p1+0, \p2+0, \p3+0, \p4+0, \p5+0, \p6+0, \p7+0, \p8+0, \p9+0, \p10+0, \p11+0, \p12+0, \p13+0, \p14+0, \p15+0, \p16+0, \p17+0, \p18+0, \p19+0, \p20+0, \p21+0, \p22+0, \p23+0, \p24+0, \p25+0, \p26+0, \p27+0, \p28+0, \p29+0, \p30+0, \p31+0
.long \p0+0, \p1+1024, \p2+98304, \p3+4096, \p4+4096, \p5+458752, \p6+131072, \p7+4096, \p8+512, \p9+4, \p10+1024, \p11+4, \p12+0, \p13+2048, \p14+2048, \p15+73728, \p16+16384, \p17+8192, \p18+458752, \p19+458752, \p20+458752, \p21+458752, \p22+4096, \p23+4096, \p24+4096, \p25+4096, \p26+1792, \p27+512, \p28+2048, \p29+4096, \p30+4096, \p31+0
.long \p0+57344, \p1+49152, \p2+49152, \p3+2048, \p4+8192, \p5+917504, \p6+262144, \p7+294912, \p8+294912, \p9+4096, \p10+2048, \p11+4096, \p12+1, \p13+32768, \p14+32768, \p15+147456, \p16+32768, \p17+16384, \p18+917504, \p19+917504, \p20+917504, \p21+917504, \p22+8192, \p23+8192, \p24+8192, \p25+8192, \p26+3584, \p27+1024, \p28+4096, \p29+4096, \p30+8192, \p31+0
.long \p0+57344, \p1+50176, \p2+147456, \p3+6144, \p4+12288, \p5+1376256, \p6+393216, \p7+299008, \p8+295424, \p9+4100, \p10+3072, \p11+4100, \p12+1, \p13+34816, \p14+34816, \p15+221184, \p16+49152, \p17+24576, \p18+1376256, \p19+1376256, \p20+1376256, \p21+1376256, \p22+12288, \p23+12288, \p24+12288, \p25+12288, \p26+5376, \p27+1536, \p28+6144, \p29+4096, \p30+12288, \p31+0
.endm
.macro recB p0, p1, p2, p3, p4, p5, p6, p7, p8, p9, p10, p11, p12, p13, p14, p15, p16, p17, p18, p19, p20, p21, p22, p23, p24, p25, p26, p27, p28, p29, p30, p31
.long \p0+0, \p1+0, \p2+0, \p3+0, \p4+0, \p5+0, \p6+0, \p7+0, \p8+0, \p9+0, \p10+0, \p11+0, \p12+0, \p13+0, \p14+0, \p15+0, \p16+0, \p17+0, \p18+0, \p19+0, \p20+0, \p21+0, \p22+0, \p23+0, \p24+0, \p25+0, \p26+0, \p27+0, \p28+0, \p29+0, \p30+0, \p31+0
.long \p0+0, \p1+0, \p2+0, \p3+4096, \p4+4096, \p5+458752, \p6+131072, \p7+4096, \p8+512, \p9+4, \p10+1024, \p11+4, \p12+0, \p13+2048, \p14+2048, \p15+73728, \p16+16384, \p17+8192, \p18+458752, \p19+458752, \p20+458752, \p21+458752, \p22+4096, \p23+4096, \p24+4096, \p25+4096, \p26+1792, \p27+512, \p28+2048, \p29+4096, \p30+4096, \p31+0
.long \p0+57344, \p1+57344, \p2+114688, \p3+2048, \p4+8192, \p5+917504, \p6+262144, \p7+294912, \p8+294912, \p9+4096, \p10+2048, \p11+4096, \p12+1, \p13+32768, \p14+32768, \p15+147456, \p16+32768, \p17+16384, \p18+917504, \p19+917504, \p20+917504, \p21+917504, \p22+8192, \p23+8192, \p24+8192, \p25+8192, \p26+3584, \p27+1024, \p28+4096, \p29+4096, \p30+8192, \p31+0
.long \p0+57344, \p1+57344, \p2+114688, \p3+6144, \p4+12288, \p5+1376256, \p6+393216, \p7+299008, \p8+295424, \p9+4100, \p10+3072, \p11+4100, \p12+1, \p13+34816, \p14+34816, \p15+221184, \p16+49152, \p17+24576, \p18+1376256, \p19+1376256, \p20+1376256, \p21+1376256, \p22+12288, \p23+12288, \p24+12288, \p25+12288, \p26+5376, \p27+1536, \p28+6144, \p29+4096, \p30+12288, \p31+0
.endm
.p2align 7
.type L_tab,@object
L_tab:
recA 256, 1024, 0, 0, 0, 256, 256, 0, 49152, 12582848, 12582912, 12579456, 0, 10485760, 10452992, 0, 256, 196608, 256, 8448, 16640, 24832, 0, 1024, 2048, 3072, 0, 0, 12582912, 0, 0, 1024
recA 1152, 1280, 256, 0, 0, 256, 256, 73728, 122880, 12583872, 12599296, 12580480, 0, 10493952, 10461184, 1179648, 262400, 196608, 256, 8448, 16640, 24832, 0, 1024, 2048, 3072, 7168, 2048, 1073741824, 1073741824, 0, 1024
recA 2048, 1536, 512, 0, 0, 256, 256, 147456, 196608, 12584896, 12615680, 12581504, 0, 10502144, 10469376, 2359296, 524544, 196608, 256, 8448, 16640, 24832, 0, 1024, 2048, 3072, 14336, 4096, 1073741824, 1073741824, 0, 1024
recA 2944, 1792, 768, 0, 0, 256, 256, 221184, 270336, 12585920, 12632064, 12582528, 0, 10510336, 10477568, 3538944, 786688, 196608, 256, 8448, 16640, 24832, 0, 1024, 2048, 3072, 21504, 6144, 1073741824, 1073741824, 0, 1024
recA 256, 1024, 0, 0, 0, 256, 256, 4718592, 4767744, 12648384, 12648448, 12644992, 8, 11010048, 10977280, 4718592, 1048832, 196608, 256, 8448, 16640, 24832, 0, 1024, 2048, 3072, 28672, 8192, 12648448, 32, 0, 1024
recA 1152, 1280, 256, 0, 0, 256, 256, 4792320, 4841472, 12649408, 12664832, 12646016, 8, 11018240, 10985472, 5898240, 1310976, 196608, 256, 8448, 16640, 24832, 0, 1024, 2048, 3072, 35840, 10240, 1073741824, 1073741824, 0, 1024
recA 2048, 1536, 512, 0, 0, 256, 256, 4866048, 4915200, 12650432, 12681216, 12647040, 8, 11026432, 10993664, 7077888, 1573120, 196608, 256, 8448, 16640, 24832, 0, 1024, 2048, 3072, 43008, 12288, 1073741824, 1073741824, 0, 1024
recA 2944, 1792, 768, 0, 0, 256, 256, 4939776, 4988928, 12651456, 12697600, 12648064, 8, 11034624, 11001856, 8257536, 1835264, 196608, 256, 8448, 16640, 24832, 0, 1024, 2048, 3072, 50176, 14336, 1073741824, 1073741824, 0, 1024
recA 384, 1152, 128, 0, 0, 384, 384, 8192, 53248, 12582856, 12582912, 12579464, 0, 10489856, 10457088, 0, 384, 229376, 384, 8576, 16768, 24960, 0, 1024, 2048, 3072, 57344, 16384, 1073741824, 1073741824, 16384, 1536
recA 1280, 1408, 384, 0, 0, 384, 384, 81920, 126976, 12583880, 12599296, 12580488, 0, 10498048, 10465280, 1179648, 262528, 229376, 384, 8576, 16768, 24960, 0, 1024, 2048, 3072, 64512, 18432, 1073741824, 1073741824, 16384, 1536
recA 2176, 1664, 640, 0, 0, 384, 384, 155648, 200704, 12584904, 12615680, 12581512, 0, 10506240, 10473472, 2359296, 524672, 229376, 384, 8576, 16768, 24960, 0, 1024, 2048, 3072, 71680, 20480, 1073741824, 1073741824, 16384, 1536
recA 3072, 1920, 896, 0, 0, 384, 384, 229376, 274432, 12585928, 12632064, 12582536, 0, 10514432, 10481664, 3538944, 786816, 229376, 384, 8576, 16768, 24960, 0, 1024, 2048, 3072, 78848, 22528, 1073741824, 1073741824, 16384, 1536
recA 384, 1152, 128, 0, 0, 384, 384, 4726784, 4771840, 12648392, 12648448, 12645000, 8, 11014144, 10981376, 4718592, 1048960, 229376, 384, 8576, 16768, 24960, 0, 1024, 2048, 3072, 86016, 24576, 1073741824, 1073741824, 16384, 1536
recA 1280, 1408, 384, 0, 0, 384, 384, 4800512, 4845568, 12649416, 12664832, 12646024, 8, 11022336, 10989568, 5898240, 1311104, 229376, 384, 8576, 16768, 24960, 0, 1024, 2048, 3072, 93184, 26624, 1073741824, 1073741824, 16384, 1536
recA 2176, 1664, 640, 0, 0, 384, 384, 4874240, 4919296, 12650440, 12681216, 12647048, 8, 11030528, 10997760, 7077888, 1573248, 229376, 384, 8576, 16768, 24960, 0, 1024, 2048, 3072, 100352, 28672, 1073741824, 1073741824, 16384, 1536
recA 3072, 1920, 896, 0, 0, 384, 384, 4947968, 4993024, 12651464, 12697600, 12648072, 8, 11038720, 11005952, 8257536, 1835392, 229376, 384, 8576, 16768, 24960, 0, 1024, 2048, 3072, 107520, 30720, 1073741824, 1073741824, 16384, 1536
recB 0, 512, 768, 0, 0, 512, 512, 0, 49152, 12582864, 12582912, 12579472, 0, 10485760, 10452992, 0, 512, 262144, 512, 8704, 16896, 25088, 0, 1024, 2048, 3072, 114688, 32768, 1073741824, 1073741824, 32768, 2048
recB 896, 1408, 1664, 0, 0, 512, 512, 73728, 122880, 12583888, 12599296, 12580496, 0, 10493952, 10461184, 1179648, 262656, 262144, 512, 8704, 16896, 25088, 0, 1024, 2048, 3072, 121856, 34816, 1073741824, 1073741824, 32768, 2048
recB 1792, 2304, 2560, 0, 0, 512, 512, 147456, 196608, 12584912, 12615680, 12581520, 0, 10502144, 10469376, 2359296, 524800, 262144, 512, 8704, 16896, 25088, 0, 1024, 2048, 3072, 129024, 36864, 1073741824, 1073741824, 32768, 2048
recB 2688, 3200, 3456, 0, 0, 512, 512, 221184, 270336, 12585936, 12632064, 12582544, 0, 10510336, 10477568, 3538944, 786944, 262144, 512, 8704, 16896, 25088, 0, 1024, 2048, 3072, 136192, 38912, 1073741824, 1073741824, 32768, 2048
recB 0, 512, 768, 0, 0, 512, 512, 4718592, 4767744, 12648400, 12648448, 12645008, 8, 11010048, 10977280, 4718592, 1049088, 262144, 512, 8704, 16896, 25088, 0, 1024, 2048, 3072, 143360, 40960, 1073741824, 1073741824, 32768, 2048
recB 896, 1408, 1664, 0, 0, 512, 512, 4792320, 4841472, 12649424, 12664832, 12646032, 8, 11018240, 10985472, 5898240, 1311232, 262144, 512, 8704, 16896, 25088, 0, 1024, 2048, 3072, 150528, 43008, 1073741824, 1073741824, 32768, 2048
recB 1792, 2304, 2560, 0, 0, 512, 512, 4866048, 4915200, 12650448, 12681216, 12647056, 8, 11026432, 10993664, 7077888, 1573376, 262144, 512, 8704, 16896, 25088, 0, 1024, 2048, 3072, 157696, 45056, 1073741824, 1073741824, 32768, 2048
recB 2688, 3200, 3456, 0, 0, 512, 512, 4939776, 4988928, 12651472, 12697600, 12648080, 8, 11034624, 11001856, 8257536, 1835520, 262144, 512, 8704, 16896, 25088, 0, 1024, 2048, 3072, 164864, 47104, 1073741824, 1073741824, 32768, 2048
recB 128, 640, 832, 0, 0, 640, 640, 8192, 53248, 12582872, 12582912, 12579480, 0, 10489856, 10457088, 0, 640, 294912, 640, 8832, 17024, 25216, 0, 1024, 2048, 3072, 172032, 49152, 1073741824, 1073741824, 49152, 2560
recB 1024, 1536, 1728, 0, 0, 640, 640, 81920, 126976, 12583896, 12599296, 12580504, 0, 10498048, 10465280, 1179648, 262784, 294912, 640, 8832, 17024, 25216, 0, 1024, 2048, 3072, 179200, 51200, 1073741824, 1073741824, 49152, 2560
recB 1920, 2432, 2624, 0, 0, 640, 640, 155648, 200704, 12584920, 12615680, 12581528, 0, 10506240, 10473472, 2359296, 524928, 294912, 640, 8832, 17024, 25216, 0, 1024, 2048, 3072, 186368, 53248, 1073741824, 1073741824, 49152, 2560
recB 2816, 3328, 3520, 0, 0, 640, 640, 229376, 274432, 12585944, 12632064, 12582552, 0, 10514432, 10481664, 3538944, 787072, 294912, 640, 8832, 17024, 25216, 0, 1024, 2048, 3072, 193536, 55296, 1073741824, 1073741824, 49152, 2560
recB 128, 640, 832, 0, 0, 640, 640, 4726784, 4771840, 12648408, 12648448, 12645016, 8, 11014144, 10981376, 4718592, 1049216, 294912, 640, 8832, 17024, 25216, 0, 1024, 2048, 3072, 200704, 57344, 1073741824, 1073741824, 49152, 2560
recB 1024, 1536, 1728, 0, 0, 640, 640, 4800512, 4845568, 12649432, 12664832, 12646040, 8, 11022336, 10989568, 5898240, 1311360, 294912, 640, 8832, 17024, 25216, 0, 1024, 2048, 3072, 207872, 59392, 1073741824, 1073741824, 49152, 2560
recB 1920, 2432, 2624, 0, 0, 640, 640, 4874240, 4919296, 12650456, 12681216, 12647064, 8, 11030528, 10997760, 7077888, 1573504, 294912, 640, 8832, 17024, 25216, 0, 1024, 2048, 3072, 215040, 61440, 1073741824, 1073741824, 49152, 2560
recB 2816, 3328, 3520, 0, 0, 640, 640, 4947968, 4993024, 12651480, 12697600, 12648088, 8, 11038720, 11005952, 8257536, 1835648, 294912, 640, 8832, 17024, 25216, 0, 1024, 2048, 3072, 222208, 63488, 1073741824, 1073741824, 49152, 2560
recA 256, 1024, 0, 0, 0, 768, 768, 589824, 638976, 12591040, 12582912, 12587648, 1, 10551296, 10518528, 0, 768, 327680, 768, 8960, 17152, 25344, 0, 1024, 2048, 3072, 229376, 65536, 12591104, 4, 65536, 3072
recA 1152, 1280, 256, 0, 0, 768, 768, 663552, 712704, 12592064, 12599296, 12588672, 1, 10559488, 10526720, 1179648, 262912, 327680, 768, 8960, 17152, 25344, 0, 1024, 2048, 3072, 236544, 67584, 1073741824, 1073741824, 65536, 3072
recA 2048, 1536, 512, 0, 0, 768, 768, 737280, 786432, 12593088, 12615680, 12589696, 1, 10567680, 10534912, 2359296, 525056, 327680, 768, 8960, 17152, 25344, 0, 1024, 2048, 3072, 243712, 69632, 1073741824, 1073741824, 65536, 3072
recA 2944, 1792, 768, 0, 0, 768, 768, 811008, 860160, 12594112, 12632064, 12590720, 1, 10575872, 10543104, 3538944, 787200, 327680, 768, 8960, 17152, 25344, 0, 1024, 2048, 3072, 250880, 71680, 1073741824, 1073741824, 65536, 3072
recA 256, 1024, 0, 0, 0, 768, 768, 5308416, 5357568, 12656576, 12648448, 12653184, 9, 11075584, 11042816, 4718592, 1049344, 327680, 768, 8960, 17152, 25344, 0, 1024, 2048, 3072, 258048, 73728, 12656640, 36, 65536, 3072
recA 1152, 1280, 256, 0, 0, 768, 768, 5382144, 5431296, 12657600, 12664832, 12654208, 9, 11083776, 11051008, 5898240, 1311488, 327680, 768, 8960, 17152, 25344, 0, 1024, 2048, 3072, 265216, 75776, 1073741824, 1073741824, 65536, 3072
recA 2048, 1536, 512, 0, 0, 768, 768, 5455872, 5505024, 12658624, 12681216, 12655232, 9, 11091968, 11059200, 7077888, 1573632, 327680, 768, 8960, 17152, 25344, 0, 1024, 2048, 3072, 272384, 77824, 1073741824, 1073741824, 65536, 3072
recA 2944, 1792, 768, 0, 0, 768, 768, 5529600, 5578752, 12659648, 12697600, 12656256, 9, 11100160, 11067392, 8257536, 1835776, 327680, 768, 8960, 17152, 25344, 0, 1024, 2048, 3072, 279552, 79872, 1073741824, 1073741824, 65536, 3072
recA 384, 1152, 128, 0, 0, 896, 896, 598016, 643072, 12591048, 12582912, 12587656, 1, 10555392, 10522624, 0, 896, 360448, 896, 9088, 17280, 25472, 0, 1024, 2048, 3072, 286720, 81920, 1073741824, 1073741824, 81920, 3584
recA 1280, 1408, 384, 0, 0, 896, 896, 671744, 716800, 12592072, 12599296, 12588680, 1, 10563584, 10530816, 1179648, 263040, 360448, 896, 9088, 17280, 25472, 0, 1024, 2048, 3072, 293888, 83968, 1073741824, 1073741824, 81920, 3584
recA 2176, 1664, 640, 0, 0, 896, 896, 745472, 790528, 12593096, 12615680, 12589704, 1, 10571776, 10539008, 2359296, 525184, 360448, 896, 9088, 17280, 25472, 0, 1024, 2048, 3072, 301056, 86016, 1073741824, 1073741824, 81920, 3584
recA 3072, 1920, 896, 0, 0, 896, 896, 819200, 864256, 12594120, 12632064, 12590728, 1, 10579968, 10547200, 3538944, 787328, 360448, 896, 9088, 17280, 25472, 0, 1024, 2048, 3072, 308224, 88064, 1073741824, 1073741824, 81920, 3584
recA 384, 1152, 128, 0, 0, 896, 896, 5316608, 5361664, 12656584, 12648448, 12653192, 9, 11079680, 11046912, 4718592, 1049472, 360448, 896, 9088, 17280, 25472, 0, 1024, 2048, 3072, 315392, 90112, 1073741824, 1073741824, 81920, 3584
recA 1280, 1408, 384, 0, 0, 896, 896, 5390336, 5435392, 12657608, 12664832, 12654216, 9, 11087872, 11055104, 5898240, 1311616, 360448, 896, 9088, 17280, 25472, 0, 1024, 2048, 3072, 322560, 92160, 1073741824, 1073741824, 81920, 3584
recA 2176, 1664, 640, 0, 0, 896, 896, 5464064, 5509120, 12658632, 12681216, 12655240, 9, 11096064, 11063296, 7077888, 1573760, 360448, 896, 9088, 17280, 25472, 0, 1024, 2048, 3072, 329728, 94208, 1073741824, 1073741824, 81920, 3584
recA 3072, 1920, 896, 0, 0, 896, 896, 5537792, 5582848, 12659656, 12697600, 12656264, 9, 11104256, 11071488, 8257536, 1835904, 360448, 896, 9088, 17280, 25472, 0, 1024, 2048, 3072, 336896, 96256, 1073741824, 1073741824, 81920, 3584
recB 0, 512, 768, 0, 0, 0, 0, 589824, 638976, 12591056, 12582912, 12587664, 1, 10551296, 10518528, 0, 0, 393216, 0, 8192, 16384, 24576, 0, 1024, 2048, 3072, 344064, 98304, 1073741824, 1073741824, 98304, 0
recB 896, 1408, 1664, 0, 0, 0, 0, 663552, 712704, 12592080, 12599296, 12588688, 1, 10559488, 10526720, 1179648, 262144, 393216, 0, 8192, 16384, 24576, 0, 1024, 2048, 3072, 351232, 100352, 1073741824, 1073741824, 98304, 0
recB 1792, 2304, 2560, 0, 0, 0, 0, 737280, 786432, 12593104, 12615680, 12589712, 1, 10567680, 10534912, 2359296, 524288, 393216, 0, 8192, 16384, 24576, 0, 1024, 2048, 3072, 358400, 102400, 1073741824, 1073741824, 98304, 0
recB 2688, 3200, 3456, 0, 0, 0, 0, 811008, 860160, 12594128, 12632064, 12590736, 1, 10575872, 10543104, 3538944, 786432, 393216, 0, 8192, 16384, 24576, 0, 1024, 2048, 3072, 365568, 104448, 1073741824, 1073741824, 98304, 0
recB 0, 512, 768, 0, 0, 0, 0, 5308416, 5357568, 12656592, 12648448, 12653200, 9, 11075584, 11042816, 4718592, 1048576, 393216, 0, 8192, 16384, 24576, 0, 1024, 2048, 3072, 372736, 106496, 1073741824, 1073741824, 98304, 0
recB 896, 1408, 1664, 0, 0, 0, 0, 5382144, 5431296, 12657616, 12664832, 12654224, 9, 11083776, 11051008, 5898240, 1310720, 393216, 0, 8192, 16384, 24576, 0, 1024, 2048, 3072, 379904, 108544, 1073741824, 1073741824, 98304, 0
recB 1792, 2304, 2560, 0, 0, 0, 0, 5455872, 5505024, 12658640, 12681216, 12655248, 9, 11091968, 11059200, 7077888, 1572864, 393216, 0, 8192, 16384, 24576, 0, 1024, 2048, 3072, 387072, 110592, 1073741824, 1073741824, 98304, 0
recB 2688, 3200, 3456, 0, 0, 0, 0, 5529600, 5578752, 12659664, 12697600, 12656272, 9, 11100160, 11067392, 8257536, 1835008, 393216, 0, 8192, 16384, 24576, 0, 1024, 2048, 3072, 394240, 112640, 1073741824, 1073741824, 98304, 0
recB 128, 640, 832, 0, 0, 128, 128, 598016, 643072, 12591064, 12582912, 12587672, 1, 10555392, 10522624, 0, 128, 425984, 128, 8320, 16512, 24704, 0, 1024, 2048, 3072, 401408, 114688, 1073741824, 1073741824, 114688, 512
recB 1024, 1536, 1728, 0, 0, 128, 128, 671744, 716800, 12592088, 12599296, 12588696, 1, 10563584, 10530816, 1179648, 262272, 425984, 128, 8320, 16512, 24704, 0, 1024, 2048, 3072, 408576, 116736, 1073741824, 1073741824, 114688, 512
recB 1920, 2432, 2624, 0, 0, 128, 128, 745472, 790528, 12593112, 12615680, 12589720, 1, 10571776, 10539008, 2359296, 524416, 425984, 128, 8320, 16512, 24704, 0, 1024, 2048, 3072, 415744, 118784, 1073741824, 1073741824, 114688, 512
recB 2816, 3328, 3520, 0, 0, 128, 128, 819200, 864256, 12594136, 12632064, 12590744, 1, 10579968, 10547200, 3538944, 786560, 425984, 128, 8320, 16512, 24704, 0, 1024, 2048, 3072, 422912, 120832, 1073741824, 1073741824, 114688, 512
recB 128, 640, 832, 0, 0, 128, 128, 5316608, 5361664, 12656600, 12648448, 12653208, 9, 11079680, 11046912, 4718592, 1048704, 425984, 128, 8320, 16512, 24704, 0, 1024, 2048, 3072, 430080, 122880, 1073741824, 1073741824, 114688, 512
recB 1024, 1536, 1728, 0, 0, 128, 128, 5390336, 5435392, 12657624, 12664832, 12654232, 9, 11087872, 11055104, 5898240, 1310848, 425984, 128, 8320, 16512, 24704, 0, 1024, 2048, 3072, 437248, 124928, 1073741824, 1073741824, 114688, 512
recB 1920, 2432, 2624, 0, 0, 128, 128, 5464064, 5509120, 12658648, 12681216, 12655256, 9, 11096064, 11063296, 7077888, 1572992, 425984, 128, 8320, 16512, 24704, 0, 1024, 2048, 3072, 444416, 126976, 1073741824, 1073741824, 114688, 512
recB 2816, 3328, 3520, 0, 0, 128, 128, 5537792, 5582848, 12659672, 12697600, 12656280, 9, 11104256, 11071488, 8257536, 1835136, 425984, 128, 8320, 16512, 24704, 0, 1024, 2048, 3072, 451584, 129024, 1073741824, 1073741824, 114688, 512
recA 256, 1024, 0, 0, 0, 256, 256, 1179648, 1228800, 12599232, 12587008, 12595840, 2, 10616832, 10584064, 294912, 65792, 655360, 8448, 16640, 24832, 256, 1024, 2048, 3072, 0, 458752, 131072, 12599296, 8, 131072, 1024
recA 1152, 1280, 256, 0, 0, 256, 256, 1253376, 1302528, 12600256, 12603392, 12596864, 2, 10625024, 10592256, 1474560, 327936, 655360, 8448, 16640, 24832, 256, 1024, 2048, 3072, 0, 465920, 133120, 1073741824, 1073741824, 131072, 1024
recA 2048, 1536, 512, 0, 0, 256, 256, 1327104, 1376256, 12601280, 12619776, 12597888, 2, 10633216, 10600448, 2654208, 590080, 655360, 8448, 16640, 24832, 256, 1024, 2048, 3072, 0, 473088, 135168, 1073741824, 1073741824, 131072, 1024
recA 2944, 1792, 768, 0, 0, 256, 256, 1400832, 1449984, 12602304, 12636160, 12598912, 2, 10641408, 10608640, 3833856, 852224, 655360, 8448, 16640, 24832, 256, 1024, 2048, 3072, 0, 480256, 137216, 1073741824, 1073741824, 131072, 1024
recA 256, 1024, 0, 0, 0, 256, 256, 5898240, 5947392, 12664768, 12652544, 12661376, 10, 11141120, 11108352, 5013504, 1114368, 655360, 8448, 16640, 24832, 256, 1024, 2048, 3072, 0, 487424, 139264, 12664832, 40, 131072, 1024
recA 1152, 1280, 256, 0, 0, 256, 256, 5971968, 6021120, 12665792, 12668928, 12662400, 10, 11149312, 11116544, 6193152, 1376512, 655360, 8448, 16640, 24832, 256, 1024, 2048, 3072, 0, 494592, 141312, 1073741824, 1073741824, 131072, 1024
recA 2048, 1536, 512, 0, 0, 256, 256, 6045696, 6094848, 12666816, 12685312, 12663424, 10, 11157504, 11124736, 7372800, 1638656, 655360, 8448, 16640, 24832, 256, 1024, 2048, 3072, 0, 501760, 143360, 1073741824, 1073741824, 131072, 1024
recA 2944, 1792, 768, 0, 0, 256, 256, 6119424, 6168576, 12667840, 12701696, 12664448, 10, 11165696, 11132928, 8552448, 1900800, 655360, 8448, 16640, 24832, 256, 1024, 2048, 3072, 0, 508928, 145408, 1073741824, 1073741824, 131072, 1024
recA 384, 1152, 128, 0, 0, 384, 384, 1187840, 1232896, 12599240, 12587008, 12595848, 2, 10620928, 10588160, 294912, 65920, 688128, 8576, 16768, 24960, 384, 1024, 2048, 3072, 0, 516096, 147456, 1073741824, 1073741824, 147456, 1536
recA 1280, 1408, 384, 0, 0, 384, 384, 1261568, 1306624, 12600264, 12603392, 12596872, 2, 10629120, 10596352, 1474560, 328064, 688128, 8576, 16768, 24960, 384, 1024, 2048, 3072, 0, 523264, 149504, 1073741824, 1073741824, 147456, 1536
recA 2176, 1664, 640, 0, 0, 384, 384, 1335296, 1380352, 12601288, 12619776, 12597896, 2, 10637312, 10604544, 2654208, 590208, 688128, 8576, 16768, 24960, 384, 1024, 2048, 3072, 0, 530432, 151552, 1073741824, 1073741824, 147456, 1536
recA 3072, 1920, 896, 0, 0, 384, 384, 1409024, 1454080, 12602312, 12636160, 12598920, 2, 10645504, 10612736, 3833856, 852352, 688128, 8576, 16768, 24960, 384, 1024, 2048, 3072, 0, 537600, 153600, 1073741824, 1073741824, 147456, 1536
recA 384, 1152, 128, 0, 0, 384, 384, 5906432, 5951488, 12664776, 12652544, 12661384, 10, 11145216, 11112448, 5013504, 1114496, 688128, 8576, 16768, 24960, 384, 1024, 2048, 3072, 0, 544768, 155648, 1073741824, 1073741824, 147456, 1536
recA 1280, 1408, 384, 0, 0, 384, 384, 5980160, 6025216, 12665800, 12668928, 12662408, 10, 11153408, 11120640, 6193152, 1376640, 688128, 8576, 16768, 24960, 384, 1024, 2048, 3072, 0, 551936, 157696, 1073741824, 1073741824, 147456, 1536
recA 2176, 1664, 640, 0, 0, 384, 384, 6053888, 6098944, 12666824, 12685312, 12663432, 10, 11161600, 11128832, 7372800, 1638784, 688128, 8576, 16768, 24960, 384, 1024, 2048, 3072, 0, 559104, 159744, 1073741824, 1073741824, 147456, 1536
recA 3072, 1920, 896, 0, 0, 384, 384, 6127616, 6172672, 12667848, 12701696, 12664456, 10, 11169792, 11137024, 8552448, 1900928, 688128, 8576, 16768, 24960, 384, 1024, 2048, 3072, 0, 566272, 161792, 1073741824, 1073741824, 147456, 1536
recB 0, 512, 768, 0, 0, 512, 512, 1179648, 1228800, 12599248, 12587008, 12595856, 2, 10616832, 10584064, 294912, 66048, 720896, 8704, 16896, 25088, 512, 1024, 2048, 3072, 0, 573440, 163840, 1073741824, 1073741824, 163840, 2048
recB 896, 1408, 1664, 0, 0, 512, 512, 1253376, 1302528, 12600272, 12603392, 12596880, 2, 10625024, 10592256, 1474560, 328192, 720896, 8704, 16896, 25088, 512, 1024, 2048, 3072, 0, 580608, 165888, 1073741824, 1073741824, 163840, 2048
recB 1792, 2304, 2560, 0, 0, 512, 512, 1327104, 1376256, 12601296, 12619776, 12597904, 2, 10633216, 10600448, 2654208, 590336, 720896, 8704, 16896, 25088, 512, 1024, 2048, 3072, 0, 587776, 167936, 1073741824, 1073741824, 163840, 2048
recB 2688, 3200, 3456, 0, 0, 512, 512, 1400832, 1449984, 12602320, 12636160, 12598928, 2, 10641408, 10608640, 3833856, 852480, 720896, 8704, 16896, 25088, 512, 1024, 2048, 3072, 0, 594944, 169984, 1073741824, 1073741824, 163840, 2048
recB 0, 512, 768, 0, 0, 512, 512, 5898240, 5947392, 12664784, 12652544, 12661392, 10, 11141120, 11108352, 5013504, 1114624, 720896, 8704, 16896, 25088, 512, 1024, 2048, 3072, 0, 602112, 172032, 1073741824, 1073741824, 163840, 2048
recB 896, 1408, 1664, 0, 0, 512, 512, 5971968, 6021120, 12665808, 12668928, 12662416, 10, 11149312, 11116544, 6193152, 1376768, 720896, 8704, 16896, 25088, 512, 1024, 2048, 3072, 0, 609280, 174080, 1073741824, 1073741824, 163840, 2048
recB 1792, 2304, 2560, 0, 0, 512, 512, 6045696, 6094848, 12666832, 12685312, 12663440, 10, 11157504, 11124736, 7372800, 1638912, 720896, 8704, 16896, 25088, 512, 1024, 2048, 3072, 0, 616448, 176128, 1073741824, 1073741824, 163840, 2048
recB 2688, 3200, 3456, 0, 0, 512, 512, 6119424, 6168576, 12667856, 12701696, 12664464, 10, 11165696, 11132928, 8552448, 1901056, 720896, 8704, 16896, 25088, 512, 1024, 2048, 3072, 0, 623616, 178176, 1073741824, 1073741824, 163840, 2048
recB 128, 640, 832, 0, 0, 640, 640, 1187840, 1232896, 12599256, 12587008, 12595864, 2, 10620928, 10588160, 294912, 66176, 753664, 8832, 17024, 25216, 640, 1024, 2048, 3072, 0, 630784, 180224, 1073741824, 1073741824, 180224, 2560
recB 1024, 1536, 1728, 0, 0, 640, 640, 1261568, 1306624, 12600280, 12603392, 12596888, 2, 10629120, 10596352, 1474560, 328320, 753664, 8832, 17024, 25216, 640, 1024, 2048, 3072, 0, 637952, 182272, 1073741824, 1073741824, 180224, 2560
recB 1920, 2432, 2624, 0, 0, 640, 640, 1335296, 1380352, 12601304, 12619776, 12597912, 2, 10637312, 10604544, 2654208, 590464, 753664, 8832, 17024, 25216, 640, 1024, 2048, 3072, 0, 645120, 184320, 1073741824, 1073741824, 180224, 2560
recB 2816, 3328, 3520, 0, 0, 640, 640, 1409024, 1454080, 12602328, 12636160, 12598936, 2, 10645504, 10612736, 3833856, 852608, 753664, 8832, 17024, 25216, 640, 1024, 2048, 3072, 0, 652288, 186368, 1073741824, 1073741824, 180224, 2560
recB 128, 640, 832, 0, 0, 640, 640, 5906432, 5951488, 12664792, 12652544, 12661400, 10, 11145216, 11112448, 5013504, 1114752, 753664, 8832, 17024, 25216, 640, 1024, 2048, 3072, 0, 659456, 188416, 1073741824, 1073741824, 180224, 2560
recB 1024, 1536, 1728, 0, 0, 640, 640, 5980160, 6025216, 12665816, 12668928, 12662424, 10, 11153408, 11120640, 6193152, 1376896, 753664, 8832, 17024, 25216, 640, 1024, 2048, 3072, 0, 666624, 190464, 1073741824, 1073741824, 180224, 2560
recB 1920, 2432, 2624, 0, 0, 640, 640, 6053888, 6098944, 12666840, 12685312, 12663448, 10, 11161600, 11128832, 7372800, 1639040, 753664, 8832, 17024, 25216, 640, 1024, 2048, 3072, 0, 673792, 192512, 1073741824, 1073741824, 180224, 2560
recB 2816, 3328, 3520, 0, 0, 640, 640, 6127616, 6172672, 12667864, 12701696, 12664472, 10, 11169792, 11137024, 8552448, 1901184, 753664, 8832, 17024, 25216, 640, 1024, 2048, 3072, 0, 680960, 194560, 1073741824, 1073741824, 180224, 2560
recA 256, 1024, 0, 0, 0, 768, 768, 1769472, 1818624, 12607424, 12587008, 12604032, 3, 10682368, 10649600, 294912, 66304, 786432, 8960, 17152, 25344, 768, 1024, 2048, 3072, 0, 688128, 196608, 12607488, 12, 196608, 3072
recA 1152, 1280, 256, 0, 0, 768, 768, 1843200, 1892352, 12608448, 12603392, 12605056, 3, 10690560, 10657792, 1474560, 328448, 786432, 8960, 17152, 25344, 768, 1024, 2048, 3072, 0, 695296, 198656, 1073741824, 1073741824, 196608, 3072
recA 2048, 1536, 512, 0, 0, 768, 768, 1916928, 1966080, 12609472, 12619776, 12606080, 3, 10698752, 10665984, 2654208, 590592, 786432, 8960, 17152, 25344, 768, 1024, 2048, 3072, 0, 702464, 200704, 1073741824, 1073741824, 196608, 3072
recA 2944, 1792, 768, 0, 0, 768, 768, 1990656, 2039808, 12610496, 12636160, 12607104, 3, 10706944, 10674176, 3833856, 852736, 786432, 8960, 17152, 25344, 768, 1024, 2048, 3072, 0, 709632, 202752, 1073741824, 1073741824, 196608, 3072
recA 256, 1024, 0, 0, 0, 768, 768, 6488064, 6537216, 12672960, 12652544, 12669568, 11, 11206656, 11173888, 5013504, 1114880, 786432, 8960, 17152, 25344, 768, 1024, 2048, 3072, 0, 716800, 204800, 12673024, 44, 196608, 3072
recA 1152, 1280, 256, 0, 0, 768, 768, 6561792, 6610944, 12673984, 12668928, 12670592, 11, 11214848, 11182080, 6193152, 1377024, 786432, 8960, 17152, 25344, 768, 1024, 2048, 3072, 0, 723968, 206848, 1073741824, 1073741824, 196608, 3072
recA 2048, 1536, 512, 0, 0, 768, 768, 6635520, 6684672, 12675008, 12685312, 12671616, 11, 11223040, 11190272, 7372800, 1639168, 786432, 8960, 17152, 25344, 768, 1024, 2048, 3072, 0, 731136, 208896, 1073741824, 1073741824, 196608, 3072
recA 2944, 1792, 768, 0, 0, 768, 768, 6709248, 6758400, 12676032, 12701696, 12672640, 11, 11231232, 11198464, 8552448, 1901312, 786432, 8960, 17152, 25344, 768, 1024, 2048, 3072, 0, 738304, 210944, 1073741824, 1073741824, 196608, 3072
recA 384, 1152, 128, 0, 0, 896, 896, 1777664, 1822720, 12607432, 12587008, 12604040, 3, 10686464, 10653696, 294912, 66432, 819200, 9088, 17280, 25472, 896, 1024, 2048, 3072, 0, 745472, 212992, 1073741824, 1073741824, 212992, 3584
recA 1280, 1408, 384, 0, 0, 896, 896, 1851392, 1896448, 12608456, 12603392, 12605064, 3, 10694656, 10661888, 1474560, 328576, 819200, 9088, 17280, 25472, 896, 1024, 2048, 3072, 0, 752640, 215040, 1073741824, 1073741824, 212992, 3584
recA 2176, 1664, 640, 0, 0, 896, 896, 1925120, 1970176, 12609480, 12619776, 12606088, 3, 10702848, 10670080, 2654208, 590720, 819200, 9088, 17280, 25472, 896, 1024, 2048, 3072, 0, 759808, 217088, 1073741824, 1073741824, 212992, 3584
recA 3072, 1920, 896, 0, 0, 896, 896, 1998848, 2043904, 12610504, 12636160, 12607112, 3, 10711040, 10678272, 3833856, 852864, 819200, 9088, 17280, 25472, 896, 1024, 2048, 3072, 0, 766976, 219136, 1073741824, 1073741824, 212992, 3584
recA 384, 1152, 128, 0, 0, 896, 896, 6496256, 6541312, 12672968, 12652544, 12669576, 11, 11210752, 11177984, 5013504, 1115008, 819200, 9088, 17280, 25472, 896, 1024, 2048, 3072, 0, 774144, 221184, 1073741824, 1073741824, 212992, 3584
recA 1280, 1408, 384, 0, 0, 896, 896, 6569984, 6615040, 12673992, 12668928, 12670600, 11, 11218944, 11186176, 6193152, 1377152, 819200, 9088, 17280, 25472, 896, 1024, 2048, 3072, 0, 781312, 223232, 1073741824, 1073741824, 212992, 3584
recA 2176, 1664, 640, 0, 0, 896, 896, 6643712, 6688768, 12675016, 12685312, 12671624, 11, 11227136, 11194368, 7372800, 1639296, 819200, 9088, 17280, 25472, 896, 1024, 2048, 3072, 0, 788480, 225280, 1073741824, 1073741824, 212992, 3584
recA 3072, 1920, 896, 0, 0, 896, 896, 6717440, 6762496, 12676040, 12701696, 12672648, 11, 11235328, 11202560, 8552448, 1901440, 819200, 9088, 17280, 25472, 896, 1024, 2048, 3072, 0, 795648, 227328, 1073741824, 1073741824, 212992, 3584
recB 0, 512, 768, 0, 0, 0, 0, 1769472, 1818624, 12607440, 12587008, 12604048, 3, 10682368, 10649600, 294912, 65536, 851968, 8192, 16384, 24576, 0, 1024, 2048, 3072, 0, 802816, 229376, 1073741824, 1073741824, 229376, 0
recB 896, 1408, 1664, 0, 0, 0, 0, 1843200, 1892352, 12608464, 12603392, 12605072, 3, 10690560, 10657792, 1474560, 327680, 851968, 8192, 16384, 24576, 0, 1024, 2048, 3072, 0, 809984, 231424, 1073741824, 1073741824, 229376, 0
recB 1792, 2304, 2560, 0, 0, 0, 0, 1916928, 1966080, 12609488, 12619776, 12606096, 3, 10698752, 10665984, 2654208, 589824, 851968, 8192, 16384, 24576, 0, 1024, 2048, 3072, 0, 817152, 233472, 1073741824, 1073741824, 229376, 0
recB 2688, 3200, 3456, 0, 0, 0, 0, 1990656, 2039808, 12610512, 12636160, 12607120, 3, 10706944, 10674176, 3833856, 851968, 851968, 8192, 16384, 24576, 0, 1024, 2048, 3072, 0, 824320, 235520, 1073741824, 1073741824, 229376, 0
recB 0, 512, 768, 0, 0, 0, 0, 6488064, 6537216, 12672976, 12652544, 12669584, 11, 11206656, 11173888, 5013504, 1114112, 851968, 8192, 16384, 24576, 0, 1024, 2048, 3072, 0, 831488, 237568, 1073741824, 1073741824, 229376, 0
recB 896, 1408, 1664, 0, 0, 0, 0, 6561792, 6610944, 12674000, 12668928, 12670608, 11, 11214848, 11182080, 6193152, 1376256, 851968, 8192, 16384, 24576, 0, 1024, 2048, 3072, 0, 838656, 239616, 1073741824, 1073741824, 229376, 0
recB 1792, 2304, 2560, 0, 0, 0, 0, 6635520, 6684672, 12675024, 12685312, 12671632, 11, 11223040, 11190272, 7372800, 1638400, 851968, 8192, 16384, 24576, 0, 1024, 2048, 3072, 0, 845824, 241664, 1073741824, 1073741824, 229376, 0
recB 2688, 3200, 3456, 0, 0, 0, 0, 6709248, 6758400, 12676048, 12701696, 12672656, 11, 11231232, 11198464, 8552448, 1900544, 851968, 8192, 16384, 24576, 0, 1024, 2048, 3072, 0, 852992, 243712, 1073741824, 1073741824, 229376, 0
recB 128, 640, 832, 0, 0, 128, 128, 1777664, 1822720, 12607448, 12587008, 12604056, 3, 10686464, 10653696, 294912, 65664, 884736, 8320, 16512, 24704, 128, 1024, 2048, 3072, 0, 860160, 245760, 1073741824, 1073741824, 245760, 512
recB 1024, 1536, 1728, 0, 0, 128, 128, 1851392, 1896448, 12608472, 12603392, 12605080, 3, 10694656, 10661888, 1474560, 327808, 884736, 8320, 16512, 24704, 128, 1024, 2048, 3072, 0, 867328, 247808, 1073741824, 1073741824, 245760, 512
recB 1920, 2432, 2624, 0, 0, 128, 128, 1925120, 1970176, 12609496, 12619776, 12606104, 3, 10702848, 10670080, 2654208, 589952, 884736, 8320, 16512, 24704, 128, 1024, 2048, 3072, 0, 874496, 249856, 1073741824, 1073741824, 245760, 512
recB 2816, 3328, 3520, 0, 0, 128, 128, 1998848, 2043904, 12610520, 12636160, 12607128, 3, 10711040, 10678272, 3833856, 852096, 884736, 8320, 16512, 24704, 128, 1024, 2048, 3072, 0, 881664, 251904, 1073741824, 1073741824, 245760, 512
recB 128, 640, 832, 0, 0, 128, 128, 6496256, 6541312, 12672984, 12652544, 12669592, 11, 11210752, 11177984, 5013504, 1114240, 884736, 8320, 16512, 24704, 128, 1024, 2048, 3072, 0, 888832, 253952, 1073741824, 1073741824, 245760, 512
recB 1024, 1536, 1728, 0, 0, 128, 128, 6569984, 6615040, 12674008, 12668928, 12670616, 11, 11218944, 11186176, 6193152, 1376384, 884736, 8320, 16512, 24704, 128, 1024, 2048, 3072, 0, 896000, 256000, 1073741824, 1073741824, 245760, 512
recB 1920, 2432, 2624, 0, 0, 128, 128, 6643712, 6688768, 12675032, 12685312, 12671640, 11, 11227136, 11194368, 7372800, 1638528, 884736, 8320, 16512, 24704, 128, 1024, 2048, 3072, 0, 903168, 258048, 1073741824, 1073741824, 245760, 512
recB 2816, 3328, 3520, 0, 0, 128, 128, 6717440, 6762496, 12676056, 12701696, 12672664, 11, 11235328, 11202560, 8552448, 1900672, 884736, 8320, 16512, 24704, 128, 1024, 2048, 3072, 0, 910336, 260096, 1073741824, 1073741824, 245760, 512
recA 256, 1024, 0, 0, 0, 256, 256, 2359296, 2408448, 12615616, 12591104, 12612224, 4, 10747904, 10715136, 589824, 131328, 1114112, 16640, 24832, 256, 8448, 2048, 3072, 0, 1024, 917504, 262144, 12615680, 16, 262144, 1024
recA 1152, 1280, 256, 0, 0, 256, 256, 2433024, 2482176, 12616640, 12607488, 12613248, 4, 10756096, 10723328, 1769472, 393472, 1114112, 16640, 24832, 256, 8448, 2048, 3072, 0, 1024, 924672, 264192, 1073741824, 1073741824, 262144, 1024
recA 2048, 1536, 512, 0, 0, 256, 256, 2506752, 2555904, 12617664, 12623872, 12614272, 4, 10764288, 10731520, 2949120, 655616, 1114112, 16640, 24832, 256, 8448, 2048, 3072, 0, 1024, 931840, 266240, 1073741824, 1073741824, 262144, 1024
recA 2944, 1792, 768, 0, 0, 256, 256, 2580480, 2629632, 12618688, 12640256, 12615296, 4, 10772480, 10739712, 4128768, 917760, 1114112, 16640, 24832, 256, 8448, 2048, 3072, 0, 1024, 939008, 268288, 1073741824, 1073741824, 262144, 1024
recA 256, 1024, 0, 0, 0, 256, 256, 7077888, 7127040, 12681152, 12656640, 12677760, 12, 11272192, 11239424, 5308416, 1179904, 1114112, 16640, 24832, 256, 8448, 2048, 3072, 0, 1024, 946176, 270336, 12681216, 48, 262144, 1024
recA 1152, 1280, 256, 0, 0, 256, 256, 7151616, 7200768, 12682176, 12673024, 12678784, 12, 11280384, 11247616, 6488064, 1442048, 1114112, 16640, 24832, 256, 8448, 2048, 3072, 0, 1024, 953344, 272384, 1073741824, 1073741824, 262144, 1024
recA 2048, 1536, 512, 0, 0, 256, 256, 7225344, 7274496, 12683200, 12689408, 12679808, 12, 11288576, 11255808, 7667712, 1704192, 1114112, 16640, 24832, 256, 8448, 2048, 3072, 0, 1024, 960512, 274432, 1073741824, 1073741824, 262144, 1024
recA 2944, 1792, 768, 0, 0, 256, 256, 7299072, 7348224, 12684224, 12705792, 12680832, 12, 11296768, 11264000, 8847360, 1966336, 1114112, 16640, 24832, 256, 8448, 2048, 3072, 0, 1024, 967680, 276480, 1073741824, 1073741824, 262144, 1024
recA 384, 1152, 128, 0, 0, 384, 384, 2367488, 2412544, 12615624, 12591104, 12612232, 4, 10752000, 10719232, 589824, 131456, 1146880, 16768, 24960, 384, 8576, 2048, 3072, 0, 1024, 974848, 278528, 1073741824, 1073741824, 278528, 1536
recA 1280, 1408, 384, 0, 0, 384, 384, 2441216, 2486272, 12616648, 12607488, 12613256, 4, 10760192, 10727424, 1769472, 393600, 1146880, 16768, 24960, 384, 8576, 2048, 3072, 0, 1024, 982016, 280576, 1073741824, 1073741824, 278528, 1536
recA 2176, 1664, 640, 0, 0, 384, 384, 2514944, 2560000, 12617672, 12623872, 12614280, 4, 10768384, 10735616, 2949120, 655744, 1146880, 16768, 24960, 384, 8576, 2048, 3072, 0, 1024, 989184, 282624, 1073741824, 1073741824, 278528, 1536
recA 3072, 1920, 896, 0, 0, 384, 384, 2588672, 2633728, 12618696, 12640256, 12615304, 4, 10776576, 10743808, 4128768, 917888, 1146880, 16768, 24960, 384, 8576, 2048, 3072, 0, 1024, 996352, 284672, 1073741824, 1073741824, 278528, 1536
recA 384, 1152, 128, 0, 0, 384, 384, 7086080, 7131136, 12681160, 12656640, 12677768, 12, 11276288, 11243520, 5308416, 1180032, 1146880, 16768, 24960, 384, 8576, 2048, 3072, 0, 1024, 1003520, 286720, 1073741824, 1073741824, 278528, 1536
recA 1280, 1408, 384, 0, 0, 384, 384, 7159808, 7204864, 12682184, 12673024, 12678792, 12, 11284480, 11251712, 6488064, 1442176, 1146880, 16768, 24960, 384, 8576, 2048, 3072, 0, 1024, 1010688, 288768, 1073741824, 1073741824, 278528, 1536
recA 2176, 1664, 640, 0, 0, 384, 384, 7233536, 7278592, 12683208, 12689408, 12679816, 12, 11292672, 11259904, 7667712, 1704320, 1146880, 16768, 24960, 384, 8576, 2048, 3072, 0, 1024, 1017856, 290816, 1073741824, 1073741824, 278528, 1536
recA 3072, 1920, 896, 0, 0, 384, 384, 7307264, 7352320, 12684232, 12705792, 12680840, 12, 11300864, 11268096, 8847360, 1966464, 1146880, 16768, 24960, 384, 8576, 2048, 3072, 0, 1024, 1025024, 292864, 1073741824, 1073741824, 278528, 1536
recB 0, 512, 768, 0, 0, 512, 512, 2359296, 2408448, 12615632, 12591104, 12612240, 4, 10747904, 10715136, 589824, 131584, 1179648, 16896, 25088, 512, 8704, 2048, 3072, 0, 1024, 1032192, 294912, 1073741824, 1073741824, 294912, 2048
recB 896, 1408, 1664, 0, 0, 512, 512, 2433024, 2482176, 12616656, 12607488, 12613264, 4, 10756096, 10723328, 1769472, 393728, 1179648, 16896, 25088, 512, 8704, 2048, 3072, 0, 1024, 1039360, 296960, 1073741824, 1073741824, 294912, 2048
recB 1792, 2304, 2560, 0, 0, 512, 512, 2506752, 2555904, 12617680, 12623872, 12614288, 4, 10764288, 10731520, 2949120, 655872, 1179648, 16896, 25088, 512, 8704, 2048, 3072, 0, 1024, 1046528, 299008, 1073741824, 1073741824, 294912, 2048
recB 2688, 3200, 3456, 0, 0, 512, 512, 2580480, 2629632, 12618704, 12640256, 12615312, 4, 10772480, 10739712, 4128768, 918016, 1179648, 16896, 25088, 512, 8704, 2048, 3072, 0, 1024, 1053696, 301056, 1073741824, 1073741824, 294912, 2048
recB 0, 512, 768, 0, 0, 512, 512, 7077888, 7127040, 12681168, 12656640, 12677776, 12, 11272192, 11239424, 5308416, 1180160, 1179648, 16896, 25088, 512, 8704, 2048, 3072, 0, 1024, 1060864, 303104, 1073741824, 1073741824, 294912, 2048
recB 896, 1408, 1664, 0, 0, 512, 512, 7151616, 7200768, 12682192, 12673024, 12678800, 12, 11280384, 11247616, 6488064, 1442304, 1179648, 16896, 25088, 512, 8704, 2048, 3072, 0, 1024, 1068032, 305152, 1073741824, 1073741824, 294912, 2048
recB 1792, 2304, 2560, 0, 0, 512, 512, 7225344, 7274496, 12683216, 12689408, 12679824, 12, 11288576, 11255808, 7667712, 1704448, 1179648, 16896, 25088, 512, 8704, 2048, 3072, 0, 1024, 1075200, 307200, 1073741824, 1073741824, 294912, 2048
recB 2688, 3200, 3456, 0, 0, 512, 512, 7299072, 7348224, 12684240, 12705792, 12680848, 12, 11296768, 11264000, 8847360, 1966592, 1179648, 16896, 25088, 512, 8704, 2048, 3072, 0, 1024, 1082368, 309248, 1073741824, 1073741824, 294912, 2048
recB 128, 640, 832, 0, 0, 640, 640, 2367488, 2412544, 12615640, 12591104, 12612248, 4, 10752000, 10719232, 589824, 131712, 1212416, 17024, 25216, 640, 8832, 2048, 3072, 0, 1024, 1089536, 311296, 1073741824, 1073741824, 311296, 2560
recB 1024, 1536, 1728, 0, 0, 640, 640, 2441216, 2486272, 12616664, 12607488, 12613272, 4, 10760192, 10727424, 1769472, 393856, 1212416, 17024, 25216, 640, 8832, 2048, 3072, 0, 1024, 1096704, 313344, 1073741824, 1073741824, 311296, 2560
recB 1920, 2432, 2624, 0, 0, 640, 640, 2514944, 2560000, 12617688, 12623872, 12614296, 4, 10768384, 10735616, 2949120, 656000, 1212416, 17024, 25216, 640, 8832, 2048, 3072, 0, 1024, 1103872, 315392, 1073741824, 1073741824, 311296, 2560
recB 2816, 3328, 3520, 0, 0, 640, 640, 2588672, 2633728, 12618712, 12640256, 12615320, 4, 10776576, 10743808, 4128768, 918144, 1212416, 17024, 25216, 640, 8832, 2048, 3072, 0, 1024, 1111040, 317440, 1073741824, 1073741824, 311296, 2560
recB 128, 640, 832, 0, 0, 640, 640, 7086080, 7131136, 12681176, 12656640, 12677784, 12, 11276288, 11243520, 5308416, 1180288, 1212416, 17024, 25216, 640, 8832, 2048, 3072, 0, 1024, 1118208, 319488, 1073741824, 1073741824, 311296, 2560
recB 1024, 1536, 1728, 0, 0, 640, 640, 7159808, 7204864, 12682200, 12673024, 12678808, 12, 11284480, 11251712, 6488064, 1442432, 1212416, 17024, 25216, 640, 8832, 2048, 3072, 0, 1024, 1125376, 321536, 1073741824, 1073741824, 311296, 2560
recB 1920, 2432, 2624, 0, 0, 640, 640, 7233536, 7278592, 12683224, 12689408, 12679832, 12, 11292672, 11259904, 7667712, 1704576, 1212416, 17024, 25216, 640, 8832, 2048, 3072, 0, 1024, 1132544, 323584, 1073741824, 1073741824, 311296, 2560
recB 2816, 3328, 3520, 0, 0, 640, 640, 7307264, 7352320, 12684248, 12705792, 12680856, 12, 11300864, 11268096, 8847360, 1966720, 1212416, 17024, 25216, 640, 8832, 2048, 3072, 0, 1024, 1139712, 325632, 1073741824, 1073741824, 311296, 2560
recA 256, 1024, 0, 0, 0, 768, 768, 2949120, 2998272, 12623808, 12591104, 12620416, 5, 10813440, 10780672, 589824, 131840, 1245184, 17152, 25344, 768, 8960, 2048, 3072, 0, 1024, 1146880, 327680, 12623872, 20, 327680, 3072
recA 1152, 1280, 256, 0, 0, 768, 768, 3022848, 3072000, 12624832, 12607488, 12621440, 5, 10821632, 10788864, 1769472, 393984, 1245184, 17152, 25344, 768, 8960, 2048, 3072, 0, 1024, 1154048, 329728, 1073741824, 1073741824, 327680, 3072
recA 2048, 1536, 512, 0, 0, 768, 768, 3096576, 3145728, 12625856, 12623872, 12622464, 5, 10829824, 10797056, 2949120, 656128, 1245184, 17152, 25344, 768, 8960, 2048, 3072, 0, 1024, 1161216, 331776, 1073741824, 1073741824, 327680, 3072
recA 2944, 1792, 768, 0, 0, 768, 768, 3170304, 3219456, 12626880, 12640256, 12623488, 5, 10838016, 10805248, 4128768, 918272, 1245184, 17152, 25344, 768, 8960, 2048, 3072, 0, 1024, 1168384, 333824, 1073741824, 1073741824, 327680, 3072
recA 256, 1024, 0, 0, 0, 768, 768, 7667712, 7716864, 12689344, 12656640, 12685952, 13, 11337728, 11304960, 5308416, 1180416, 1245184, 17152, 25344, 768, 8960, 2048, 3072, 0, 1024, 1175552, 335872, 12689408, 52, 327680, 3072
recA 1152, 1280, 256, 0, 0, 768, 768, 7741440, 7790592, 12690368, 12673024, 12686976, 13, 11345920, 11313152, 6488064, 1442560, 1245184, 17152, 25344, 768, 8960, 2048, 3072, 0, 1024, 1182720, 337920, 1073741824, 1073741824, 327680, 3072
recA 2048, 1536, 512, 0, 0, 768, 768, 7815168, 7864320, 12691392, 12689408, 12688000, 13, 11354112, 11321344, 7667712, 1704704, 1245184, 17152, 25344, 768, 8960, 2048, 3072, 0, 1024, 1189888, 339968, 1073741824, 1073741824, 327680, 3072
recA 2944, 1792, 768, 0, 0, 768, 768, 7888896, 7938048, 12692416, 12705792, 12689024, 13, 11362304, 11329536, 8847360, 1966848, 1245184, 17152, 25344, 768, 8960, 2048, 3072, 0, 1024, 1197056, 342016, 1073741824, 1073741824, 327680, 3072
recA 384, 1152, 128, 0, 0, 896, 896, 2957312, 3002368, 12623816, 12591104, 12620424, 5, 10817536, 10784768, 589824, 131968, 1277952, 17280, 25472, 896, 9088, 2048, 3072, 0, 1024, 1204224, 344064, 1073741824, 1073741824, 344064, 3584
recA 1280, 1408, 384, 0, 0, 896, 896, 3031040, 3076096, 12624840, 12607488, 12621448, 5, 10825728, 10792960, 1769472, 394112, 1277952, 17280, 25472, 896, 9088, 2048, 3072, 0, 1024, 1211392, 346112, 1073741824, 1073741824, 344064, 3584
recA 2176, 1664, 640, 0, 0, 896, 896, 3104768, 3149824, 12625864, 12623872, 12622472, 5, 10833920, 10801152, 2949120, 656256, 1277952, 17280, 25472, 896, 9088, 2048, 3072, 0, 1024, 1218560, 348160, 1073741824, 1073741824, 344064, 3584
recA 3072, 1920, 896, 0, 0, 896, 896, 3178496, 3223552, 12626888, 12640256, 12623496, 5, 10842112, 10809344, 4128768, 918400, 1277952, 17280, 25472, 896, 9088, 2048, 3072, 0, 1024, 1225728, 350208, 1073741824, 1073741824, 344064, 3584
recA 384, 1152, 128, 0, 0, 896, 896, 7675904, 7720960, 12689352, 12656640, 12685960, 13, 11341824, 11309056, 5308416, 1180544, 1277952, 17280, 25472, 896, 9088, 2048, 3072, 0, 1024, 1232896, 352256, 1073741824, 1073741824, 344064, 3584
recA 1280, 1408, 384, 0, 0, 896, 896, 7749632, 7794688, 12690376, 12673024, 12686984, 13, 11350016, 11317248, 6488064, 1442688, 1277952, 17280, 25472, 896, 9088, 2048, 3072, 0, 1024, 1240064, 354304, 1073741824, 1073741824, 344064, 3584
recA 2176, 1664, 640, 0, 0, 896, 896, 7823360, 7868416, 12691400, 12689408, 12688008, 13, 11358208, 11325440, 7667712, 1704832, 1277952, 17280, 25472, 896, 9088, 2048, 3072, 0, 1024, 1247232, 356352, 1073741824, 1073741824, 344064, 3584
recA 3072, 1920, 896, 0, 0, 896, 896, 7897088, 7942144, 12692424, 12705792, 12689032, 13, 11366400, 11333632, 8847360, 1966976, 1277952, 17280, 25472, 896, 9088, 2048, 3072, 0, 1024, 1254400, 358400, 1073741824, 1073741824, 344064, 3584
recB 0, 512, 768, 0, 0, 0, 0, 2949120, 2998272, 12623824, 12591104, 12620432, 5, 10813440, 10780672, 589824, 131072, 1310720, 16384, 24576, 0, 8192, 2048, 3072, 0, 1024, 1261568, 360448, 1073741824, 1073741824, 360448, 0
recB 896, 1408, 1664, 0, 0, 0, 0, 3022848, 3072000, 12624848, 12607488, 12621456, 5, 10821632, 10788864, 1769472, 393216, 1310720, 16384, 24576, 0, 8192, 2048, 3072, 0, 1024, 1268736, 362496, 1073741824, 1073741824, 360448, 0
recB 1792, 2304, 2560, 0, 0, 0, 0, 3096576, 3145728, 12625872, 12623872, 12622480, 5, 10829824, 10797056, 2949120, 655360, 1310720, 16384, 24576, 0, 8192, 2048, 3072, 0, 1024, 1275904, 364544, 1073741824, 1073741824, 360448, 0
recB 2688, 3200, 3456, 0, 0, 0, 0, 3170304, 3219456, 12626896, 12640256, 12623504, 5, 10838016, 10805248, 4128768, 917504, 1310720, 16384, 24576, 0, 8192, 2048, 3072, 0, 1024, 1283072, 366592, 1073741824, 1073741824, 360448, 0
recB 0, 512, 768, 0, 0, 0, 0, 7667712, 7716864, 12689360, 12656640, 12685968, 13, 11337728, 11304960, 5308416, 1179648, 1310720, 16384, 24576, 0, 8192, 2048, 3072, 0, 1024, 1290240, 368640, 1073741824, 1073741824, 360448, 0
recB 896, 1408, 1664, 0, 0, 0, 0, 7741440, 7790592, 12690384, 12673024, 12686992, 13, 11345920, 11313152, 6488064, 1441792, 1310720, 16384, 24576, 0, 8192, 2048, 3072, 0, 1024, 1297408, 370688, 1073741824, 1073741824, 360448, 0
recB 1792, 2304, 2560, 0, 0, 0, 0, 7815168, 7864320, 12691408, 12689408, 12688016, 13, 11354112, 11321344, 7667712, 1703936, 1310720, 16384, 24576, 0, 8192, 2048, 3072, 0, 1024, 1304576, 372736, 1073741824, 1073741824, 360448, 0
recB 2688, 3200, 3456, 0, 0, 0, 0, 7888896, 7938048, 12692432, 12705792, 12689040, 13, 11362304, 11329536, 8847360, 1966080, 1310720, 16384, 24576, 0, 8192, 2048, 3072, 0, 1024, 1311744, 374784, 1073741824, 1073741824, 360448, 0
recB 128, 640, 832, 0, 0, 128, 128, 2957312, 3002368, 12623832, 12591104, 12620440, 5, 10817536, 10784768, 589824, 131200, 1343488, 16512, 24704, 128, 8320, 2048, 3072, 0, 1024, 1318912, 376832, 1073741824, 1073741824, 376832, 512
recB 1024, 1536, 1728, 0, 0, 128, 128, 3031040, 3076096, 12624856, 12607488, 12621464, 5, 10825728, 10792960, 1769472, 393344, 1343488, 16512, 24704, 128, 8320, 2048, 3072, 0, 1024, 1326080, 378880, 1073741824, 1073741824, 376832, 512
recB 1920, 2432, 2624, 0, 0, 128, 128, 3104768, 3149824, 12625880, 12623872, 12622488, 5, 10833920, 10801152, 2949120, 655488, 1343488, 16512, 24704, 128, 8320, 2048, 3072, 0, 1024, 1333248, 380928, 1073741824, 1073741824, 376832, 512
recB 2816, 3328, 3520, 0, 0, 128, 128, 3178496, 3223552, 12626904, 12640256, 12623512, 5, 10842112, 10809344, 4128768, 917632, 1343488, 16512, 24704, 128, 8320, 2048, 3072, 0, 1024, 1340416, 382976, 1073741824, 1073741824, 376832, 512
recB 128, 640, 832, 0, 0, 128, 128, 7675904, 7720960, 12689368, 12656640, 12685976, 13, 11341824, 11309056, 5308416, 1179776, 1343488, 16512, 24704, 128, 8320, 2048, 3072, 0, 1024, 1347584, 385024, 1073741824, 1073741824, 376832, 512
recB 1024, 1536, 1728, 0, 0, 128, 128, 7749632, 7794688, 12690392, 12673024, 12687000, 13, 11350016, 11317248, 6488064, 1441920, 1343488, 16512, 24704, 128, 8320, 2048, 3072, 0, 1024, 1354752, 387072, 1073741824, 1073741824, 376832, 512
recB 1920, 2432, 2624, 0, 0, 128, 128, 7823360, 7868416, 12691416, 12689408, 12688024, 13, 11358208, 11325440, 7667712, 1704064, 1343488, 16512, 24704, 128, 8320, 2048, 3072, 0, 1024, 1361920, 389120, 1073741824, 1073741824, 376832, 512
recB 2816, 3328, 3520, 0, 0, 128, 128, 7897088, 7942144, 12692440, 12705792, 12689048, 13, 11366400, 11333632, 8847360, 1966208, 1343488, 16512, 24704, 128, 8320, 2048, 3072, 0, 1024, 1369088, 391168, 1073741824, 1073741824, 376832, 512
recA 256, 1024, 0, 0, 0, 256, 256, 3538944, 3588096, 12632000, 12595200, 12628608, 6, 10878976, 10846208, 884736, 196864, 1572864, 24832, 256, 8448, 16640, 3072, 0, 1024, 2048, 1376256, 393216, 12632064, 24, 393216, 1024
recA 1152, 1280, 256, 0, 0, 256, 256, 3612672, 3661824, 12633024, 12611584, 12629632, 6, 10887168, 10854400, 2064384, 459008, 1572864, 24832, 256, 8448, 16640, 3072, 0, 1024, 2048, 1383424, 395264, 1073741824, 1073741824, 393216, 1024
recA 2048, 1536, 512, 0, 0, 256, 256, 3686400, 3735552, 12634048, 12627968, 12630656, 6, 10895360, 10862592, 3244032, 721152, 1572864, 24832, 256, 8448, 16640, 3072, 0, 1024, 2048, 1390592, 397312, 1073741824, 1073741824, 393216, 1024
recA 2944, 1792, 768, 0, 0, 256, 256, 3760128, 3809280, 12635072, 12644352, 12631680, 6, 10903552, 10870784, 4423680, 983296, 1572864, 24832, 256, 8448, 16640, 3072, 0, 1024, 2048, 1397760, 399360, 1073741824, 1073741824, 393216, 1024
recA 256, 1024, 0, 0, 0, 256, 256, 8257536, 8306688, 12697536, 12660736, 12694144, 14, 11403264, 11370496, 5603328, 1245440, 1572864, 24832, 256, 8448, 16640, 3072, 0, 1024, 2048, 1404928, 401408, 12697600, 56, 393216, 1024
recA 1152, 1280, 256, 0, 0, 256, 256, 8331264, 8380416, 12698560, 12677120, 12695168, 14, 11411456, 11378688, 6782976, 1507584, 1572864, 24832, 256, 8448, 16640, 3072, 0, 1024, 2048, 1412096, 403456, 1073741824, 1073741824, 393216, 1024
recA 2048, 1536, 512, 0, 0, 256, 256, 8404992, 8454144, 12699584, 12693504, 12696192, 14, 11419648, 11386880, 7962624, 1769728, 1572864, 24832, 256, 8448, 16640, 3072, 0, 1024, 2048, 1419264, 405504, 1073741824, 1073741824, 393216, 1024
recA 2944, 1792, 768, 0, 0, 256, 256, 8478720, 8527872, 12700608, 12709888, 12697216, 14, 11427840, 11395072, 9142272, 2031872, 1572864, 24832, 256, 8448, 16640, 3072, 0, 1024, 2048, 1426432, 407552, 1073741824, 1073741824, 393216, 1024
recA 384, 1152, 128, 0, 0, 384, 384, 3547136, 3592192, 12632008, 12595200, 12628616, 6, 10883072, 10850304, 884736, 196992, 1605632, 24960, 384, 8576, 16768, 3072, 0, 1024, 2048, 1433600, 409600, 1073741824, 1073741824, 409600, 1536
recA 1280, 1408, 384, 0, 0, 384, 384, 3620864, 3665920, 12633032, 12611584, 12629640, 6, 10891264, 10858496, 2064384, 459136, 1605632, 24960, 384, 8576, 16768, 3072, 0, 1024, 2048, 1440768, 411648, 1073741824, 1073741824, 409600, 1536
recA 2176, 1664, 640, 0, 0, 384, 384, 3694592, 3739648, 12634056, 12627968, 12630664, 6, 10899456, 10866688, 3244032, 721280, 1605632, 24960, 384, 8576, 16768, 3072, 0, 1024, 2048, 1447936, 413696, 1073741824, 1073741824, 409600, 1536
recA 3072, 1920, 896, 0, 0, 384, 384, 3768320, 3813376, 12635080, 12644352, 12631688, 6, 10907648, 10874880, 4423680, 983424, 1605632, 24960, 384, 8576, 16768, 3072, 0, 1024, 2048, 1455104, 415744, 1073741824, 1073741824, 409600, 1536
recA 384, 1152, 128, 0, 0, 384, 384, 8265728, 8310784, 12697544, 12660736, 12694152, 14, 11407360, 11374592, 5603328, 1245568, 1605632, 24960, 384, 8576, 16768, 3072, 0, 1024, 2048, 1462272, 417792, 1073741824, 1073741824, 409600, 1536
recA 1280, 1408, 384, 0, 0, 384, 384, 8339456, 8384512, 12698568, 12677120, 12695176, 14, 11415552, 11382784, 6782976, 1507712, 1605632, 24960, 384, 8576, 16768, 3072, 0, 1024, 2048, 1469440, 419840, 1073741824, 1073741824, 409600, 1536
recA 2176, 1664, 640, 0, 0, 384, 384, 8413184, 8458240, 12699592, 12693504, 12696200, 14, 11423744, 11390976, 7962624, 1769856, 1605632, 24960, 384, 8576, 16768, 3072, 0, 1024, 2048, 1476608, 421888, 1073741824, 1073741824, 409600, 1536
recA 3072, 1920, 896, 0, 0, 384, 384, 8486912, 8531968, 12700616, 12709888, 12697224, 14, 11431936, 11399168, 9142272, 2032000, 1605632, 24960, 384, 8576, 16768, 3072, 0, 1024, 2048, 1483776, 423936, 1073741824, 1073741824, 409600, 1536
recB 0, 512, 768, 0, 0, 512, 512, 3538944, 3588096, 12632016, 12595200, 12628624, 6, 10878976, 10846208, 884736, 197120, 1638400, 25088, 512, 8704, 16896, 3072, 0, 1024, 2048, 1490944, 425984, 1073741824, 1073741824, 425984, 2048
recB 896, 1408, 1664, 0, 0, 512, 512, 3612672, 3661824, 12633040, 12611584, 12629648, 6, 10887168, 10854400, 2064384, 459264, 1638400, 25088, 512, 8704, 16896, 3072, 0, 1024, 2048, 1498112, 428032, 1073741824, 1073741824, 425984, 2048
recB 1792, 2304, 2560, 0, 0, 512, 512, 3686400, 3735552, 12634064, 12627968, 12630672, 6, 10895360, 10862592, 3244032, 721408, 1638400, 25088, 512, 8704, 16896, 3072, 0, 1024, 2048, 1505280, 430080, 1073741824, 1073741824, 425984, 2048
recB 2688, 3200, 3456, 0, 0, 512, 512, 3760128, 3809280, 12635088, 12644352, 12631696, 6, 10903552, 10870784, 4423680, 983552, 1638400, 25088, 512, 8704, 16896, 3072, 0, 1024, 2048, 1512448, 432128, 1073741824, 1073741824, 425984, 2048
recB 0, 512, 768, 0, 0, 512, 512, 8257536, 8306688, 12697552, 12660736, 12694160, 14, 11403264, 11370496, 5603328, 1245696, 1638400, 25088, 512, 8704, 16896, 3072, 0, 1024, 2048, 1519616, 434176, 1073741824, 1073741824, 425984, 2048
recB 896, 1408, 1664, 0, 0, 512, 512, 8331264, 8380416, 12698576, 12677120, 12695184, 14, 11411456, 11378688, 6782976, 1507840, 1638400, 25088, 512, 8704, 16896, 3072, 0, 1024, 2048, 1526784, 436224, 1073741824, 1073741824, 425984, 2048
recB 1792, 2304, 2560, 0, 0, 512, 512, 8404992, 8454144, 12699600, 12693504, 12696208, 14, 11419648, 11386880, 7962624, 1769984, 1638400, 25088, 512, 8704, 16896, 3072, 0, 1024, 2048, 1533952, 438272, 1073741824, 1073741824, 425984, 2048
recB 2688, 3200, 3456, 0, 0, 512, 512, 8478720, 8527872, 12700624, 12709888, 12697232, 14, 11427840, 11395072, 9142272, 2032128, 1638400, 25088, 512, 8704, 16896, 3072, 0, 1024, 2048, 1541120, 440320, 1073741824, 1073741824, 425984, 2048
recB 128, 640, 832, 0, 0, 640, 640, 3547136, 3592192, 12632024, 12595200, 12628632, 6, 10883072, 10850304, 884736, 197248, 1671168, 25216, 640, 8832, 17024, 3072, 0, 1024, 2048, 1548288, 442368, 1073741824, 1073741824, 442368, 2560
recB 1024, 1536, 1728, 0, 0, 640, 640, 3620864, 3665920, 12633048, 12611584, 12629656, 6, 10891264, 10858496, 2064384, 459392, 1671168, 25216, 640, 8832, 17024, 3072, 0, 1024, 2048, 1555456, 444416, 1073741824, 1073741824, 442368, 2560
recB 1920, 2432, 2624, 0, 0, 640, 640, 3694592, 3739648, 12634072, 12627968, 12630680, 6, 10899456, 10866688, 3244032, 721536, 1671168, 25216, 640, 8832, 17024, 3072, 0, 1024, 2048, 1562624, 446464, 1073741824, 1073741824, 442368, 2560
recB 2816, 3328, 3520, 0, 0, 640, 640, 3768320, 3813376, 12635096, 12644352, 12631704, 6, 10907648, 10874880, 4423680, 983680, 1671168, 25216, 640, 8832, 17024, 3072, 0, 1024, 2048, 1569792, 448512, 1073741824, 1073741824, 442368, 2560
recB 128, 640, 832, 0, 0, 640, 640, 8265728, 8310784, 12697560, 12660736, 12694168, 14, 11407360, 11374592, 5603328, 1245824, 1671168, 25216, 640, 8832, 17024, 3072, 0, 1024, 2048, 1576960, 450560, 1073741824, 1073741824, 442368, 2560
recB 1024, 1536, 1728, 0, 0, 640, 640, 8339456, 8384512, 12698584, 12677120, 12695192, 14, 11415552, 11382784, 6782976, 1507968, 1671168, 25216, 640, 8832, 17024, 3072, 0, 1024, 2048, 1584128, 452608, 1073741824, 1073741824, 442368, 2560
recB 1920, 2432, 2624, 0, 0, 640, 640, 8413184, 8458240, 12699608, 12693504, 12696216, 14, 11423744, 11390976, 7962624, 1770112, 1671168, 25216, 640, 8832, 17024, 3072, 0, 1024, 2048, 1591296, 454656, 1073741824, 1073741824, 442368, 2560
recB 2816, 3328, 3520, 0, 0, 640, 640, 8486912, 8531968, 12700632, 12709888, 12697240, 14, 11431936, 11399168, 9142272, 2032256, 1671168, 25216, 640, 8832, 17024, 3072, 0, 1024, 2048, 1598464, 456704, 1073741824, 1073741824, 442368, 2560
recA 256, 1024, 0, 0, 0, 768, 768, 4128768, 4177920, 12640192, 12595200, 12636800, 7, 10944512, 10911744, 884736, 197376, 1703936, 25344, 768, 8960, 17152, 3072, 0, 1024, 2048, 1605632, 458752, 12640256, 28, 458752, 3072
recA 1152, 1280, 256, 0, 0, 768, 768, 4202496, 4251648, 12641216, 12611584, 12637824, 7, 10952704, 10919936, 2064384, 459520, 1703936, 25344, 768, 8960, 17152, 3072, 0, 1024, 2048, 1612800, 460800, 1073741824, 1073741824, 458752, 3072
recA 2048, 1536, 512, 0, 0, 768, 768, 4276224, 4325376, 12642240, 12627968, 12638848, 7, 10960896, 10928128, 3244032, 721664, 1703936, 25344, 768, 8960, 17152, 3072, 0, 1024, 2048, 1619968, 462848, 1073741824, 1073741824, 458752, 3072
recA 2944, 1792, 768, 0, 0, 768, 768, 4349952, 4399104, 12643264, 12644352, 12639872, 7, 10969088, 10936320, 4423680, 983808, 1703936, 25344, 768, 8960, 17152, 3072, 0, 1024, 2048, 1627136, 464896, 1073741824, 1073741824, 458752, 3072
recA 256, 1024, 0, 0, 0, 768, 768, 8847360, 8896512, 12705728, 12660736, 12702336, 15, 11468800, 11436032, 5603328, 1245952, 1703936, 25344, 768, 8960, 17152, 3072, 0, 1024, 2048, 1634304, 466944, 12705792, 60, 458752, 3072
recA 1152, 1280, 256, 0, 0, 768, 768, 8921088, 8970240, 12706752, 12677120, 12703360, 15, 11476992, 11444224, 6782976, 1508096, 1703936, 25344, 768, 8960, 17152, 3072, 0, 1024, 2048, 1641472, 468992, 1073741824, 1073741824, 458752, 3072
recA 2048, 1536, 512, 0, 0, 768, 768, 8994816, 9043968, 12707776, 12693504, 12704384, 15, 11485184, 11452416, 7962624, 1770240, 1703936, 25344, 768, 8960, 17152, 3072, 0, 1024, 2048, 1648640, 471040, 1073741824, 1073741824, 458752, 3072
recA 2944, 1792, 768, 0, 0, 768, 768, 9068544, 9117696, 12708800, 12709888, 12705408, 15, 11493376, 11460608, 9142272, 2032384, 1703936, 25344, 768, 8960, 17152, 3072, 0, 1024, 2048, 1655808, 473088, 1073741824, 1073741824, 458752, 3072
recA 384, 1152, 128, 0, 0, 896, 896, 4136960, 4182016, 12640200, 12595200, 12636808, 7, 10948608, 10915840, 884736, 197504, 1736704, 25472, 896, 9088, 17280, 3072, 0, 1024, 2048, 1662976, 475136, 1073741824, 1073741824, 475136, 3584
recA 1280, 1408, 384, 0, 0, 896, 896, 4210688, 4255744, 12641224, 12611584, 12637832, 7, 10956800, 10924032, 2064384, 459648, 1736704, 25472, 896, 9088, 17280, 3072, 0, 1024, 2048, 1670144, 477184, 1073741824, 1073741824, 475136, 3584
recA 2176, 1664, 640, 0, 0, 896, 896, 4284416, 4329472, 12642248, 12627968, 12638856, 7, 10964992, 10932224, 3244032, 721792, 1736704, 25472, 896, 9088, 17280, 3072, 0, 1024, 2048, 1677312, 479232, 1073741824, 1073741824, 475136, 3584
recA 3072, 1920, 896, 0, 0, 896, 896, 4358144, 4403200, 12643272, 12644352, 12639880, 7, 10973184, 10940416, 4423680, 983936, 1736704, 25472, 896, 9088, 17280, 3072, 0, 1024, 2048, 1684480, 481280, 1073741824, 1073741824, 475136, 3584
recA 384, 1152, 128, 0, 0, 896, 896, 8855552, 8900608, 12705736, 12660736, 12702344, 15, 11472896, 11440128, 5603328, 1246080, 1736704, 25472, 896, 9088, 17280, 3072, 0, 1024, 2048, 1691648, 483328, 1073741824, 1073741824, 475136, 3584
recA 1280, 1408, 384, 0, 0, 896, 896, 8929280, 8974336, 12706760, 12677120, 12703368, 15, 11481088, 11448320, 6782976, 1508224, 1736704, 25472, 896, 9088, 17280, 3072, 0, 1024, 2048, 1698816, 485376, 1073741824, 1073741824, 475136, 3584
recA 2176, 1664, 640, 0, 0, 896, 896, 9003008, 9048064, 12707784, 12693504, 12704392, 15, 11489280, 11456512, 7962624, 1770368, 1736704, 25472, 896, 9088, 17280, 3072, 0, 1024, 2048, 1705984, 487424, 1073741824, 1073741824, 475136, 3584
recA 3072, 1920, 896, 0, 0, 896, 896, 9076736, 9121792, 12708808, 12709888, 12705416, 15, 11497472, 11464704, 9142272, 2032512, 1736704, 25472, 896, 9088, 17280, 3072, 0, 1024, 2048, 1713152, 489472, 1073741824, 1073741824, 475136, 3584
recB 0, 512, 768, 0, 0, 0, 0, 4128768, 4177920, 12640208, 12595200, 12636816, 7, 10944512, 10911744, 884736, 196608, 1769472, 24576, 0, 8192, 16384, 3072, 0, 1024, 2048, 1720320, 491520, 1073741824, 1073741824, 491520, 0
recB 896, 1408, 1664, 0, 0, 0, 0, 4202496, 4251648, 12641232, 12611584, 12637840, 7, 10952704, 10919936, 2064384, 458752, 1769472, 24576, 0, 8192, 16384, 3072, 0, 1024, 2048, 1727488, 493568, 1073741824, 1073741824, 491520, 0
recB 1792, 2304, 2560, 0, 0, 0, 0, 4276224, 4325376, 12642256, 12627968, 12638864, 7, 10960896, 10928128, 3244032, 720896, 1769472, 24576, 0, 8192, 16384, 3072, 0, 1024, 2048, 1734656, 495616, 1073741824, 1073741824, 491520, 0
recB 2688, 3200, 3456, 0, 0, 0, 0, 4349952, 4399104, 12643280, 12644352, 12639888, 7, 10969088, 10936320, 4423680, 983040, 1769472, 24576, 0, 8192, 16384, 3072, 0, 1024, 2048, 1741824, 497664, 1073741824, 1073741824, 491520, 0
recB 0, 512, 768, 0, 0, 0, 0, 8847360, 8896512, 12705744, 12660736, 12702352, 15, 11468800, 11436032, 5603328, 1245184, 1769472, 24576, 0, 8192, 16384, 3072, 0, 1024, 2048, 1748992, 499712, 1073741824, 1073741824, 491520, 0
recB 896, 1408, 1664, 0, 0, 0, 0, 8921088, 8970240, 12706768, 12677120, 12703376, 15, 11476992, 11444224, 6782976, 1507328, 1769472, 24576, 0, 8192, 16384, 3072, 0, 1024, 2048, 1756160, 501760, 1073741824, 1073741824, 491520, 0
recB 1792, 2304, 2560, 0, 0, 0, 0, 8994816, 9043968, 12707792, 12693504, 12704400, 15, 11485184, 11452416, 7962624, 1769472, 1769472, 24576, 0, 8192, 16384, 3072, 0, 1024, 2048, 1763328, 503808, 1073741824, 1073741824, 491520, 0
recB 2688, 3200, 3456, 0, 0, 0, 0, 9068544, 9117696, 12708816, 12709888, 12705424, 15, 11493376, 11460608, 9142272, 2031616, 1769472, 24576, 0, 8192, 16384, 3072, 0, 1024, 2048, 1770496, 505856, 1073741824, 1073741824, 491520, 0
recB 128, 640, 832, 0, 0, 128, 128, 4136960, 4182016, 12640216, 12595200, 12636824, 7, 10948608, 10915840, 884736, 196736, 1802240, 24704, 128, 8320, 16512, 3072, 0, 1024, 2048, 1777664, 507904, 1073741824, 1073741824, 507904, 512
recB 1024, 1536, 1728, 0, 0, 128, 128, 4210688, 4255744, 12641240, 12611584, 12637848, 7, 10956800, 10924032, 2064384, 458880, 1802240, 24704, 128, 8320, 16512, 3072, 0, 1024, 2048, 1784832, 509952, 1073741824, 1073741824, 507904, 512
recB 1920, 2432, 2624, 0, 0, 128, 128, 4284416, 4329472, 12642264, 12627968, 12638872, 7, 10964992, 10932224, 3244032, 721024, 1802240, 24704, 128, 8320, 16512, 3072, 0, 1024, 2048, 1792000, 512000, 1073741824, 1073741824, 507904, 512
recB 2816, 3328, 3520, 0, 0, 128, 128, 4358144, 4403200, 12643288, 12644352, 12639896, 7, 10973184, 10940416, 4423680, 983168, 1802240, 24704, 128, 8320, 16512, 3072, 0, 1024, 2048, 1799168, 514048, 1073741824, 1073741824, 507904, 512
recB 128, 640, 832, 0, 0, 128, 128, 8855552, 8900608, 12705752, 12660736, 12702360, 15, 11472896, 11440128, 5603328, 1245312, 1802240, 24704, 128, 8320, 16512, 3072, 0, 1024, 2048, 1806336, 516096, 1073741824, 1073741824, 507904, 512
recB 1024, 1536, 1728, 0, 0, 128, 128, 8929280, 8974336, 12706776, 12677120, 12703384, 15, 11481088, 11448320, 6782976, 1507456, 1802240, 24704, 128, 8320, 16512, 3072, 0, 1024, 2048, 1813504, 518144, 1073741824, 1073741824, 507904, 512
recB 1920, 2432, 2624, 0, 0, 128, 128, 9003008, 9048064, 12707800, 12693504, 12704408, 15, 11489280, 11456512, 7962624, 1769600, 1802240, 24704, 128, 8320, 16512, 3072, 0, 1024, 2048, 1820672, 520192, 1073741824, 1073741824, 507904, 512
recB 2816, 3328, 3520, 0, 0, 128, 128, 9076736, 9121792, 12708824, 12709888, 12705432, 15, 11497472, 11464704, 9142272, 2031744, 1802240, 24704, 128, 8320, 16512, 3072, 0, 1024, 2048, 1827840, 522240, 1073741824, 1073741824, 507904, 512
.size L_tab, 131072
.section .rodata,"a"
.p2align 6
.amdhsa_kernel parallel_sum__sliding_local_dilated__glu_gated_swiglu__prompt_kernel
  .amdhsa_next_free_vgpr 512
  .amdhsa_next_free_sgpr 102
  .amdhsa_accum_offset 256
  .amdhsa_group_segment_fixed_size 0
  .amdhsa_kernarg_size 80
  .amdhsa_user_sgpr_count 2
  .amdhsa_user_sgpr_kernarg_segment_ptr 1
  .amdhsa_system_sgpr_workgroup_id_x 1
.end_amdhsa_kernel
```
